```python
import torch

def _softmax(x, axis=-1):
    return torch.softmax(x, dim=axis)

def _gelu(x):
    return torch.nn.functional.gelu(x, approximate='tanh')

def _silu(x):
    return torch.nn.functional.silu(x)

def _sigmoid(x):
    return torch.sigmoid(x)

def _layernorm(x, axis=-1, eps=1e-05):
    m = x.mean(dim=axis, keepdim=True)
    v = x.var(dim=axis, keepdim=True, unbiased=False)
    return (x - m) / torch.sqrt(v + eps)

def _scatter_add(tgt, idx, src, axis=0):
    return tgt.clone().index_add_(axis, idx, src)

def _segment_sum(src, seg, n):
    out = torch.zeros((n,) + src.shape[1:], dtype=src.dtype)
    return out.index_add_(0, seg, src)

def _pad(x, pw):
    flat = tuple((v for pair in reversed(pw) for v in pair))
    return torch.nn.functional.pad(x, flat)
kernel_name = 'adaLN_cond__ssm_conv_s4__swiglu_ffn__prompt'

def setup_inputs():

    _w = lambda a: (lambda t: t.to(torch.bfloat16) if t.is_floating_point() else t)(torch.as_tensor(a))

    def _A_setup():
        B, L, D, N = (1, 2048, 448, 256)
        A_re = -(lambda _x: torch.exp(torch.as_tensor(_x)))((lambda *s: torch.randn(*s, dtype=torch.bfloat16) * 3.2)(D, N))
        A_im = torch.pi * (lambda *s: torch.randn(*s, dtype=torch.bfloat16) * 0.1)(D, N)
        B_re = (lambda *s: torch.randn(*s, dtype=torch.bfloat16) * 0.1)(D, N)
        B_im = (lambda *s: torch.randn(*s, dtype=torch.bfloat16) * 0.1)(D, N)
        C_re = (lambda *s: torch.randn(*s, dtype=torch.bfloat16) * 0.1)(D, N)
        C_im = (lambda *s: torch.randn(*s, dtype=torch.bfloat16) * 0.1)(D, N)
        log_dt = (lambda *s: torch.randn(*s, dtype=torch.bfloat16) * 0.1)(D) * 0.5 - 4.0
        Dskip = (lambda *s: torch.randn(*s, dtype=torch.bfloat16) * 0.1)(D)
        return {'u': _w((lambda *s: torch.randn(*s, dtype=torch.bfloat16) * 0.05)(B, L, D)), 'A_re': _w(A_re), 'A_im': _w(A_im), 'B_re': _w(B_re), 'B_im': _w(B_im), 'C_re': _w(C_re), 'C_im': _w(C_im), 'log_dt': _w(log_dt), 'Dskip': _w(Dskip)}
    _A_in = _A_setup()

    def _B_setup():
        B, S, D, F = (1, 2048, 448, 1792)
        return {'x': _w((lambda *s: torch.randn(*s, dtype=torch.bfloat16) * 0.05)(B, S, D)), 'w_gate': _w((lambda *s: torch.randn(*s, dtype=torch.bfloat16) * 0.05)(D, F)), 'w_up': _w((lambda *s: torch.randn(*s, dtype=torch.bfloat16) * 0.05)(D, F)), 'w_down': _w((lambda *s: torch.randn(*s, dtype=torch.bfloat16) * 0.05)(F, D))}
    _B_in = _B_setup()
    return {'A_u': _A_in['u'], 'A_A_re': _A_in['A_re'], 'A_A_im': _A_in['A_im'], 'A_B_re': _A_in['B_re'], 'A_B_im': _A_in['B_im'], 'A_C_re': _A_in['C_re'], 'A_C_im': _A_in['C_im'], 'A_log_dt': _A_in['log_dt'], 'A_Dskip': _A_in['Dskip'], 'B_x': _B_in['x'], 'B_w_gate': _B_in['w_gate'], 'B_w_up': _B_in['w_up'], 'B_w_down': _B_in['w_down'], 'c': _w((lambda *s: torch.randn(*s, dtype=torch.bfloat16) * 0.1)(1, 448) * 8.0), 'w_mod': _w((lambda *s: torch.randn(*s, dtype=torch.bfloat16) * 0.1)(448, 6 * 448) * 448 ** (-0.5) * 8.0)}

def reference(A_u, A_A_re, A_A_im, A_B_re, A_B_im, A_C_re, A_C_im, A_log_dt, A_Dskip, B_x, B_w_gate, B_w_up, B_w_down, c, w_mod):

    def _A_ref(u, A_re, A_im, B_re, B_im, C_re, C_im, log_dt, Dskip):
        Bsz, L, D = u.shape
        dt = torch.exp(log_dt)[:, None]
        A = A_re + 1j * A_im
        Bc = B_re + 1j * B_im
        Cc = C_re + 1j * C_im
        logdA = dt * A
        dB = dt * Bc
        l = (lambda x, dt: x.to(dt))(torch.arange(L), A_re.dtype)
        P = torch.exp(logdA[:, :, None] * l[None, None, :])
        K = torch.einsum('dn,dnl,dn->dl', Cc, P, dB).real
        L2 = 2 * L
        Kp = _pad(K, ((0, 0), (0, L)))
        up = (lambda x, *d: x.permute(*d))(u, 0, 2, 1)
        up = _pad(up, ((0, 0), (0, 0), (0, L)))
        Kf = (lambda x, axes=(-2, -1): torch.fft.rfft2(x.float(), dim=axes))(Kp[:, None, :], axes=(-2, -1))
        Uf = (lambda x, axes=(-2, -1): torch.fft.rfft2(x.float(), dim=axes))(up[:, :, None, :], axes=(-2, -1))
        Yf = Uf * Kf[None, :, :, :]
        y = (lambda x, s, axes=(-2, -1): torch.fft.irfft2(x, s=s, dim=axes).to(torch.bfloat16))(Yf, (1, L2), axes=(-2, -1))[:, :, 0, :L]
        y = (lambda x, *d: x.permute(*d))(y, 0, 2, 1) + u * Dskip[None, None, :]
        return y

    def _B_ref(x, w_gate, w_up, w_down):
        g = _silu(x @ w_gate)
        u = x @ w_up
        return g * u @ w_down
    x = A_u
    mod = (_silu(c) @ w_mod).reshape(c.shape[0], 6, 1, -1)
    sa, ca, ga, sb, cb, gb = (mod[:, 0].clone(), mod[:, 1].clone(), mod[:, 2].clone(), mod[:, 3].clone(), mod[:, 4].clone(), mod[:, 5].clone())
    h = _layernorm(x, axis=-1) * (1 + ca) + sa
    x = x + ga * _A_ref(h, A_A_re, A_A_im, A_B_re, A_B_im, A_C_re, A_C_im, A_log_dt, A_Dskip)
    h = _layernorm(x, axis=-1) * (1 + cb) + sb
    x = x + gb * _B_ref(h, B_w_gate, B_w_up, B_w_down)
    return x
```

```asm
; @launch grid=(256,1,1) block=(256,1,1) lds=163840
.amdgcn_target "amdgcn-amd-amdhsa--gfx950"
.text
.globl adaLN_cond__ssm_conv_s4__swiglu_ffn__prompt_kernel
.p2align 8
.type adaLN_cond__ssm_conv_s4__swiglu_ffn__prompt_kernel,@function
adaLN_cond__ssm_conv_s4__swiglu_ffn__prompt_kernel:
    s_cmp_ge_u32 s2, 256
    s_cbranch_scc1 L_end
    s_load_dwordx2 s[40:41], s[0:1], 0
    s_load_dwordx2 s[44:45], s[0:1], 136
    s_load_dwordx16 s[4:19], s[0:1], 0
    s_load_dwordx16 s[20:35], s[0:1], 64
    s_getpc_b64 s[76:77]
L_pc:
    s_lshr_b32 s74, s2, 3
    s_mul_i32 s74, s74, 1664
    v_lshrrev_b32 v3, 6, v0
    v_min_u32 v4, 12, v0
    v_lshl_add_u32 v4, v4, 7, s74
    v_min_u32 v4, L_code_end-L_pc-4, v4
    v_readfirstlane_b32 s64, v3
    v_and_b32 v1, 63, v0
    global_load_dword v5, v4, s[76:77]
    s_sub_u32 s66, s2, 32
    s_cbranch_scc1 L_helper
    s_and_b32 s76, s66, 7
    s_lshr_b32 s77, s66, 3
    s_mul_i32 s63, s76, 28
    s_add_u32 s63, s63, s77
    s_lshl_b32 s74, s63, 10
    v_lshl_add_u32 v99, v0, 2, s74
    s_lshl_b32 s75, s63, 2
    s_waitcnt lgkmcnt(0)
    global_load_dword v66, v99, s[6:7] nt
    global_load_dword v67, v99, s[8:9] nt
    global_load_dword v68, v99, s[10:11] nt
    global_load_dword v69, v99, s[12:13] nt
    global_load_dword v70, v99, s[14:15] nt
    global_load_dword v71, v99, s[16:17] nt
    s_load_dword s72, s[18:19], s75
    s_load_dword s73, s[20:21], s75
    s_load_dword s65, s[44:45], 0
    s_mov_b32 s42, 1835008
    s_mov_b32 s43, 0x00020000
    s_mov_b32 s46, 0x10000000
    s_mov_b32 s47, 0x00020000
    s_lshl2_add_u32 s36, s2, s64
    s_mul_i32 s37, s36, 1792
    v_lshrrev_b32 v3, 5, v1
    v_mul_u32_u24 v3, 896, v3
    v_and_b32 v4, 31, v1
    v_cmp_gt_u32 vcc, 28, v4
    v_lshl_add_u32 v3, v4, 4, v3
    v_bfrev_b32 v4, 2
    v_cndmask_b32 v2, v4, v3, vcc
    v_min_u32 v98, 147, v0
    v_lshrrev_b32 v100, 1, v98
    v_mul_u32_u24 v100, 896, v100
    v_and_b32 v98, 1, v98
    v_mul_u32_u24 v98, 108, v98
    v_add_u32 v98, v98, v100
    s_mul_i32 s74, s77, 592
    s_add_u32 s74, s74, s76
    s_mul_i32 s74, s74, 112
    s_lshl_b32 s78, s36, 4
    s_add_u32 s78, s78, 4096
    buffer_load_dword v5, off, s[44:47], s78
    buffer_load_dwordx4 v[88:91], v2, s[40:43], s37 offen
    buffer_load_dwordx4 v[92:95], v2, s[40:43], s37 offen offset:448
    v_add_u32 v101, s74, v98
    v_mul_u32_u24 v31, 1792, v1
    s_mul_i32 s79, s64, 229376
    s_add_u32 s79, s79, s75
    s_and_b32 s23, s64, 1
    s_mul_i32 s38, s64, 16320
    s_lshr_b32 s76, s64, 1
    s_mul_i32 s39, s76, 9152
    s_add_u32 s39, s39, 33792
    v_and_b32 v98, 31, v1
    v_lshrrev_b32 v99, 5, v1
    v_lshl_add_u32 v100, v99, 4, s38
    v_mul_u32_u24 v105, 272, v98
    v_add_u32 v105, v105, v100
    v_cmp_lt_u32 vcc, 27, v98
    v_add_u32 v104, 8704, v105
    v_add_u32 v100, 8160, v105
    v_cndmask_b32 v104, v104, v100, vcc
    v_lshlrev_b32 v98, 4, v98
    v_sub_u32 v98, s39, v98
    v_lshlrev_b32 v108, 3, v99
    v_sub_u32 v108, v98, v108
    s_add_u32 s74, s23, 9
    v_lshlrev_b32 v109, s74, v99
    v_sub_u32 v109, v98, v109
    v_lshl_add_u32 v106, v1, 4, s38
    s_xor_b32 s74, s64, 1
    s_mul_i32 s74, s74, 16320
    v_lshl_add_u32 v107, v1, 4, s74
    s_lshl_b32 s74, s64, 11
    v_lshl_add_u32 v52, v1, 4, s74
    v_and_b32 v98, 3, v1
    v_mul_u32_u24 v20, 3584, v98
    s_lshl_b32 s74, s63, 4
    s_add_u32 s74, s74, 32768
    v_add_u32 v20, s74, v20
    v_bfe_u32 v28, v1, 1, 1
    v_cvt_f32_u32 v28, v28
    v_mov_b32 v207, 0x3f80
    s_mov_b32 m0, s38
    s_lshl_b32 s11, s64, 10
    s_lshl_b32 s12, s64, 13
    ds_write_addtid_b32 v207
    v_lshrrev_b32 v96, 3, v1
    v_and_b32 v97, 7, v1
    s_lshr_b32 s74, s66, 3
    s_mul_i32 s67, s74, 9363
    s_lshr_b32 s67, s67, 16
    s_mul_i32 s68, s67, 7
    s_sub_u32 s68, s74, s68
    s_bfe_u32 s75, s66, 0x20001
    s_lshl2_add_u32 s69, s75, s67
    s_and_b32 s75, s66, 1
    s_mul_i32 s70, s75, 7
    s_add_u32 s70, s70, s68
    s_lshl1_add_u32 s71, s67, s68
    s_bfe_u32 s75, s66, 0x20001
    s_add_u32 s71, s71, s75
    s_mov_b32 s76, 0x06543210
    s_mov_b32 s77, 0x10654321
    s_sub_u32 s75, s71, 7
    s_min_u32 s71, s71, s75
    s_lshl_b32 s71, s71, 2
    s_lshr_b64 s[76:77], s[76:77], s71
    s_cmp_lt_u32 s64, 2
    s_cselect_b64 s[48:49], s[24:25], s[26:27]
    s_mov_b32 s50, 1605632
    s_mov_b32 s51, 0x00020000
    s_bfe_u32 s74, s76, 0x30000
    s_lshl_b32 s4, s74, 12
    s_bfe_u32 s74, s76, 0x30004
    s_lshl_b32 s5, s74, 12
    s_bfe_u32 s74, s76, 0x30008
    s_lshl_b32 s6, s74, 12
    s_bfe_u32 s74, s76, 0x3000c
    s_lshl_b32 s7, s74, 12
    s_bfe_u32 s74, s76, 0x30010
    s_lshl_b32 s8, s74, 12
    s_bfe_u32 s74, s76, 0x30014
    s_lshl_b32 s9, s74, 12
    s_bfe_u32 s74, s76, 0x30018
    s_lshl_b32 s10, s74, 12
    v_lshlrev_b32 v98, 1, v96
    v_and_b32 v98, 4, v98
    v_xor_b32 v98, v98, v97
    v_lshlrev_b32 v98, 4, v98
    s_lshl1_add_u32 s74, s70, s23
    s_lshl_b32 s74, s74, 7
    v_mul_u32_u24 v12, 3584, v96
    v_add3_u32 v12, v12, v98, s74
    s_bitcmp1_b32 s67, 0
    s_cbranch_scc1 L_varB
    buffer_load_dword v5, v101, s[40:43], 0 offen
    s_add_u32 m0, s12, 98304
    s_mul_i32 s13, s4, 56
    buffer_load_dwordx4 v12, s[48:51], s13 offen  lds
    s_add_u32 s13, s13, 27648
    buffer_load_dwordx4 v12, s[48:51], s13 offen offset:1024  lds
    s_mov_b32 m0, s38
    s_mov_b64 exec, 0
    s_cmp_eq_u32 s64, 0
    s_cbranch_scc1 L_padS0
    s_cmp_eq_u32 s64, 1
    s_cbranch_scc1 L_padS1
    s_cmp_eq_u32 s64, 2
    s_cbranch_scc1 L_padS2
    s_branch L_padS3
L_padS3:
L_retS:
    s_mov_b64 exec, -1
    s_waitcnt lgkmcnt(0)
    s_add_u32 s65, s65, 1
    s_lshl_b32 s74, s72, 16
    s_and_b32 s75, s72, 0xffff0000
    s_lshl_b32 s76, s73, 16
    s_and_b32 s77, s73, 0xffff0000
    s_cmp_lt_u32 s64, 2
    s_cselect_b32 s72, s74, s75
    s_cselect_b32 s73, s76, s77
    v_mov_b32 v98, 0x3fb8aa3b
    v_mul_f32 v102, s72, v98
    v_exp_f32 v102, v102
    s_nop 0
    v_cvt_pk_bf16_f32 v102, v102, v102
    v_lshlrev_b32 v102, 16, v102
    s_waitcnt vmcnt(6)
    v_lshlrev_b32 v174, 16, v66
    v_lshlrev_b32 v175, 16, v67
    v_lshlrev_b32 v176, 16, v68
    v_lshlrev_b32 v177, 16, v69
    v_lshlrev_b32 v178, 16, v70
    v_lshlrev_b32 v179, 16, v71
    v_mul_f32 v174, v102, v174
    v_mul_f32 v175, v102, v175
    v_mul_f32 v174, 0x3fb8aa3b, v174
    v_mul_f32 v175, 0.15915494, v175
    v_mul_f32 v176, v102, v176
    v_mul_f32 v177, v102, v177
    v_mul_f32 v98, 0x41000000, v174
    v_mul_f32 v99, 0x41000000, v175
    v_exp_f32 v98, v98
    v_fract_f32 v99, v99
    v_cos_f32 v188, v99
    v_sin_f32 v189, v99
    v_mul_f32 v188, v188, v98
    v_mul_f32 v189, v189, v98
    v_exp_f32 v98, v174
    v_fract_f32 v99, v175
    v_cos_f32 v182, v99
    v_sin_f32 v183, v99
    v_mul_f32 v182, v182, v98
    v_mul_f32 v183, v183, v98
    v_mul_f32 v98, 0x43800000, v174
    v_mul_f32 v99, 0x43800000, v175
    v_exp_f32 v98, v98
    v_fract_f32 v99, v99
    v_cos_f32 v190, v99
    v_sin_f32 v191, v99
    v_mul_f32 v190, v190, v98
    v_mul_f32 v191, v191, v98
    .p2align 3
    v_pk_mul_f32 v[184:185], v[182:183], v[182:183] op_sel:[0,0] op_sel_hi:[1,0]
    v_pk_fma_f32 v[184:185], v[182:183], v[182:183], v[184:185] op_sel:[1,1,0] op_sel_hi:[0,1,1] neg_lo:[0,1,0]
    v_cvt_pk_bf16_f32 v200, v188, v189
    v_pk_mul_f32 v[180:181], v[178:179], v[176:177] op_sel:[0,0] op_sel_hi:[1,0]
    v_pk_fma_f32 v[180:181], v[178:179], v[176:177], v[180:181] op_sel:[1,1,0] op_sel_hi:[0,1,1] neg_lo:[0,1,0]
    v_pk_mul_f32 v[186:187], v[184:185], v[184:185] op_sel:[0,0] op_sel_hi:[1,0]
    v_pk_fma_f32 v[186:187], v[184:185], v[184:185], v[186:187] op_sel:[1,1,0] op_sel_hi:[0,1,1] neg_lo:[0,1,0]
    v_cvt_pk_bf16_f32 v201, v180, -v181
    v_pk_mul_f32 v[192:193], v[188:189], v[188:189] op_sel:[0,0] op_sel_hi:[1,0]
    v_pk_fma_f32 v[192:193], v[188:189], v[188:189], v[192:193] op_sel:[1,1,0] op_sel_hi:[0,1,1] neg_lo:[0,1,0]
    v_cvt_pk_bf16_f32 v202, v192, v193
    v_pk_mul_f32 v[194:195], v[192:193], v[188:189] op_sel:[0,0] op_sel_hi:[1,0]
    v_pk_fma_f32 v[194:195], v[192:193], v[188:189], v[194:195] op_sel:[1,1,0] op_sel_hi:[0,1,1] neg_lo:[0,1,0]
    v_cvt_pk_bf16_f32 v203, v194, v195
    s_add_u32 m0, s12, 100352
    s_add_u32 s13, s13, 29696
    buffer_load_dwordx4 v12, s[48:51], s13 offen  lds
    s_add_u32 s13, s13, 27648
    buffer_load_dwordx4 v12, s[48:51], s13 offen offset:1024  lds
    s_mov_b32 m0, s38
    s_nop 0
    ds_write_addtid_b32 v200 offset:272
    ds_write_addtid_b32 v201 offset:8704
    ds_write_addtid_b32 v202 offset:544
    ds_write_addtid_b32 v203 offset:816
    .p2align 3
    v_pk_mul_f32 v[192:193], v[194:195], v[188:189] op_sel:[0,0] op_sel_hi:[1,0]
    v_pk_fma_f32 v[192:193], v[194:195], v[188:189], v[192:193] op_sel:[1,1,0] op_sel_hi:[0,1,1] neg_lo:[0,1,0]
    v_cvt_pk_bf16_f32 v204, v192, v193
    v_pk_mul_f32 v[194:195], v[192:193], v[188:189] op_sel:[0,0] op_sel_hi:[1,0]
    v_pk_fma_f32 v[194:195], v[192:193], v[188:189], v[194:195] op_sel:[1,1,0] op_sel_hi:[0,1,1] neg_lo:[0,1,0]
    v_cvt_pk_bf16_f32 v205, v194, v195
    v_pk_mul_f32 v[192:193], v[194:195], v[188:189] op_sel:[0,0] op_sel_hi:[1,0]
    v_pk_fma_f32 v[192:193], v[194:195], v[188:189], v[192:193] op_sel:[1,1,0] op_sel_hi:[0,1,1] neg_lo:[0,1,0]
    v_cvt_pk_bf16_f32 v206, v192, v193
    v_pk_mul_f32 v[194:195], v[192:193], v[188:189] op_sel:[0,0] op_sel_hi:[1,0]
    v_pk_fma_f32 v[194:195], v[192:193], v[188:189], v[194:195] op_sel:[1,1,0] op_sel_hi:[0,1,1] neg_lo:[0,1,0]
    v_cvt_pk_bf16_f32 v207, v194, v195
    ds_write_addtid_b32 v204 offset:1088
    ds_write_addtid_b32 v205 offset:1360
    ds_write_addtid_b32 v206 offset:1632
    ds_write_addtid_b32 v207 offset:1904
    .p2align 3
    v_pk_mul_f32 v[192:193], v[194:195], v[188:189] op_sel:[0,0] op_sel_hi:[1,0]
    v_pk_fma_f32 v[192:193], v[194:195], v[188:189], v[192:193] op_sel:[1,1,0] op_sel_hi:[0,1,1] neg_lo:[0,1,0]
    v_cvt_pk_bf16_f32 v200, v192, v193
    v_pk_mul_f32 v[194:195], v[192:193], v[188:189] op_sel:[0,0] op_sel_hi:[1,0]
    v_pk_fma_f32 v[194:195], v[192:193], v[188:189], v[194:195] op_sel:[1,1,0] op_sel_hi:[0,1,1] neg_lo:[0,1,0]
    v_cvt_pk_bf16_f32 v201, v194, v195
    v_pk_mul_f32 v[192:193], v[194:195], v[188:189] op_sel:[0,0] op_sel_hi:[1,0]
    v_pk_fma_f32 v[192:193], v[194:195], v[188:189], v[192:193] op_sel:[1,1,0] op_sel_hi:[0,1,1] neg_lo:[0,1,0]
    v_cvt_pk_bf16_f32 v202, v192, v193
    v_pk_mul_f32 v[194:195], v[192:193], v[188:189] op_sel:[0,0] op_sel_hi:[1,0]
    v_pk_fma_f32 v[194:195], v[192:193], v[188:189], v[194:195] op_sel:[1,1,0] op_sel_hi:[0,1,1] neg_lo:[0,1,0]
    v_cvt_pk_bf16_f32 v203, v194, v195
    s_add_u32 m0, s12, 102400
    s_add_u32 s13, s13, 29696
    buffer_load_dwordx4 v12, s[48:51], s13 offen  lds
    s_add_u32 s13, s13, 27648
    buffer_load_dwordx4 v12, s[48:51], s13 offen offset:1024  lds
    s_mov_b32 m0, s38
    s_nop 0
    ds_write_addtid_b32 v200 offset:2176
    ds_write_addtid_b32 v201 offset:2448
    ds_write_addtid_b32 v202 offset:2720
    ds_write_addtid_b32 v203 offset:2992
    .p2align 3
    v_pk_mul_f32 v[192:193], v[194:195], v[188:189] op_sel:[0,0] op_sel_hi:[1,0]
    v_pk_fma_f32 v[192:193], v[194:195], v[188:189], v[192:193] op_sel:[1,1,0] op_sel_hi:[0,1,1] neg_lo:[0,1,0]
    v_cvt_pk_bf16_f32 v204, v192, v193
    v_pk_mul_f32 v[194:195], v[192:193], v[188:189] op_sel:[0,0] op_sel_hi:[1,0]
    v_pk_fma_f32 v[194:195], v[192:193], v[188:189], v[194:195] op_sel:[1,1,0] op_sel_hi:[0,1,1] neg_lo:[0,1,0]
    v_cvt_pk_bf16_f32 v205, v194, v195
    v_pk_mul_f32 v[192:193], v[194:195], v[188:189] op_sel:[0,0] op_sel_hi:[1,0]
    v_pk_fma_f32 v[192:193], v[194:195], v[188:189], v[192:193] op_sel:[1,1,0] op_sel_hi:[0,1,1] neg_lo:[0,1,0]
    v_cvt_pk_bf16_f32 v206, v192, v193
    v_pk_mul_f32 v[194:195], v[192:193], v[188:189] op_sel:[0,0] op_sel_hi:[1,0]
    v_pk_fma_f32 v[194:195], v[192:193], v[188:189], v[194:195] op_sel:[1,1,0] op_sel_hi:[0,1,1] neg_lo:[0,1,0]
    v_cvt_pk_bf16_f32 v207, v194, v195
    ds_write_addtid_b32 v204 offset:3264
    ds_write_addtid_b32 v205 offset:3536
    ds_write_addtid_b32 v206 offset:3808
    ds_write_addtid_b32 v207 offset:4080
    .p2align 3
    v_pk_mul_f32 v[192:193], v[194:195], v[188:189] op_sel:[0,0] op_sel_hi:[1,0]
    v_pk_fma_f32 v[192:193], v[194:195], v[188:189], v[192:193] op_sel:[1,1,0] op_sel_hi:[0,1,1] neg_lo:[0,1,0]
    v_cvt_pk_bf16_f32 v200, v192, v193
    v_pk_mul_f32 v[194:195], v[192:193], v[188:189] op_sel:[0,0] op_sel_hi:[1,0]
    v_pk_fma_f32 v[194:195], v[192:193], v[188:189], v[194:195] op_sel:[1,1,0] op_sel_hi:[0,1,1] neg_lo:[0,1,0]
    v_cvt_pk_bf16_f32 v201, v194, v195
    v_pk_mul_f32 v[192:193], v[194:195], v[188:189] op_sel:[0,0] op_sel_hi:[1,0]
    v_pk_fma_f32 v[192:193], v[194:195], v[188:189], v[192:193] op_sel:[1,1,0] op_sel_hi:[0,1,1] neg_lo:[0,1,0]
    v_cvt_pk_bf16_f32 v202, v192, v193
    v_pk_mul_f32 v[194:195], v[192:193], v[188:189] op_sel:[0,0] op_sel_hi:[1,0]
    v_pk_fma_f32 v[194:195], v[192:193], v[188:189], v[194:195] op_sel:[1,1,0] op_sel_hi:[0,1,1] neg_lo:[0,1,0]
    v_cvt_pk_bf16_f32 v203, v194, v195
    s_waitcnt vmcnt(7)
    v_mov_b32 v214, 0x3f803f80
    v_mov_b32 v212, 0
    v_mov_b32 v213, 0
    v_dot2c_f32_bf16 v212, v88, v214
    v_dot2c_f32_bf16 v213, v88, v88
    v_dot2c_f32_bf16 v212, v89, v214
    v_dot2c_f32_bf16 v213, v89, v89
    v_dot2c_f32_bf16 v212, v90, v214
    v_dot2c_f32_bf16 v213, v90, v90
    v_dot2c_f32_bf16 v212, v91, v214
    v_dot2c_f32_bf16 v213, v91, v91
    v_dot2c_f32_bf16 v212, v92, v214
    v_dot2c_f32_bf16 v213, v92, v92
    v_dot2c_f32_bf16 v212, v93, v214
    v_dot2c_f32_bf16 v213, v93, v93
    v_dot2c_f32_bf16 v212, v94, v214
    v_dot2c_f32_bf16 v213, v94, v94
    v_dot2c_f32_bf16 v212, v95, v214
    v_dot2c_f32_bf16 v213, v95, v95
    s_nop 1
    v_add_f32_dpp v212, v212, v212 row_shr:1 row_mask:0xf bank_mask:0xf bound_ctrl:1
    v_add_f32_dpp v213, v213, v213 row_shr:1 row_mask:0xf bank_mask:0xf bound_ctrl:1
    s_nop 0
    v_add_f32_dpp v212, v212, v212 row_shr:2 row_mask:0xf bank_mask:0xf bound_ctrl:1
    v_add_f32_dpp v213, v213, v213 row_shr:2 row_mask:0xf bank_mask:0xf bound_ctrl:1
    s_nop 0
    v_add_f32_dpp v212, v212, v212 row_shr:4 row_mask:0xf bank_mask:0xf bound_ctrl:1
    v_add_f32_dpp v213, v213, v213 row_shr:4 row_mask:0xf bank_mask:0xf bound_ctrl:1
    s_nop 0
    v_add_f32_dpp v212, v212, v212 row_shr:8 row_mask:0xf bank_mask:0xf bound_ctrl:1
    v_add_f32_dpp v213, v213, v213 row_shr:8 row_mask:0xf bank_mask:0xf bound_ctrl:1
    s_nop 0
    v_add_f32_dpp v212, v212, v212 row_bcast:15 row_mask:0xa bank_mask:0xf
    v_add_f32_dpp v213, v213, v213 row_bcast:15 row_mask:0xa bank_mask:0xf
    v_mul_f32 v212, 0x3b124925, v212
    v_mul_f32 v215, v212, v212
    v_mov_b32 v214, 0x3b124925
    v_fma_f32 v213, v213, v214, -v215
    v_max_f32 v213, 0, v213
    v_add_f32 v213, 0x3727c5ac, v213
    v_rsq_f32 v210, v213
    v_mov_b32 v211, s65
    v_mul_f32 v212, v212, v210
    v_readlane_b32 s75, v210, 31
    v_readlane_b32 s76, v212, 31
    s_lshl_b32 s74, s36, 4
    s_add_u32 s74, s74, 4096
    v_mov_b32 v209, s75
    v_cvt_pk_bf16_f32 v208, -s76, -v212
    s_mov_b32 exec_lo, 0
    s_mov_b32 exec_hi, 0x80000000
    buffer_store_dwordx4 v[208:211], off, s[44:47], s74 sc1
    s_mov_b64 exec, -1
    s_add_u32 m0, s12, 104448
    s_add_u32 s13, s13, 29696
    buffer_load_dwordx4 v12, s[48:51], s13 offen  lds
    s_add_u32 s13, s13, 27648
    buffer_load_dwordx4 v12, s[48:51], s13 offen offset:1024  lds
    s_mov_b32 m0, s38
    s_nop 0
    ds_write_addtid_b32 v200 offset:4352
    ds_write_addtid_b32 v201 offset:4624
    ds_write_addtid_b32 v202 offset:4896
    ds_write_addtid_b32 v203 offset:5168
    .p2align 3
    v_pk_mul_f32 v[192:193], v[194:195], v[188:189] op_sel:[0,0] op_sel_hi:[1,0]
    v_pk_fma_f32 v[192:193], v[194:195], v[188:189], v[192:193] op_sel:[1,1,0] op_sel_hi:[0,1,1] neg_lo:[0,1,0]
    v_cvt_pk_bf16_f32 v204, v192, v193
    v_pk_mul_f32 v[194:195], v[192:193], v[188:189] op_sel:[0,0] op_sel_hi:[1,0]
    v_pk_fma_f32 v[194:195], v[192:193], v[188:189], v[194:195] op_sel:[1,1,0] op_sel_hi:[0,1,1] neg_lo:[0,1,0]
    v_cvt_pk_bf16_f32 v205, v194, v195
    v_pk_mul_f32 v[192:193], v[194:195], v[188:189] op_sel:[0,0] op_sel_hi:[1,0]
    v_pk_fma_f32 v[192:193], v[194:195], v[188:189], v[192:193] op_sel:[1,1,0] op_sel_hi:[0,1,1] neg_lo:[0,1,0]
    v_cvt_pk_bf16_f32 v206, v192, v193
    v_pk_mul_f32 v[194:195], v[192:193], v[188:189] op_sel:[0,0] op_sel_hi:[1,0]
    v_pk_fma_f32 v[194:195], v[192:193], v[188:189], v[194:195] op_sel:[1,1,0] op_sel_hi:[0,1,1] neg_lo:[0,1,0]
    v_cvt_pk_bf16_f32 v207, v194, v195
    ds_write_addtid_b32 v204 offset:5440
    ds_write_addtid_b32 v205 offset:5712
    ds_write_addtid_b32 v206 offset:5984
    ds_write_addtid_b32 v207 offset:6256
    .p2align 3
    v_pk_mul_f32 v[192:193], v[194:195], v[188:189] op_sel:[0,0] op_sel_hi:[1,0]
    v_pk_fma_f32 v[192:193], v[194:195], v[188:189], v[192:193] op_sel:[1,1,0] op_sel_hi:[0,1,1] neg_lo:[0,1,0]
    v_cvt_pk_bf16_f32 v200, v192, v193
    v_pk_mul_f32 v[194:195], v[192:193], v[188:189] op_sel:[0,0] op_sel_hi:[1,0]
    v_pk_fma_f32 v[194:195], v[192:193], v[188:189], v[194:195] op_sel:[1,1,0] op_sel_hi:[0,1,1] neg_lo:[0,1,0]
    v_cvt_pk_bf16_f32 v201, v194, v195
    v_pk_mul_f32 v[192:193], v[194:195], v[188:189] op_sel:[0,0] op_sel_hi:[1,0]
    v_pk_fma_f32 v[192:193], v[194:195], v[188:189], v[192:193] op_sel:[1,1,0] op_sel_hi:[0,1,1] neg_lo:[0,1,0]
    v_cvt_pk_bf16_f32 v202, v192, v193
    v_pk_mul_f32 v[194:195], v[192:193], v[188:189] op_sel:[0,0] op_sel_hi:[1,0]
    v_pk_fma_f32 v[194:195], v[192:193], v[188:189], v[194:195] op_sel:[1,1,0] op_sel_hi:[0,1,1] neg_lo:[0,1,0]
    v_cvt_pk_bf16_f32 v203, v194, v195
    ds_write_addtid_b32 v200 offset:6528
    ds_write_addtid_b32 v201 offset:6800
    ds_write_addtid_b32 v202 offset:7072
    ds_write_addtid_b32 v203 offset:7344
    .p2align 3
    v_pk_mul_f32 v[192:193], v[194:195], v[188:189] op_sel:[0,0] op_sel_hi:[1,0]
    v_pk_fma_f32 v[192:193], v[194:195], v[188:189], v[192:193] op_sel:[1,1,0] op_sel_hi:[0,1,1] neg_lo:[0,1,0]
    v_cvt_pk_bf16_f32 v204, v192, v193
    v_pk_mul_f32 v[194:195], v[192:193], v[188:189] op_sel:[0,0] op_sel_hi:[1,0]
    v_pk_fma_f32 v[194:195], v[192:193], v[188:189], v[194:195] op_sel:[1,1,0] op_sel_hi:[0,1,1] neg_lo:[0,1,0]
    v_cvt_pk_bf16_f32 v205, v194, v195
    v_pk_mul_f32 v[192:193], v[194:195], v[188:189] op_sel:[0,0] op_sel_hi:[1,0]
    v_pk_fma_f32 v[192:193], v[194:195], v[188:189], v[192:193] op_sel:[1,1,0] op_sel_hi:[0,1,1] neg_lo:[0,1,0]
    v_cvt_pk_bf16_f32 v206, v192, v193
    v_pk_mul_f32 v[194:195], v[192:193], v[188:189] op_sel:[0,0] op_sel_hi:[1,0]
    v_pk_fma_f32 v[194:195], v[192:193], v[188:189], v[194:195] op_sel:[1,1,0] op_sel_hi:[0,1,1] neg_lo:[0,1,0]
    v_cvt_pk_bf16_f32 v207, v194, v195
    s_add_u32 m0, s12, 131072
    s_mul_i32 s13, s5, 56
    buffer_load_dwordx4 v12, s[48:51], s13 offen  lds
    s_add_u32 s13, s13, 27648
    buffer_load_dwordx4 v12, s[48:51], s13 offen offset:1024  lds
    s_mov_b32 m0, s38
    s_nop 0
    ds_write_addtid_b32 v204 offset:7616
    ds_write_addtid_b32 v205 offset:7888
    ds_write_addtid_b32 v206 offset:8160
    ds_write_addtid_b32 v207 offset:8432
    .p2align 3
    v_pk_mul_f32 v[194:195], v[180:181], v[182:183] op_sel:[0,0] op_sel_hi:[1,0]
    v_pk_fma_f32 v[194:195], v[180:181], v[182:183], v[194:195] op_sel:[1,1,0] op_sel_hi:[0,1,1] neg_lo:[0,1,0]
    v_cvt_pk_bf16_f32 v200, v194, -v195
    v_pk_mul_f32 v[192:193], v[194:195], v[182:183] op_sel:[0,0] op_sel_hi:[1,0]
    v_pk_fma_f32 v[192:193], v[194:195], v[182:183], v[192:193] op_sel:[1,1,0] op_sel_hi:[0,1,1] neg_lo:[0,1,0]
    v_cvt_pk_bf16_f32 v201, v192, -v193
    v_pk_mul_f32 v[194:195], v[192:193], v[182:183] op_sel:[0,0] op_sel_hi:[1,0]
    v_pk_fma_f32 v[194:195], v[192:193], v[182:183], v[194:195] op_sel:[1,1,0] op_sel_hi:[0,1,1] neg_lo:[0,1,0]
    v_cvt_pk_bf16_f32 v202, v194, -v195
    v_pk_mul_f32 v[192:193], v[194:195], v[182:183] op_sel:[0,0] op_sel_hi:[1,0]
    v_pk_fma_f32 v[192:193], v[194:195], v[182:183], v[192:193] op_sel:[1,1,0] op_sel_hi:[0,1,1] neg_lo:[0,1,0]
    v_cvt_pk_bf16_f32 v203, v192, -v193
    ds_read_b128 v[142:145], v105 offset:0
    ds_read_b128 v[146:149], v105 offset:32
    ds_write_addtid_b32 v200 offset:8976
    ds_write_addtid_b32 v201 offset:9248
    ds_write_addtid_b32 v202 offset:9520
    ds_write_addtid_b32 v203 offset:9792
    .p2align 3
    v_pk_mul_f32 v[194:195], v[192:193], v[182:183] op_sel:[0,0] op_sel_hi:[1,0]
    v_pk_fma_f32 v[194:195], v[192:193], v[182:183], v[194:195] op_sel:[1,1,0] op_sel_hi:[0,1,1] neg_lo:[0,1,0]
    v_cvt_pk_bf16_f32 v204, v194, -v195
    v_pk_mul_f32 v[192:193], v[194:195], v[182:183] op_sel:[0,0] op_sel_hi:[1,0]
    v_pk_fma_f32 v[192:193], v[194:195], v[182:183], v[192:193] op_sel:[1,1,0] op_sel_hi:[0,1,1] neg_lo:[0,1,0]
    v_cvt_pk_bf16_f32 v205, v192, -v193
    v_pk_mul_f32 v[194:195], v[192:193], v[182:183] op_sel:[0,0] op_sel_hi:[1,0]
    v_pk_fma_f32 v[194:195], v[192:193], v[182:183], v[194:195] op_sel:[1,1,0] op_sel_hi:[0,1,1] neg_lo:[0,1,0]
    v_cvt_pk_bf16_f32 v206, v194, -v195
    v_pk_mul_f32 v[198:199], v[180:181], v[190:191] op_sel:[0,0] op_sel_hi:[1,0]
    v_pk_fma_f32 v[198:199], v[180:181], v[190:191], v[198:199] op_sel:[1,1,0] op_sel_hi:[0,1,1] neg_lo:[0,1,0]
    v_cvt_pk_bf16_f32 v207, v198, -v199
    s_add_u32 m0, s12, 133120
    s_add_u32 s13, s13, 29696
    buffer_load_dwordx4 v12, s[48:51], s13 offen  lds
    s_add_u32 s13, s13, 27648
    buffer_load_dwordx4 v12, s[48:51], s13 offen offset:1024  lds
    s_mov_b32 m0, s38
    ds_read_b128 v[150:153], v105 offset:64
    ds_write_addtid_b32 v204 offset:10064
    ds_write_addtid_b32 v205 offset:10336
    ds_write_addtid_b32 v206 offset:10608
    ds_write_addtid_b32 v207 offset:10880
    .p2align 3
    v_pk_mul_f32 v[194:195], v[198:199], v[184:185] op_sel:[0,0] op_sel_hi:[1,0]
    v_pk_fma_f32 v[194:195], v[198:199], v[184:185], v[194:195] op_sel:[1,1,0] op_sel_hi:[0,1,1] neg_lo:[0,1,0]
    v_cvt_pk_bf16_f32 v200, v194, -v195
    v_pk_mul_f32 v[192:193], v[194:195], v[184:185] op_sel:[0,0] op_sel_hi:[1,0]
    v_pk_fma_f32 v[192:193], v[194:195], v[184:185], v[192:193] op_sel:[1,1,0] op_sel_hi:[0,1,1] neg_lo:[0,1,0]
    v_cvt_pk_bf16_f32 v201, v192, -v193
    v_pk_mul_f32 v[194:195], v[192:193], v[184:185] op_sel:[0,0] op_sel_hi:[1,0]
    v_pk_fma_f32 v[194:195], v[192:193], v[184:185], v[194:195] op_sel:[1,1,0] op_sel_hi:[0,1,1] neg_lo:[0,1,0]
    v_cvt_pk_bf16_f32 v202, v194, -v195
    v_pk_mul_f32 v[192:193], v[194:195], v[184:185] op_sel:[0,0] op_sel_hi:[1,0]
    v_pk_fma_f32 v[192:193], v[194:195], v[184:185], v[192:193] op_sel:[1,1,0] op_sel_hi:[0,1,1] neg_lo:[0,1,0]
    v_cvt_pk_bf16_f32 v203, v192, -v193
    ds_read_b128 v[154:157], v105 offset:96
    ds_write_addtid_b32 v200 offset:11152
    ds_write_addtid_b32 v201 offset:11968
    ds_write_addtid_b32 v201 offset:11424
    ds_write_addtid_b32 v202 offset:12240
    ds_write_addtid_b32 v203 offset:12512
    .p2align 3
    v_pk_mul_f32 v[196:197], v[198:199], v[190:191] op_sel:[0,0] op_sel_hi:[1,0]
    v_pk_fma_f32 v[196:197], v[198:199], v[190:191], v[196:197] op_sel:[1,1,0] op_sel_hi:[0,1,1] neg_lo:[0,1,0]
    v_cvt_pk_bf16_f32 v204, v196, -v197
    v_pk_mul_f32 v[194:195], v[196:197], v[186:187] op_sel:[0,0] op_sel_hi:[1,0]
    v_pk_fma_f32 v[194:195], v[196:197], v[186:187], v[194:195] op_sel:[1,1,0] op_sel_hi:[0,1,1] neg_lo:[0,1,0]
    v_cvt_pk_bf16_f32 v205, v194, -v195
    v_pk_mul_f32 v[192:193], v[194:195], v[186:187] op_sel:[0,0] op_sel_hi:[1,0]
    v_pk_fma_f32 v[192:193], v[194:195], v[186:187], v[192:193] op_sel:[1,1,0] op_sel_hi:[0,1,1] neg_lo:[0,1,0]
    v_cvt_pk_bf16_f32 v206, v192, -v193
    v_pk_mul_f32 v[198:199], v[196:197], v[190:191] op_sel:[0,0] op_sel_hi:[1,0]
    v_pk_fma_f32 v[198:199], v[196:197], v[190:191], v[198:199] op_sel:[1,1,0] op_sel_hi:[0,1,1] neg_lo:[0,1,0]
    v_cvt_pk_bf16_f32 v207, v198, -v199
    s_add_u32 m0, s12, 135168
L_padS0:
    s_cbranch_execz L_retS
    s_add_u32 s13, s13, 29696
    buffer_load_dwordx4 v12, s[48:51], s13 offen  lds
    s_add_u32 s13, s13, 27648
    buffer_load_dwordx4 v12, s[48:51], s13 offen offset:1024  lds
    s_mov_b32 m0, s38
    ds_read_b128 v[158:161], v105 offset:128
    ds_read_b128 v[162:165], v105 offset:160
    ds_write_addtid_b32 v204 offset:11696
    ds_write_addtid_b32 v205 offset:13056
    ds_write_addtid_b32 v206 offset:13328
    ds_write_addtid_b32 v207 offset:12784
    .p2align 3
    v_pk_mul_f32 v[194:195], v[198:199], v[186:187] op_sel:[0,0] op_sel_hi:[1,0]
    v_pk_fma_f32 v[194:195], v[198:199], v[186:187], v[194:195] op_sel:[1,1,0] op_sel_hi:[0,1,1] neg_lo:[0,1,0]
    v_cvt_pk_bf16_f32 v200, v194, -v195
    v_pk_mul_f32 v[192:193], v[194:195], v[186:187] op_sel:[0,0] op_sel_hi:[1,0]
    v_pk_fma_f32 v[192:193], v[194:195], v[186:187], v[192:193] op_sel:[1,1,0] op_sel_hi:[0,1,1] neg_lo:[0,1,0]
    v_cvt_pk_bf16_f32 v201, v192, -v193
    v_pk_mul_f32 v[196:197], v[198:199], v[190:191] op_sel:[0,0] op_sel_hi:[1,0]
    v_pk_fma_f32 v[196:197], v[198:199], v[190:191], v[196:197] op_sel:[1,1,0] op_sel_hi:[0,1,1] neg_lo:[0,1,0]
    v_cvt_pk_bf16_f32 v202, v196, -v197
    v_pk_mul_f32 v[194:195], v[196:197], v[188:189] op_sel:[0,0] op_sel_hi:[1,0]
    v_pk_fma_f32 v[194:195], v[196:197], v[188:189], v[194:195] op_sel:[1,1,0] op_sel_hi:[0,1,1] neg_lo:[0,1,0]
    v_cvt_pk_bf16_f32 v203, v194, -v195
    ds_read_b128 v[166:169], v105 offset:192
    ds_write_addtid_b32 v200 offset:14144
    ds_write_addtid_b32 v201 offset:14416
    ds_write_addtid_b32 v202 offset:13600
    ds_write_addtid_b32 v203 offset:13872
    .p2align 3
    v_pk_mul_f32 v[198:199], v[196:197], v[190:191] op_sel:[0,0] op_sel_hi:[1,0]
    v_pk_fma_f32 v[198:199], v[196:197], v[190:191], v[198:199] op_sel:[1,1,0] op_sel_hi:[0,1,1] neg_lo:[0,1,0]
    v_cvt_pk_bf16_f32 v204, v198, -v199
    v_pk_mul_f32 v[194:195], v[198:199], v[188:189] op_sel:[0,0] op_sel_hi:[1,0]
    v_pk_fma_f32 v[194:195], v[198:199], v[188:189], v[194:195] op_sel:[1,1,0] op_sel_hi:[0,1,1] neg_lo:[0,1,0]
    v_cvt_pk_bf16_f32 v205, v194, -v195
    v_pk_mul_f32 v[196:197], v[198:199], v[190:191] op_sel:[0,0] op_sel_hi:[1,0]
    v_pk_fma_f32 v[196:197], v[198:199], v[190:191], v[196:197] op_sel:[1,1,0] op_sel_hi:[0,1,1] neg_lo:[0,1,0]
    v_cvt_pk_bf16_f32 v206, v196, -v197
    v_pk_mul_f32 v[194:195], v[196:197], v[188:189] op_sel:[0,0] op_sel_hi:[1,0]
    v_pk_fma_f32 v[194:195], v[196:197], v[188:189], v[194:195] op_sel:[1,1,0] op_sel_hi:[0,1,1] neg_lo:[0,1,0]
    v_cvt_pk_bf16_f32 v207, v194, -v195
    ds_read_b128 v[170:173], v105 offset:224
    ds_write_addtid_b32 v204 offset:15232
    ds_write_addtid_b32 v205 offset:15504
    ds_write_addtid_b32 v206 offset:14688
    ds_write_addtid_b32 v207 offset:14960
    .p2align 3
    v_pk_mul_f32 v[198:199], v[196:197], v[190:191] op_sel:[0,0] op_sel_hi:[1,0]
    v_pk_fma_f32 v[198:199], v[196:197], v[190:191], v[198:199] op_sel:[1,1,0] op_sel_hi:[0,1,1] neg_lo:[0,1,0]
    v_cvt_pk_bf16_f32 v200, v198, -v199
    v_pk_mul_f32 v[194:195], v[198:199], v[188:189] op_sel:[0,0] op_sel_hi:[1,0]
    v_pk_fma_f32 v[194:195], v[198:199], v[188:189], v[194:195] op_sel:[1,1,0] op_sel_hi:[0,1,1] neg_lo:[0,1,0]
    v_cvt_pk_bf16_f32 v201, v194, -v195
    ds_write_addtid_b32 v200 offset:15776
    ds_write_addtid_b32 v201 offset:16048
    ds_read_b128 v[110:113], v104 offset:0
    ds_read_b128 v[114:117], v104 offset:32
    ds_read_b128 v[118:121], v104 offset:64
    ds_read_b128 v[122:125], v104 offset:96
    ds_read_b128 v[126:129], v104 offset:128
    ds_read_b128 v[130:133], v104 offset:160
    ds_read_b128 v[134:137], v104 offset:192
    ds_read_b128 v[138:141], v104 offset:224
    v_and_b32 v174, 0xffff0000, v66
    v_and_b32 v175, 0xffff0000, v67
    v_and_b32 v176, 0xffff0000, v68
    v_and_b32 v177, 0xffff0000, v69
    v_and_b32 v178, 0xffff0000, v70
    v_and_b32 v179, 0xffff0000, v71
    v_mul_f32 v174, v102, v174
    v_mul_f32 v175, v102, v175
    v_mul_f32 v174, 0x3fb8aa3b, v174
    v_mul_f32 v175, 0.15915494, v175
    s_waitcnt lgkmcnt(7)
    v_mfma_f32_32x32x16_bf16 v[72:87], v[110:113], v[142:145], 0
    v_mul_f32 v176, v102, v176
    v_mul_f32 v177, v102, v177
    v_mul_f32 v98, 0x41000000, v174
    v_mul_f32 v99, 0x41000000, v175
    s_waitcnt lgkmcnt(6)
    v_mfma_f32_32x32x16_bf16 v[72:87], v[114:117], v[146:149], v[72:87]
    v_exp_f32 v98, v98
    v_fract_f32 v99, v99
    v_cos_f32 v188, v99
    s_waitcnt lgkmcnt(5)
    v_mfma_f32_32x32x16_bf16 v[72:87], v[118:121], v[150:153], v[72:87]
    v_sin_f32 v189, v99
    v_mul_f32 v188, v188, v98
    s_waitcnt lgkmcnt(4)
    v_mfma_f32_32x32x16_bf16 v[72:87], v[122:125], v[154:157], v[72:87]
    v_mul_f32 v189, v189, v98
    v_exp_f32 v98, v174
    v_fract_f32 v99, v175
    s_waitcnt lgkmcnt(3)
    v_mfma_f32_32x32x16_bf16 v[72:87], v[126:129], v[158:161], v[72:87]
    v_cos_f32 v182, v99
    v_sin_f32 v183, v99
    s_waitcnt lgkmcnt(2)
    v_mfma_f32_32x32x16_bf16 v[72:87], v[130:133], v[162:165], v[72:87]
    v_mul_f32 v182, v182, v98
    v_mul_f32 v183, v183, v98
    v_mul_f32 v98, 0x43800000, v174
    v_mul_f32 v99, 0x43800000, v175
    s_waitcnt lgkmcnt(1)
    v_mfma_f32_32x32x16_bf16 v[72:87], v[134:137], v[166:169], v[72:87]
    v_exp_f32 v98, v98
    v_fract_f32 v99, v99
    v_cos_f32 v190, v99
    s_waitcnt lgkmcnt(0)
    v_mfma_f32_32x32x16_bf16 v[72:87], v[138:141], v[170:173], v[72:87]
    v_sin_f32 v191, v99
    v_mul_f32 v190, v190, v98
    v_mul_f32 v191, v191, v98
    .p2align 3
    v_pk_mul_f32 v[184:185], v[182:183], v[182:183] op_sel:[0,0] op_sel_hi:[1,0]
    v_pk_fma_f32 v[184:185], v[182:183], v[182:183], v[184:185] op_sel:[1,1,0] op_sel_hi:[0,1,1] neg_lo:[0,1,0]
    v_cvt_pk_bf16_f32 v200, v188, v189
    v_pk_mul_f32 v[180:181], v[178:179], v[176:177] op_sel:[0,0] op_sel_hi:[1,0]
    v_pk_fma_f32 v[180:181], v[178:179], v[176:177], v[180:181] op_sel:[1,1,0] op_sel_hi:[0,1,1] neg_lo:[0,1,0]
    v_pk_mul_f32 v[186:187], v[184:185], v[184:185] op_sel:[0,0] op_sel_hi:[1,0]
    v_pk_fma_f32 v[186:187], v[184:185], v[184:185], v[186:187] op_sel:[1,1,0] op_sel_hi:[0,1,1] neg_lo:[0,1,0]
    v_cvt_pk_bf16_f32 v201, v180, -v181
    v_pk_mul_f32 v[192:193], v[188:189], v[188:189] op_sel:[0,0] op_sel_hi:[1,0]
    v_pk_fma_f32 v[192:193], v[188:189], v[188:189], v[192:193] op_sel:[1,1,0] op_sel_hi:[0,1,1] neg_lo:[0,1,0]
    v_cvt_pk_bf16_f32 v202, v192, v193
    v_pk_mul_f32 v[194:195], v[192:193], v[188:189] op_sel:[0,0] op_sel_hi:[1,0]
    v_pk_fma_f32 v[194:195], v[192:193], v[188:189], v[194:195] op_sel:[1,1,0] op_sel_hi:[0,1,1] neg_lo:[0,1,0]
    v_cvt_pk_bf16_f32 v203, v194, v195
    s_add_u32 m0, s12, 137216
    s_add_u32 s13, s13, 29696
    buffer_load_dwordx4 v12, s[48:51], s13 offen  lds
    s_add_u32 s13, s13, 27648
    buffer_load_dwordx4 v12, s[48:51], s13 offen offset:1024  lds
    s_mov_b32 m0, s38
    s_nop 0
    ds_write_addtid_b32 v200 offset:272
    ds_write_addtid_b32 v201 offset:8704
    ds_write_addtid_b32 v202 offset:544
    ds_write_addtid_b32 v203 offset:816
    .p2align 3
    v_pk_mul_f32 v[192:193], v[194:195], v[188:189] op_sel:[0,0] op_sel_hi:[1,0]
    v_pk_fma_f32 v[192:193], v[194:195], v[188:189], v[192:193] op_sel:[1,1,0] op_sel_hi:[0,1,1] neg_lo:[0,1,0]
    v_cvt_pk_bf16_f32 v204, v192, v193
    v_pk_mul_f32 v[194:195], v[192:193], v[188:189] op_sel:[0,0] op_sel_hi:[1,0]
    v_pk_fma_f32 v[194:195], v[192:193], v[188:189], v[194:195] op_sel:[1,1,0] op_sel_hi:[0,1,1] neg_lo:[0,1,0]
    v_cvt_pk_bf16_f32 v205, v194, v195
    v_pk_mul_f32 v[192:193], v[194:195], v[188:189] op_sel:[0,0] op_sel_hi:[1,0]
    v_pk_fma_f32 v[192:193], v[194:195], v[188:189], v[192:193] op_sel:[1,1,0] op_sel_hi:[0,1,1] neg_lo:[0,1,0]
    v_cvt_pk_bf16_f32 v206, v192, v193
    v_pk_mul_f32 v[194:195], v[192:193], v[188:189] op_sel:[0,0] op_sel_hi:[1,0]
    v_pk_fma_f32 v[194:195], v[192:193], v[188:189], v[194:195] op_sel:[1,1,0] op_sel_hi:[0,1,1] neg_lo:[0,1,0]
    v_cvt_pk_bf16_f32 v207, v194, v195
    ds_write_addtid_b32 v204 offset:1088
    ds_write_addtid_b32 v205 offset:1360
    ds_write_addtid_b32 v206 offset:1632
    ds_write_addtid_b32 v207 offset:1904
    .p2align 3
    v_pk_mul_f32 v[192:193], v[194:195], v[188:189] op_sel:[0,0] op_sel_hi:[1,0]
    v_pk_fma_f32 v[192:193], v[194:195], v[188:189], v[192:193] op_sel:[1,1,0] op_sel_hi:[0,1,1] neg_lo:[0,1,0]
    v_cvt_pk_bf16_f32 v200, v192, v193
    v_pk_mul_f32 v[194:195], v[192:193], v[188:189] op_sel:[0,0] op_sel_hi:[1,0]
    v_pk_fma_f32 v[194:195], v[192:193], v[188:189], v[194:195] op_sel:[1,1,0] op_sel_hi:[0,1,1] neg_lo:[0,1,0]
    v_cvt_pk_bf16_f32 v201, v194, v195
    v_pk_mul_f32 v[192:193], v[194:195], v[188:189] op_sel:[0,0] op_sel_hi:[1,0]
    v_pk_fma_f32 v[192:193], v[194:195], v[188:189], v[192:193] op_sel:[1,1,0] op_sel_hi:[0,1,1] neg_lo:[0,1,0]
    v_cvt_pk_bf16_f32 v202, v192, v193
    v_pk_mul_f32 v[194:195], v[192:193], v[188:189] op_sel:[0,0] op_sel_hi:[1,0]
    v_pk_fma_f32 v[194:195], v[192:193], v[188:189], v[194:195] op_sel:[1,1,0] op_sel_hi:[0,1,1] neg_lo:[0,1,0]
    v_cvt_pk_bf16_f32 v203, v194, v195
    ds_write_addtid_b32 v200 offset:2176
    ds_write_addtid_b32 v201 offset:2448
    ds_write_addtid_b32 v202 offset:2720
    ds_write_addtid_b32 v203 offset:2992
    .p2align 3
    v_pk_mul_f32 v[192:193], v[194:195], v[188:189] op_sel:[0,0] op_sel_hi:[1,0]
    v_pk_fma_f32 v[192:193], v[194:195], v[188:189], v[192:193] op_sel:[1,1,0] op_sel_hi:[0,1,1] neg_lo:[0,1,0]
    v_cvt_pk_bf16_f32 v204, v192, v193
    v_pk_mul_f32 v[194:195], v[192:193], v[188:189] op_sel:[0,0] op_sel_hi:[1,0]
    v_pk_fma_f32 v[194:195], v[192:193], v[188:189], v[194:195] op_sel:[1,1,0] op_sel_hi:[0,1,1] neg_lo:[0,1,0]
    v_cvt_pk_bf16_f32 v205, v194, v195
    v_pk_mul_f32 v[192:193], v[194:195], v[188:189] op_sel:[0,0] op_sel_hi:[1,0]
    v_pk_fma_f32 v[192:193], v[194:195], v[188:189], v[192:193] op_sel:[1,1,0] op_sel_hi:[0,1,1] neg_lo:[0,1,0]
    v_cvt_pk_bf16_f32 v206, v192, v193
    v_pk_mul_f32 v[194:195], v[192:193], v[188:189] op_sel:[0,0] op_sel_hi:[1,0]
    v_pk_fma_f32 v[194:195], v[192:193], v[188:189], v[194:195] op_sel:[1,1,0] op_sel_hi:[0,1,1] neg_lo:[0,1,0]
    v_cvt_pk_bf16_f32 v207, v194, v195
    ds_write_addtid_b32 v204 offset:3264
    ds_write_addtid_b32 v205 offset:3536
    ds_write_addtid_b32 v206 offset:3808
    ds_write_addtid_b32 v207 offset:4080
    .p2align 3
    v_pk_mul_f32 v[192:193], v[194:195], v[188:189] op_sel:[0,0] op_sel_hi:[1,0]
    v_pk_fma_f32 v[192:193], v[194:195], v[188:189], v[192:193] op_sel:[1,1,0] op_sel_hi:[0,1,1] neg_lo:[0,1,0]
    v_cvt_pk_bf16_f32 v200, v192, v193
    v_pk_mul_f32 v[194:195], v[192:193], v[188:189] op_sel:[0,0] op_sel_hi:[1,0]
    v_pk_fma_f32 v[194:195], v[192:193], v[188:189], v[194:195] op_sel:[1,1,0] op_sel_hi:[0,1,1] neg_lo:[0,1,0]
    v_cvt_pk_bf16_f32 v201, v194, v195
    v_pk_mul_f32 v[192:193], v[194:195], v[188:189] op_sel:[0,0] op_sel_hi:[1,0]
    v_pk_fma_f32 v[192:193], v[194:195], v[188:189], v[192:193] op_sel:[1,1,0] op_sel_hi:[0,1,1] neg_lo:[0,1,0]
    v_cvt_pk_bf16_f32 v202, v192, v193
    v_pk_mul_f32 v[194:195], v[192:193], v[188:189] op_sel:[0,0] op_sel_hi:[1,0]
    v_pk_fma_f32 v[194:195], v[192:193], v[188:189], v[194:195] op_sel:[1,1,0] op_sel_hi:[0,1,1] neg_lo:[0,1,0]
    v_cvt_pk_bf16_f32 v203, v194, v195
    buffer_load_dword v54, v31, s[40:43], s79 offen
    ds_write_addtid_b32 v200 offset:4352
    ds_write_addtid_b32 v201 offset:4624
    ds_write_addtid_b32 v202 offset:4896
    ds_write_addtid_b32 v203 offset:5168
    .p2align 3
    v_pk_mul_f32 v[192:193], v[194:195], v[188:189] op_sel:[0,0] op_sel_hi:[1,0]
    v_pk_fma_f32 v[192:193], v[194:195], v[188:189], v[192:193] op_sel:[1,1,0] op_sel_hi:[0,1,1] neg_lo:[0,1,0]
    v_cvt_pk_bf16_f32 v204, v192, v193
    v_pk_mul_f32 v[194:195], v[192:193], v[188:189] op_sel:[0,0] op_sel_hi:[1,0]
    v_pk_fma_f32 v[194:195], v[192:193], v[188:189], v[194:195] op_sel:[1,1,0] op_sel_hi:[0,1,1] neg_lo:[0,1,0]
    v_cvt_pk_bf16_f32 v205, v194, v195
    v_pk_mul_f32 v[192:193], v[194:195], v[188:189] op_sel:[0,0] op_sel_hi:[1,0]
    v_pk_fma_f32 v[192:193], v[194:195], v[188:189], v[192:193] op_sel:[1,1,0] op_sel_hi:[0,1,1] neg_lo:[0,1,0]
    v_cvt_pk_bf16_f32 v206, v192, v193
    v_pk_mul_f32 v[194:195], v[192:193], v[188:189] op_sel:[0,0] op_sel_hi:[1,0]
    v_pk_fma_f32 v[194:195], v[192:193], v[188:189], v[194:195] op_sel:[1,1,0] op_sel_hi:[0,1,1] neg_lo:[0,1,0]
    v_cvt_pk_bf16_f32 v207, v194, v195
    ds_write_addtid_b32 v204 offset:5440
    ds_write_addtid_b32 v205 offset:5712
    ds_write_addtid_b32 v206 offset:5984
    ds_write_addtid_b32 v207 offset:6256
    .p2align 3
    v_pk_mul_f32 v[192:193], v[194:195], v[188:189] op_sel:[0,0] op_sel_hi:[1,0]
    v_pk_fma_f32 v[192:193], v[194:195], v[188:189], v[192:193] op_sel:[1,1,0] op_sel_hi:[0,1,1] neg_lo:[0,1,0]
    v_cvt_pk_bf16_f32 v200, v192, v193
    v_pk_mul_f32 v[194:195], v[192:193], v[188:189] op_sel:[0,0] op_sel_hi:[1,0]
    v_pk_fma_f32 v[194:195], v[192:193], v[188:189], v[194:195] op_sel:[1,1,0] op_sel_hi:[0,1,1] neg_lo:[0,1,0]
    v_cvt_pk_bf16_f32 v201, v194, v195
    v_pk_mul_f32 v[192:193], v[194:195], v[188:189] op_sel:[0,0] op_sel_hi:[1,0]
    v_pk_fma_f32 v[192:193], v[194:195], v[188:189], v[192:193] op_sel:[1,1,0] op_sel_hi:[0,1,1] neg_lo:[0,1,0]
    v_cvt_pk_bf16_f32 v202, v192, v193
    v_pk_mul_f32 v[194:195], v[192:193], v[188:189] op_sel:[0,0] op_sel_hi:[1,0]
    v_pk_fma_f32 v[194:195], v[192:193], v[188:189], v[194:195] op_sel:[1,1,0] op_sel_hi:[0,1,1] neg_lo:[0,1,0]
    v_cvt_pk_bf16_f32 v203, v194, v195
    ds_write_addtid_b32 v200 offset:6528
    ds_write_addtid_b32 v201 offset:6800
    ds_write_addtid_b32 v202 offset:7072
    ds_write_addtid_b32 v203 offset:7344
    .p2align 3
    v_pk_mul_f32 v[192:193], v[194:195], v[188:189] op_sel:[0,0] op_sel_hi:[1,0]
    v_pk_fma_f32 v[192:193], v[194:195], v[188:189], v[192:193] op_sel:[1,1,0] op_sel_hi:[0,1,1] neg_lo:[0,1,0]
    v_cvt_pk_bf16_f32 v204, v192, v193
    v_pk_mul_f32 v[194:195], v[192:193], v[188:189] op_sel:[0,0] op_sel_hi:[1,0]
    v_pk_fma_f32 v[194:195], v[192:193], v[188:189], v[194:195] op_sel:[1,1,0] op_sel_hi:[0,1,1] neg_lo:[0,1,0]
    v_cvt_pk_bf16_f32 v205, v194, v195
    v_pk_mul_f32 v[192:193], v[194:195], v[188:189] op_sel:[0,0] op_sel_hi:[1,0]
    v_pk_fma_f32 v[192:193], v[194:195], v[188:189], v[192:193] op_sel:[1,1,0] op_sel_hi:[0,1,1] neg_lo:[0,1,0]
    v_cvt_pk_bf16_f32 v206, v192, v193
    v_pk_mul_f32 v[194:195], v[192:193], v[188:189] op_sel:[0,0] op_sel_hi:[1,0]
    v_pk_fma_f32 v[194:195], v[192:193], v[188:189], v[194:195] op_sel:[1,1,0] op_sel_hi:[0,1,1] neg_lo:[0,1,0]
    v_cvt_pk_bf16_f32 v207, v194, v195
    ds_write_addtid_b32 v204 offset:7616
    ds_write_addtid_b32 v205 offset:7888
    ds_write_addtid_b32 v206 offset:8160
    ds_write_addtid_b32 v207 offset:8432
    .p2align 3
    v_pk_mul_f32 v[194:195], v[180:181], v[182:183] op_sel:[0,0] op_sel_hi:[1,0]
    v_pk_fma_f32 v[194:195], v[180:181], v[182:183], v[194:195] op_sel:[1,1,0] op_sel_hi:[0,1,1] neg_lo:[0,1,0]
    v_cvt_pk_bf16_f32 v200, v194, -v195
    v_pk_mul_f32 v[192:193], v[194:195], v[182:183] op_sel:[0,0] op_sel_hi:[1,0]
    v_pk_fma_f32 v[192:193], v[194:195], v[182:183], v[192:193] op_sel:[1,1,0] op_sel_hi:[0,1,1] neg_lo:[0,1,0]
    v_cvt_pk_bf16_f32 v201, v192, -v193
    v_pk_mul_f32 v[194:195], v[192:193], v[182:183] op_sel:[0,0] op_sel_hi:[1,0]
    v_pk_fma_f32 v[194:195], v[192:193], v[182:183], v[194:195] op_sel:[1,1,0] op_sel_hi:[0,1,1] neg_lo:[0,1,0]
    v_cvt_pk_bf16_f32 v202, v194, -v195
    v_pk_mul_f32 v[192:193], v[194:195], v[182:183] op_sel:[0,0] op_sel_hi:[1,0]
    v_pk_fma_f32 v[192:193], v[194:195], v[182:183], v[192:193] op_sel:[1,1,0] op_sel_hi:[0,1,1] neg_lo:[0,1,0]
    v_cvt_pk_bf16_f32 v203, v192, -v193
    ds_read_b128 v[142:145], v105 offset:0
    ds_read_b128 v[146:149], v105 offset:32
    ds_write_addtid_b32 v200 offset:8976
    ds_write_addtid_b32 v201 offset:9248
    ds_write_addtid_b32 v202 offset:9520
    ds_write_addtid_b32 v203 offset:9792
    .p2align 3
    v_pk_mul_f32 v[194:195], v[192:193], v[182:183] op_sel:[0,0] op_sel_hi:[1,0]
    v_pk_fma_f32 v[194:195], v[192:193], v[182:183], v[194:195] op_sel:[1,1,0] op_sel_hi:[0,1,1] neg_lo:[0,1,0]
    v_cvt_pk_bf16_f32 v204, v194, -v195
    v_pk_mul_f32 v[192:193], v[194:195], v[182:183] op_sel:[0,0] op_sel_hi:[1,0]
    v_pk_fma_f32 v[192:193], v[194:195], v[182:183], v[192:193] op_sel:[1,1,0] op_sel_hi:[0,1,1] neg_lo:[0,1,0]
    v_cvt_pk_bf16_f32 v205, v192, -v193
    v_pk_mul_f32 v[194:195], v[192:193], v[182:183] op_sel:[0,0] op_sel_hi:[1,0]
    v_pk_fma_f32 v[194:195], v[192:193], v[182:183], v[194:195] op_sel:[1,1,0] op_sel_hi:[0,1,1] neg_lo:[0,1,0]
    v_cvt_pk_bf16_f32 v206, v194, -v195
    v_pk_mul_f32 v[198:199], v[180:181], v[190:191] op_sel:[0,0] op_sel_hi:[1,0]
    v_pk_fma_f32 v[198:199], v[180:181], v[190:191], v[198:199] op_sel:[1,1,0] op_sel_hi:[0,1,1] neg_lo:[0,1,0]
    v_cvt_pk_bf16_f32 v207, v198, -v199
    buffer_load_dword v55, v31, s[40:43], s79 offen offset:896
    s_add_u32 s79, s79, 114688
    ds_read_b128 v[150:153], v105 offset:64
    ds_write_addtid_b32 v204 offset:10064
    ds_write_addtid_b32 v205 offset:10336
    ds_write_addtid_b32 v206 offset:10608
    ds_write_addtid_b32 v207 offset:10880
    .p2align 3
    v_pk_mul_f32 v[194:195], v[198:199], v[184:185] op_sel:[0,0] op_sel_hi:[1,0]
    v_pk_fma_f32 v[194:195], v[198:199], v[184:185], v[194:195] op_sel:[1,1,0] op_sel_hi:[0,1,1] neg_lo:[0,1,0]
    v_cvt_pk_bf16_f32 v200, v194, -v195
    v_pk_mul_f32 v[192:193], v[194:195], v[184:185] op_sel:[0,0] op_sel_hi:[1,0]
    v_pk_fma_f32 v[192:193], v[194:195], v[184:185], v[192:193] op_sel:[1,1,0] op_sel_hi:[0,1,1] neg_lo:[0,1,0]
    v_cvt_pk_bf16_f32 v201, v192, -v193
    v_pk_mul_f32 v[194:195], v[192:193], v[184:185] op_sel:[0,0] op_sel_hi:[1,0]
    v_pk_fma_f32 v[194:195], v[192:193], v[184:185], v[194:195] op_sel:[1,1,0] op_sel_hi:[0,1,1] neg_lo:[0,1,0]
    v_cvt_pk_bf16_f32 v202, v194, -v195
    v_pk_mul_f32 v[192:193], v[194:195], v[184:185] op_sel:[0,0] op_sel_hi:[1,0]
    v_pk_fma_f32 v[192:193], v[194:195], v[184:185], v[192:193] op_sel:[1,1,0] op_sel_hi:[0,1,1] neg_lo:[0,1,0]
    v_cvt_pk_bf16_f32 v203, v192, -v193
    ds_read_b128 v[154:157], v105 offset:96
    ds_write_addtid_b32 v200 offset:11152
    ds_write_addtid_b32 v201 offset:11968
    ds_write_addtid_b32 v201 offset:11424
    ds_write_addtid_b32 v202 offset:12240
    ds_write_addtid_b32 v203 offset:12512
    .p2align 3
    v_pk_mul_f32 v[196:197], v[198:199], v[190:191] op_sel:[0,0] op_sel_hi:[1,0]
    v_pk_fma_f32 v[196:197], v[198:199], v[190:191], v[196:197] op_sel:[1,1,0] op_sel_hi:[0,1,1] neg_lo:[0,1,0]
    v_cvt_pk_bf16_f32 v204, v196, -v197
    v_pk_mul_f32 v[194:195], v[196:197], v[186:187] op_sel:[0,0] op_sel_hi:[1,0]
    v_pk_fma_f32 v[194:195], v[196:197], v[186:187], v[194:195] op_sel:[1,1,0] op_sel_hi:[0,1,1] neg_lo:[0,1,0]
    v_cvt_pk_bf16_f32 v205, v194, -v195
    v_pk_mul_f32 v[192:193], v[194:195], v[186:187] op_sel:[0,0] op_sel_hi:[1,0]
    v_pk_fma_f32 v[192:193], v[194:195], v[186:187], v[192:193] op_sel:[1,1,0] op_sel_hi:[0,1,1] neg_lo:[0,1,0]
    v_cvt_pk_bf16_f32 v206, v192, -v193
    v_pk_mul_f32 v[198:199], v[196:197], v[190:191] op_sel:[0,0] op_sel_hi:[1,0]
    v_pk_fma_f32 v[198:199], v[196:197], v[190:191], v[198:199] op_sel:[1,1,0] op_sel_hi:[0,1,1] neg_lo:[0,1,0]
    v_cvt_pk_bf16_f32 v207, v198, -v199
    ds_read_b128 v[158:161], v105 offset:128
    ds_read_b128 v[162:165], v105 offset:160
    ds_write_addtid_b32 v204 offset:11696
    ds_write_addtid_b32 v205 offset:13056
    ds_write_addtid_b32 v206 offset:13328
    ds_write_addtid_b32 v207 offset:12784
    .p2align 3
    v_pk_mul_f32 v[194:195], v[198:199], v[186:187] op_sel:[0,0] op_sel_hi:[1,0]
    v_pk_fma_f32 v[194:195], v[198:199], v[186:187], v[194:195] op_sel:[1,1,0] op_sel_hi:[0,1,1] neg_lo:[0,1,0]
    v_cvt_pk_bf16_f32 v200, v194, -v195
    v_pk_mul_f32 v[192:193], v[194:195], v[186:187] op_sel:[0,0] op_sel_hi:[1,0]
    v_pk_fma_f32 v[192:193], v[194:195], v[186:187], v[192:193] op_sel:[1,1,0] op_sel_hi:[0,1,1] neg_lo:[0,1,0]
    v_cvt_pk_bf16_f32 v201, v192, -v193
    v_pk_mul_f32 v[196:197], v[198:199], v[190:191] op_sel:[0,0] op_sel_hi:[1,0]
    v_pk_fma_f32 v[196:197], v[198:199], v[190:191], v[196:197] op_sel:[1,1,0] op_sel_hi:[0,1,1] neg_lo:[0,1,0]
    v_cvt_pk_bf16_f32 v202, v196, -v197
    v_pk_mul_f32 v[194:195], v[196:197], v[188:189] op_sel:[0,0] op_sel_hi:[1,0]
    v_pk_fma_f32 v[194:195], v[196:197], v[188:189], v[194:195] op_sel:[1,1,0] op_sel_hi:[0,1,1] neg_lo:[0,1,0]
    v_cvt_pk_bf16_f32 v203, v194, -v195
    ds_read_b128 v[166:169], v105 offset:192
    ds_write_addtid_b32 v200 offset:14144
    ds_write_addtid_b32 v201 offset:14416
    ds_write_addtid_b32 v202 offset:13600
    ds_write_addtid_b32 v203 offset:13872
    .p2align 3
    v_pk_mul_f32 v[198:199], v[196:197], v[190:191] op_sel:[0,0] op_sel_hi:[1,0]
    v_pk_fma_f32 v[198:199], v[196:197], v[190:191], v[198:199] op_sel:[1,1,0] op_sel_hi:[0,1,1] neg_lo:[0,1,0]
    v_cvt_pk_bf16_f32 v204, v198, -v199
    v_pk_mul_f32 v[194:195], v[198:199], v[188:189] op_sel:[0,0] op_sel_hi:[1,0]
    v_pk_fma_f32 v[194:195], v[198:199], v[188:189], v[194:195] op_sel:[1,1,0] op_sel_hi:[0,1,1] neg_lo:[0,1,0]
    v_cvt_pk_bf16_f32 v205, v194, -v195
    v_pk_mul_f32 v[196:197], v[198:199], v[190:191] op_sel:[0,0] op_sel_hi:[1,0]
    v_pk_fma_f32 v[196:197], v[198:199], v[190:191], v[196:197] op_sel:[1,1,0] op_sel_hi:[0,1,1] neg_lo:[0,1,0]
    v_cvt_pk_bf16_f32 v206, v196, -v197
    v_pk_mul_f32 v[194:195], v[196:197], v[188:189] op_sel:[0,0] op_sel_hi:[1,0]
    v_pk_fma_f32 v[194:195], v[196:197], v[188:189], v[194:195] op_sel:[1,1,0] op_sel_hi:[0,1,1] neg_lo:[0,1,0]
    v_cvt_pk_bf16_f32 v207, v194, -v195
    ds_read_b128 v[170:173], v105 offset:224
    ds_write_addtid_b32 v204 offset:15232
    ds_write_addtid_b32 v205 offset:15504
    ds_write_addtid_b32 v206 offset:14688
    ds_write_addtid_b32 v207 offset:14960
    .p2align 3
    v_pk_mul_f32 v[198:199], v[196:197], v[190:191] op_sel:[0,0] op_sel_hi:[1,0]
    v_pk_fma_f32 v[198:199], v[196:197], v[190:191], v[198:199] op_sel:[1,1,0] op_sel_hi:[0,1,1] neg_lo:[0,1,0]
    v_cvt_pk_bf16_f32 v200, v198, -v199
    v_pk_mul_f32 v[194:195], v[198:199], v[188:189] op_sel:[0,0] op_sel_hi:[1,0]
    v_pk_fma_f32 v[194:195], v[198:199], v[188:189], v[194:195] op_sel:[1,1,0] op_sel_hi:[0,1,1] neg_lo:[0,1,0]
    v_cvt_pk_bf16_f32 v201, v194, -v195
    ds_write_addtid_b32 v200 offset:15776
    ds_write_addtid_b32 v201 offset:16048
    ds_read_b128 v[110:113], v104 offset:0
    ds_read_b128 v[114:117], v104 offset:32
    ds_read_b128 v[118:121], v104 offset:64
    ds_read_b128 v[122:125], v104 offset:96
    ds_read_b128 v[126:129], v104 offset:128
    ds_read_b128 v[130:133], v104 offset:160
    ds_read_b128 v[134:137], v104 offset:192
    ds_read_b128 v[138:141], v104 offset:224
    v_mov_b32 v200, 0
    v_mov_b32 v201, 0
    s_mul_i32 s74, s64, 3136
    s_add_u32 s74, s74, s68
    s_lshl_b32 s74, s74, 7
    v_and_b32 v98, 6, v96
    v_xor_b32 v98, v98, v97
    v_lshlrev_b32 v98, 4, v98
    v_mul_u32_u24 v6, 896, v96
    v_add3_u32 v6, v6, v98, s74
    s_lshr_b32 s76, s64, 1
    s_lshl_b32 s75, s23, 8
    s_mul_i32 s74, s76, 16640
    s_add_u32 s74, s74, s75
    s_add_u32 s74, s74, 65024
    s_add_u32 s75, s75, s39
    s_add_u32 s75, s75, 5024
    v_lshrrev_b32 v98, 4, v1
    v_bfe_u32 v99, v1, 2, 2
    v_add_u32 v99, v99, v98
    s_waitcnt lgkmcnt(7)
    v_mfma_f32_32x32x16_bf16 v[72:87], v[110:113], v[142:145], v[72:87]
    v_and_b32 v100, 3, v1
    v_mul_u32_u24 v174, 4160, v100
    v_lshl_add_u32 v21, v99, 4, v174
    v_add_u32 v21, s74, v21
    v_lshl_add_u32 v22, v98, 4, s75
    s_waitcnt lgkmcnt(6)
    v_mfma_f32_32x32x16_bf16 v[72:87], v[114:117], v[146:149], v[72:87]
    buffer_load_dword v56, v31, s[40:43], s79 offen
    v_lshlrev_b32 v99, 6, v97
    v_sub_u32 v22, v22, v99
    v_and_b32 v99, 1, v96
    s_waitcnt lgkmcnt(5)
    v_mfma_f32_32x32x16_bf16 v[72:87], v[118:121], v[150:153], v[72:87]
    buffer_load_dwordx4 v[32:35], v20, s[44:47], 0 offen sc1
    v_mul_u32_u24 v99, 4576, v99
    v_sub_u32 v22, v22, v99
    v_lshrrev_b32 v98, 4, v0
    s_waitcnt lgkmcnt(4)
    v_mfma_f32_32x32x16_bf16 v[72:87], v[122:125], v[154:157], v[72:87]
    s_mov_b32 s37, 4096
    v_and_b32 v99, 1, v96
    v_lshl_add_u32 v98, v98, 2, v99
    v_mul_u32_u24 v98, 28672, v98
    v_lshl_add_u32 v26, v97, 4, v98
    s_waitcnt lgkmcnt(3)
    v_mfma_f32_32x32x16_bf16 v[72:87], v[126:129], v[158:161], v[72:87]
    buffer_load_dwordx4 v[58:61], v52, s[44:47], s37 offen offset:0 sc1
    v_lshrrev_b32 v99, 1, v97
    v_lshl_add_u32 v98, v99, 4, v98
    v_and_b32 v99, 1, v97
    s_waitcnt lgkmcnt(2)
    v_mfma_f32_32x32x16_bf16 v[72:87], v[130:133], v[162:165], v[72:87]
    buffer_load_dwordx4 v[62:65], v52, s[44:47], s37 offen offset:1024 sc1
    v_lshl_add_u32 v25, v99, 6, v98
    v_xor_b32 v99, v97, v96
    v_lshl_add_u32 v99, v97, 3, v99
    s_waitcnt lgkmcnt(1)
    v_mfma_f32_32x32x16_bf16 v[72:87], v[134:137], v[166:169], v[72:87]
    s_lshl_b32 s74, s64, 12
    v_lshl_add_u32 v23, v99, 4, s74
    v_mul_u32_u24 v53, 4160, v96
    v_lshl_add_u32 v53, v97, 3, v53
    v_add_u32 v53, 65024, v53
    s_waitcnt lgkmcnt(0)
    v_mfma_f32_32x32x16_bf16 v[72:87], v[138:141], v[170:173], v[72:87]
    v_lshrrev_b32 v29, 1, v52
    v_add_u32 v29, 52096, v29
    s_lshl_b32 s60, s64, 9
    s_add_u32 s60, s60, 65024
    s_add_u32 s75, s60, 512
    s_add_u32 s74, s60, 2
    v_mov_b32 v30, s75
    s_nop 0
    v_writelane_b32 v30, s74, 0
    v_lshlrev_b32 v27, 4, v0
    v_xor_b32 v98, v0, v96
    v_lshlrev_b32 v24, 4, v98
    s_lshl_b32 s36, s69, 8
    s_add_u32 s36, s36, 196608
    v_mov_b32 v4, s65
    s_mul_i32 s14, s64, 224
    s_add_u32 s14, s14, s66
    s_lshl_b32 s14, s14, 7
    s_add_u32 s14, s14, 786432
    s_mov_b32 s52, s28
    s_mov_b32 s53, s29
    s_mov_b32 s54, 1605632
    s_mov_b32 s55, 0x00020000
    s_cmp_lg_u32 s23, 0
    s_cbranch_scc1 L_expB
    ds_write_b128 v106, v[82:85]
    s_mov_b64 exec, 1
    v_add_f32 v72, s73, v72
    s_mov_b64 exec, -1
    s_mov_b32 s56, s34
    s_mov_b32 s57, s35
    s_mov_b32 s58, 1835008
    s_mov_b32 s59, 0x00020000
    v_lshrrev_b32 v99, 5, v1
    v_bfe_u32 v98, v1, 4, 1
    v_and_b32 v100, 3, v1
    v_lshlrev_b32 v100, 3, v100
    v_lshl_add_u32 v100, v98, 5, v100
    v_bfe_u32 v98, v1, 2, 2
    v_lshl_add_u32 v174, v99, 3, v98
    v_lshl_add_u32 v16, v174, 6, v100
    v_and_b32 v98, 8, v1
    v_lshl_add_u32 v100, v98, 3, v100
    v_bfe_u32 v175, v1, 2, 3
    v_lshl_add_u32 v99, v99, 4, v175
    s_waitcnt lgkmcnt(0)
    s_barrier
    ds_read_b128 v[176:179], v107 offset:13248
    ds_read_b128 v[180:183], v107 offset:14272
    ds_read_b128 v[184:187], v107 offset:15296
    v_lshrrev_b32 v175, 1, v175
    v_lshlrev_b32 v175, 5, v175
    v_lshl_add_u32 v175, v99, 7, v175
    v_and_b32 v99, 3, v1
    v_lshl_add_u32 v175, v99, 3, v175
    v_add_u32 v7, s12, v175
    v_xor_b32 v8, 65536, v7
    v_xor_b32 v9, 65568, v7
    v_xor_b32 v10, 65600, v7
    v_xor_b32 v11, 65632, v7
    s_lshr_b32 s74, s64, 1
    s_lshl_b32 s74, s74, 7
    s_add_u32 s74, s74, s23
    s_lshl_b32 s74, s74, 6
    v_lshl_add_u32 v13, v174, 7, v100
    v_xor_b32 v13, s74, v13
    v_add_u32 v17, 65536, v16
    v_add_u32 v14, 65536, v13
    v_add_u32 v18, 65536, v17
    v_add_u32 v15, 65536, v14
    s_waitcnt lgkmcnt(0)
    v_pk_add_f32 v[72:73], v[72:73], v[176:177]
    v_pk_add_f32 v[74:75], v[74:75], v[178:179]
    v_pk_add_f32 v[76:77], v[76:77], v[180:181]
    v_pk_add_f32 v[78:79], v[78:79], v[182:183]
    v_pk_add_f32 v[80:81], v[80:81], v[184:185]
    v_cvt_pk_bf16_f32 v192, v75, v74
    v_cvt_pk_bf16_f32 v193, v73, v72
    v_cvt_pk_bf16_f32 v194, v78, v77
    v_cvt_pk_bf16_f32 v195, v76, v76
    v_cvt_pk_bf16_f32 v196, v81, v81
    v_cvt_pk_bf16_f32 v197, v80, v80
    v_cvt_pk_bf16_f32 v198, v80, v79
    v_cvt_pk_bf16_f32 v199, v79, v79
    ds_write_b64 v108, v[192:193] offset:4088
    ds_write_b64 v108, v[194:195] offset:3576
    ds_write_b64 v109, v[196:197] offset:3056
    ds_write_b64 v109, v[198:199] offset:3064
    ds_write_b64 v108, v[192:193] offset:8656
    ds_write_b64 v108, v[194:195] offset:8144
    ds_write_b64 v109, v[196:197] offset:7624
    ds_write_b64 v109, v[198:199] offset:7632
    s_branch L_expD
L_expB:
    ds_write_b128 v106, v[72:75] offset:13248
    ds_write_b128 v106, v[76:79] offset:14272
    ds_write_b128 v106, v[80:83] offset:15296
    s_mov_b32 vcc_lo, 0xaaaaaaaa
    s_mov_b32 vcc_hi, 0xaaaaaaaa
    s_mov_b32 s56, s34
    s_mov_b32 s57, s35
    s_mov_b32 s58, 1835008
    s_mov_b32 s59, 0x00020000
    v_lshrrev_b32 v99, 5, v1
    v_bfe_u32 v98, v1, 4, 1
    v_and_b32 v100, 3, v1
    v_lshlrev_b32 v100, 3, v100
    v_lshl_add_u32 v100, v98, 5, v100
    v_bfe_u32 v98, v1, 2, 2
    v_lshl_add_u32 v174, v99, 3, v98
    v_lshl_add_u32 v16, v174, 6, v100
    v_and_b32 v98, 8, v1
    v_lshl_add_u32 v100, v98, 3, v100
    v_bfe_u32 v175, v1, 2, 3
    v_lshl_add_u32 v99, v99, 4, v175
    s_waitcnt lgkmcnt(0)
    s_barrier
    ds_read_b128 v[176:179], v107
    v_lshrrev_b32 v175, 1, v175
    v_lshlrev_b32 v175, 5, v175
    v_lshl_add_u32 v175, v99, 7, v175
    v_and_b32 v99, 3, v1
    v_lshl_add_u32 v175, v99, 3, v175
    v_add_u32 v7, s12, v175
    v_xor_b32 v8, 65536, v7
    v_xor_b32 v9, 65568, v7
    v_xor_b32 v10, 65600, v7
    v_xor_b32 v11, 65632, v7
    s_lshr_b32 s74, s64, 1
    s_lshl_b32 s74, s74, 7
    s_add_u32 s74, s74, s23
    s_lshl_b32 s74, s74, 6
    v_lshl_add_u32 v13, v174, 7, v100
    v_xor_b32 v13, s74, v13
L_padS1:
    s_cbranch_execz L_retS
    v_add_u32 v17, 65536, v16
    v_add_u32 v14, 65536, v13
    v_add_u32 v18, 65536, v17
    v_add_u32 v15, 65536, v14
    s_waitcnt lgkmcnt(0)
    v_pk_add_f32 v[82:83], v[82:83], v[176:177]
    v_pk_add_f32 v[84:85], v[84:85], v[178:179]
    v_cndmask_b32 v202, v82, v83, vcc
    v_cvt_pk_bf16_f32 v192, v83, v83
    v_cvt_pk_bf16_f32 v193, v83, v202
    v_cvt_pk_bf16_f32 v194, v82, v82
    v_cvt_pk_bf16_f32 v195, v82, v82
    v_cndmask_b32 v202, v84, v85, vcc
    v_cvt_pk_bf16_f32 v196, v85, v85
    v_cvt_pk_bf16_f32 v197, v85, v202
    v_cvt_pk_bf16_f32 v198, v84, v84
    v_cvt_pk_bf16_f32 v199, v84, v84
    ds_write_b64 v109, v[192:193] offset:2032
    ds_write_b64 v109, v[194:195] offset:2040
    ds_write_b64 v109, v[196:197] offset:1520
    ds_write_b64 v109, v[198:199] offset:1528
    ds_write_b64 v109, v[192:193] offset:6600
    ds_write_b64 v109, v[194:195] offset:6608
    ds_write_b64 v109, v[196:197] offset:6088
    ds_write_b64 v109, v[198:199] offset:6096
L_expD:
    s_mul_i32 s74, s23, 4568
    s_add_u32 m0, s74, s39
    s_nop 0
    ds_write_addtid_b32 v200 offset:4096
    ds_write_addtid_b32 v200 offset:4304
    s_mov_b32 s37, 12288
    buffer_load_dwordx4 v[44:47], v52, s[44:47], s37 offen offset:0 sc1
    buffer_load_dwordx4 v[48:51], v52, s[44:47], s37 offen offset:1024 sc1
    buffer_load_dword v57, v31, s[40:43], s79 offen offset:896
    s_add_u32 s79, s79, 802816
    s_waitcnt vmcnt(17)
    s_cmp_eq_u32 s64, 0
    s_barrier
    s_cbranch_scc0 L_nozero
    ds_write_b64 v53, v[200:201]
L_nozero:
    s_waitcnt vmcnt(5)
    v_cmpx_eq_u32 vcc, s65, v35
    s_nop 0
    s_cmp_eq_u64 exec, -1
    s_mov_b64 exec, -1
    s_cbranch_scc0 L_m1_re
L_m1_ok:
    s_nop 0
    v_add_f32_dpp v32, v32, v32 quad_perm:[1,0,3,2] row_mask:0xf bank_mask:0xf
    v_add_f32_dpp v33, v33, v33 quad_perm:[1,0,3,2] row_mask:0xf bank_mask:0xf
    v_cvt_pk_bf16_f32 v34, v32, v33
    v_lshlrev_b32 v32, 16, v34
    v_and_b32 v33, 0xffff0000, v34
    v_add_f32 v32, v32, v28
    v_add_f32 v33, v33, v28
    v_cvt_pk_bf16_f32 v34, v32, v33
    v_lshlrev_b32 v32, 16, v34
    v_and_b32 v33, 0xffff0000, v34
    v_and_b32 v66, 2, v1
    v_mul_u32_u24 v66, 3584, v66
    v_mov_b32_dpp v36, v32 quad_perm:[0,0,0,0] row_mask:0xf bank_mask:0xf
    v_mov_b32_dpp v38, v32 quad_perm:[2,2,2,2] row_mask:0xf bank_mask:0xf
    v_mov_b32_dpp v37, v33 quad_perm:[0,0,0,0] row_mask:0xf bank_mask:0xf
    v_mov_b32_dpp v39, v33 quad_perm:[2,2,2,2] row_mask:0xf bank_mask:0xf
    v_add_u32 v20, v20, v66
    v_add_u32 v20, 14336, v20
    s_waitcnt vmcnt(0)
    v_cmpx_eq_u32 vcc, s65, v61
    v_cmpx_eq_u32 vcc, s65, v65
    v_cmpx_eq_u32 vcc, s65, v47
    v_cmpx_eq_u32 vcc, s65, v51
    s_nop 0
    s_cmp_eq_u64 exec, -1
    s_mov_b64 exec, -1
    s_cbranch_scc0 L_h1_re
L_h1_ok:
    ds_write_b64 v29, v[54:55] offset:0
    ds_write_b64 v29, v[56:57] offset:512
    s_mov_b32 m0, s60
    v_lshlrev_b32 v74, 16, v54
    v_and_b32 v75, 0xffff0000, v54
    v_lshlrev_b32 v76, 16, v55
    v_and_b32 v77, 0xffff0000, v55
    v_lshlrev_b32 v78, 16, v58
    v_and_b32 v79, 0xffff0000, v58
    v_pk_fma_f32 v[74:75], v[74:75], v[58:59], v[78:79] op_sel:[0,1,0] op_sel_hi:[1,1,0]
    v_pk_fma_f32 v[76:77], v[76:77], v[60:61], v[78:79] op_sel:[0,0,1] op_sel_hi:[1,0,1]
    v_pk_fma_f32 v[74:75], v[74:75], v[38:39], v[36:37]
    v_pk_fma_f32 v[76:77], v[76:77], v[38:39], v[36:37]
    v_cvt_pk_bf16_f32 v66, v74, v76
    v_cvt_pk_bf16_f32 v67, v75, v77
    ds_write_addtid_b32 v66 offset:4212
    ds_write_addtid_b32 v66 offset:12528
    ds_write_addtid_b32 v67 offset:20852
    ds_write_addtid_b32 v67 offset:29168
    v_mov_b32_dpp v80, v66 wave_shr:1 row_mask:0xf bank_mask:0xf
    v_mov_b32_dpp v81, v67 wave_shr:1 row_mask:0xf bank_mask:0xf
    v_alignbit_b32 v70, v66, v80, 16
    v_alignbit_b32 v71, v67, v81, 16
    v_lshlrev_b32 v74, 16, v56
    v_and_b32 v75, 0xffff0000, v56
    v_lshlrev_b32 v76, 16, v57
    v_and_b32 v77, 0xffff0000, v57
    v_lshlrev_b32 v78, 16, v62
    v_and_b32 v79, 0xffff0000, v62
    v_pk_fma_f32 v[74:75], v[74:75], v[62:63], v[78:79] op_sel:[0,1,0] op_sel_hi:[1,1,0]
    v_pk_fma_f32 v[76:77], v[76:77], v[64:65], v[78:79] op_sel:[0,0,1] op_sel_hi:[1,0,1]
    v_pk_fma_f32 v[74:75], v[74:75], v[38:39], v[36:37]
    v_pk_fma_f32 v[76:77], v[76:77], v[38:39], v[36:37]
    v_mov_b32_dpp v80, v66 wave_ror:1 row_mask:0xf bank_mask:0xf
    v_mov_b32_dpp v81, v67 wave_ror:1 row_mask:0xf bank_mask:0xf
    v_cvt_pk_bf16_f32 v68, v74, v76
    v_cvt_pk_bf16_f32 v69, v75, v77
    s_mov_b64 exec, -2
    ds_write_addtid_b32 v70 offset:52
    ds_write_addtid_b32 v70 offset:8368
    ds_write_addtid_b32 v71 offset:16692
    ds_write_addtid_b32 v71 offset:25008
    s_mov_b64 exec, -1
    ds_write_addtid_b32 v68 offset:4468
    ds_write_addtid_b32 v68 offset:12784
    ds_write_addtid_b32 v69 offset:21108
    ds_write_addtid_b32 v69 offset:29424
    v_mov_b32_dpp v80, v68 wave_shr:1 row_mask:0xf bank_mask:0xf
    v_mov_b32_dpp v81, v69 wave_shr:1 row_mask:0xf bank_mask:0xf
    v_alignbit_b32 v72, v68, v80, 16
    v_alignbit_b32 v73, v69, v81, 16
    v_lshrrev_b32 v80, 16, v68
    v_lshrrev_b32 v81, 16, v69
    s_mov_b64 exec, 1
    v_mov_b32 v80, v66
    v_mov_b32 v81, v67
    s_mov_b64 exec, -1
    ds_write_addtid_b32 v72 offset:308
    ds_write_addtid_b32 v72 offset:8624
    ds_write_addtid_b32 v73 offset:16948
    ds_write_addtid_b32 v73 offset:25264
    s_mov_b32 exec_lo, 1
    s_mov_b32 exec_hi, 0x80000000
    ds_write_b16 v30, v80 offset:52
    ds_write_b16 v30, v80 offset:8368
    ds_write_b16 v30, v81 offset:16692
    ds_write_b16 v30, v81 offset:25008
    s_mov_b64 exec, -1
    buffer_load_dwordx4 v[32:35], v20, s[44:47], 0 offen sc1
    buffer_load_dword v40, v31, s[40:43], s79 offen
    s_waitcnt lgkmcnt(0)
    s_barrier
    ds_read_b128 v[144:147], v21 offset:128
    ds_read_b128 v[208:211], v22 offset:3712
    ds_read_b128 v[212:215], v22 offset:3200
    ds_read_b128 v[216:219], v22 offset:2688
    ds_read_b128 v[220:223], v22 offset:2176
    ds_read_b128 v[148:151], v21 offset:640
    ds_read_b128 v[152:155], v21 offset:1152
    ds_read_b128 v[156:159], v21 offset:1664
    ds_read_b128 v[176:179], v21 offset:192
    ds_read_b128 v[240:243], v22 offset:3776
    ds_read_b128 v[244:247], v22 offset:3264
    ds_read_b128 v[248:251], v22 offset:2752
    ds_read_b128 v[252:255], v22 offset:2240
    ds_read_b128 v[180:183], v21 offset:704
    ds_read_b128 v[184:187], v21 offset:1216
    ds_read_b128 v[188:191], v21 offset:1728
    s_waitcnt lgkmcnt(14)
    v_mfma_f32_16x16x32_bf16 v[96:99], v[144:147], v[208:211], 0
    ds_read_b128 v[128:131], v21 offset:0
    s_waitcnt lgkmcnt(14)
    v_mfma_f32_16x16x32_bf16 v[100:103], v[144:147], v[212:215], 0
    ds_read_b128 v[192:195], v22 offset:3584
    s_waitcnt lgkmcnt(14)
    v_mfma_f32_16x16x32_bf16 v[104:107], v[144:147], v[216:219], 0
    ds_read_b128 v[196:199], v22 offset:3072
    s_waitcnt lgkmcnt(14)
    v_mfma_f32_16x16x32_bf16 v[108:111], v[144:147], v[220:223], 0
    ds_read_b128 v[200:203], v22 offset:2560
    s_waitcnt lgkmcnt(12)
    v_mfma_f32_16x16x32_bf16 v[100:103], v[148:151], v[208:211], v[100:103]
    ds_read_b128 v[204:207], v22 offset:2048
    v_mfma_f32_16x16x32_bf16 v[104:107], v[148:151], v[212:215], v[104:107]
    buffer_load_dword v41, v31, s[40:43], s79 offen offset:896
    ds_read_b128 v[132:135], v21 offset:512
    v_mfma_f32_16x16x32_bf16 v[108:111], v[148:151], v[216:219], v[108:111]
    ds_read_b128 v[136:139], v21 offset:1024
    v_mfma_f32_16x16x32_bf16 v[104:107], v[152:155], v[208:211], v[104:107]
    ds_read_b128 v[140:143], v21 offset:1536
    v_mfma_f32_16x16x32_bf16 v[108:111], v[152:155], v[212:215], v[108:111]
    v_mfma_f32_16x16x32_bf16 v[108:111], v[156:159], v[208:211], v[108:111]
    s_waitcnt lgkmcnt(8)
    v_mfma_f32_16x16x32_bf16 v[96:99], v[176:179], v[240:243], v[96:99]
    ds_read_b128 v[160:163], v21 offset:64
    v_mfma_f32_16x16x32_bf16 v[100:103], v[176:179], v[244:247], v[100:103]
    ds_read_b128 v[224:227], v22 offset:3648
    v_mfma_f32_16x16x32_bf16 v[104:107], v[176:179], v[248:251], v[104:107]
    ds_read_b128 v[228:231], v22 offset:3136
    s_add_u32 s79, s79, 114688
    v_mfma_f32_16x16x32_bf16 v[108:111], v[176:179], v[252:255], v[108:111]
    ds_read_b128 v[232:235], v22 offset:2624
    v_mfma_f32_16x16x32_bf16 v[100:103], v[180:183], v[240:243], v[100:103]
    ds_read_b128 v[236:239], v22 offset:2112
    v_mfma_f32_16x16x32_bf16 v[104:107], v[180:183], v[244:247], v[104:107]
    ds_read_b128 v[164:167], v21 offset:576
    v_mfma_f32_16x16x32_bf16 v[108:111], v[180:183], v[248:251], v[108:111]
    ds_read_b128 v[168:171], v21 offset:1088
    v_mfma_f32_16x16x32_bf16 v[104:107], v[184:187], v[240:243], v[104:107]
    ds_read_b128 v[172:175], v21 offset:1600
    v_mfma_f32_16x16x32_bf16 v[108:111], v[184:187], v[244:247], v[108:111]
    v_mfma_f32_16x16x32_bf16 v[108:111], v[188:191], v[240:243], v[108:111]
    s_waitcnt lgkmcnt(8)
    v_mfma_f32_16x16x32_bf16 v[96:99], v[128:131], v[192:195], v[96:99]
    ds_read_b128 v[208:211], v22 offset:1536
    v_mfma_f32_16x16x32_bf16 v[100:103], v[128:131], v[196:199], v[100:103]
    ds_read_b128 v[212:215], v22 offset:1024
    v_mfma_f32_16x16x32_bf16 v[104:107], v[128:131], v[200:203], v[104:107]
    v_mfma_f32_16x16x32_bf16 v[108:111], v[128:131], v[204:207], v[108:111]
    ds_read_b128 v[216:219], v22 offset:512
    v_mfma_f32_16x16x32_bf16 v[100:103], v[132:135], v[192:195], v[100:103]
    buffer_load_dword v42, v31, s[40:43], s79 offen
    v_mfma_f32_16x16x32_bf16 v[104:107], v[132:135], v[196:199], v[104:107]
    ds_read_b128 v[220:223], v22 offset:0
    v_mfma_f32_16x16x32_bf16 v[108:111], v[132:135], v[200:203], v[108:111]
    s_waitcnt vmcnt(3)
    v_cmp_ne_u32 vcc, s65, v35
    v_mfma_f32_16x16x32_bf16 v[104:107], v[136:139], v[192:195], v[104:107]
    s_cbranch_vccnz L_m2_re
L_m2_ok:
    v_mfma_f32_16x16x32_bf16 v[108:111], v[136:139], v[196:199], v[108:111]
    ds_read_b128 v[52:55], v27 offset:52096
    v_add_f32_dpp v32, v32, v32 quad_perm:[1,0,3,2] row_mask:0xf bank_mask:0xf
    v_mfma_f32_16x16x32_bf16 v[108:111], v[140:143], v[192:195], v[108:111]
    v_add_f32_dpp v33, v33, v33 quad_perm:[1,0,3,2] row_mask:0xf bank_mask:0xf
    s_waitcnt lgkmcnt(5)
    v_mfma_f32_16x16x32_bf16 v[108:111], v[160:163], v[236:239], v[108:111]
    ds_read_b128 v[240:243], v22 offset:1600
    ds_read_b64_tr_b16 a[0:1], v14 offset:32768
    v_mfma_f32_16x16x32_bf16 v[108:111], v[164:167], v[232:235], v[108:111]
    ds_read_b64_tr_b16 a[2:3], v14 offset:33280
    v_cvt_pk_bf16_f32 v34, v32, v33
    v_mfma_f32_16x16x32_bf16 v[108:111], v[168:171], v[228:231], v[108:111]
    ds_read_b128 v[244:247], v22 offset:1088
    ds_read_b64_tr_b16 a[112:113], v14 offset:49152
    v_mfma_f32_16x16x32_bf16 v[108:111], v[172:175], v[224:227], v[108:111]
    ds_read_b64_tr_b16 a[114:115], v14 offset:49664
    v_lshlrev_b32 v32, 16, v34
    v_mfma_f32_16x16x32_bf16 v[104:107], v[160:163], v[232:235], v[104:107]
    ds_read_b128 v[248:251], v22 offset:576
    v_and_b32 v33, 0xffff0000, v34
    v_mfma_f32_16x16x32_bf16 v[104:107], v[164:167], v[228:231], v[104:107]
    buffer_load_dword v43, v31, s[40:43], s79 offen offset:896
    v_mfma_f32_16x16x32_bf16 v[104:107], v[168:171], v[224:227], v[104:107]
    ds_read_b128 v[252:255], v22 offset:64
    ds_read_b64_tr_b16 a[4:5], v14 offset:34816
    v_mfma_f32_16x16x32_bf16 v[100:103], v[160:163], v[228:231], v[100:103]
    ds_read_b64_tr_b16 a[6:7], v14 offset:35328
    ds_read_b64_tr_b16 a[116:117], v14 offset:51200
    v_mfma_f32_16x16x32_bf16 v[100:103], v[164:167], v[224:227], v[100:103]
    ds_read_b64_tr_b16 a[118:119], v14 offset:51712
    ds_read_b64_tr_b16 a[8:9], v14 offset:36864
    v_mfma_f32_16x16x32_bf16 v[96:99], v[160:163], v[224:227], v[96:99]
    ds_read_b64_tr_b16 a[10:11], v14 offset:37376
    s_waitcnt lgkmcnt(15)
    v_mfma_f32_16x16x32_bf16 v[112:115], v[128:131], v[208:211], 0
    ds_write_b128 v23, v[108:111] offset:3072
    v_mfma_f32_16x16x32_bf16 v[116:119], v[128:131], v[212:215], 0
    ds_read_b64_tr_b16 a[120:121], v14 offset:53248
    ds_read_b64_tr_b16 a[122:123], v14 offset:53760
    v_mfma_f32_16x16x32_bf16 v[120:123], v[128:131], v[216:219], 0
    ds_write_b128 v23, v[104:107] offset:2048
    v_mfma_f32_16x16x32_bf16 v[124:127], v[128:131], v[220:223], 0
    ds_read_b64_tr_b16 a[12:13], v14 offset:38912
    ds_read_b64_tr_b16 a[14:15], v14 offset:39424
    v_mfma_f32_16x16x32_bf16 v[112:115], v[132:135], v[204:207], v[112:115]
    ds_write_b128 v23, v[100:103] offset:1024
    v_mfma_f32_16x16x32_bf16 v[116:119], v[132:135], v[208:211], v[116:119]
    ds_read_b64_tr_b16 a[124:125], v14 offset:55296
    s_add_u32 s79, s79, 114688
    v_mfma_f32_16x16x32_bf16 v[120:123], v[132:135], v[212:215], v[120:123]
    ds_write_b128 v23, v[96:99] offset:0
    v_mfma_f32_16x16x32_bf16 v[124:127], v[132:135], v[216:219], v[124:127]
    ds_read_b64_tr_b16 a[126:127], v14 offset:55808
    v_add_f32 v32, v32, v28
    v_mfma_f32_16x16x32_bf16 v[112:115], v[136:139], v[200:203], v[112:115]
    v_add_f32 v33, v33, v28
    v_cvt_pk_bf16_f32 v34, v32, v33
    v_mfma_f32_16x16x32_bf16 v[116:119], v[136:139], v[204:207], v[116:119]
    v_lshlrev_b32 v32, 16, v34
    v_and_b32 v33, 0xffff0000, v34
    v_mfma_f32_16x16x32_bf16 v[120:123], v[136:139], v[208:211], v[120:123]
    v_readlane_b32 s30, v32, 0
    v_readlane_b32 s31, v33, 0
    v_mfma_f32_16x16x32_bf16 v[124:127], v[136:139], v[212:215], v[124:127]
    s_waitcnt lgkmcnt(0)
    s_barrier
    v_mfma_f32_16x16x32_bf16 v[112:115], v[140:143], v[196:199], v[112:115]
    ds_read_b128 v[64:67], v24 offset:0
    v_readlane_b32 s32, v32, 2
    v_mfma_f32_16x16x32_bf16 v[116:119], v[140:143], v[200:203], v[116:119]
    ds_read_b128 v[68:71], v24 offset:4096
    v_readlane_b32 s33, v33, 2
    v_mfma_f32_16x16x32_bf16 v[120:123], v[140:143], v[204:207], v[120:123]
    ds_read_b128 v[72:75], v24 offset:8192
    s_lshl_b32 s74, s63, 7
    v_mfma_f32_16x16x32_bf16 v[124:127], v[140:143], v[208:211], v[124:127]
    ds_read_b128 v[76:79], v24 offset:12288
    s_add_u32 s76, s74, 5242880
    v_mfma_f32_16x16x32_bf16 v[112:115], v[160:163], v[240:243], v[112:115]
    ds_read_b128 v[192:195], v22 offset:3712
    s_add_u32 s77, s74, 7340032
    v_mfma_f32_16x16x32_bf16 v[116:119], v[160:163], v[244:247], v[116:119]
    ds_read_b128 v[196:199], v22 offset:3200
    s_mov_b32 vcc_lo, 0x55555555
    v_mfma_f32_16x16x32_bf16 v[120:123], v[160:163], v[248:251], v[120:123]
    ds_read_b128 v[200:203], v22 offset:2688
    s_mov_b32 vcc_hi, 0x55555555
    v_mfma_f32_16x16x32_bf16 v[124:127], v[160:163], v[252:255], v[124:127]
    buffer_load_dword v92, off, s[44:47], s36 sc1
    ds_read_b128 v[204:207], v22 offset:2176
    v_mfma_f32_16x16x32_bf16 v[112:115], v[164:167], v[236:239], v[112:115]
    buffer_load_dword v92, off, s[44:47], s36 offset:128 sc1
    v_mfma_f32_16x16x32_bf16 v[116:119], v[164:167], v[240:243], v[116:119]
    ds_read_b128 v[208:211], v22 offset:1664
    v_mfma_f32_16x16x32_bf16 v[120:123], v[164:167], v[244:247], v[120:123]
    ds_read_b128 v[212:215], v22 offset:1152
    v_lshlrev_b32 v56, 16, v52
    v_mfma_f32_16x16x32_bf16 v[124:127], v[164:167], v[248:251], v[124:127]
    ds_read_b128 v[216:219], v22 offset:640
    v_and_b32 v60, 0xffff0000, v52
    v_mfma_f32_16x16x32_bf16 v[112:115], v[168:171], v[232:235], v[112:115]
    ds_read_b128 v[220:223], v22 offset:128
    v_lshlrev_b32 v57, 16, v53
    v_mfma_f32_16x16x32_bf16 v[116:119], v[168:171], v[236:239], v[116:119]
    v_and_b32 v61, 0xffff0000, v53
    v_lshlrev_b32 v58, 16, v54
    v_mfma_f32_16x16x32_bf16 v[120:123], v[168:171], v[240:243], v[120:123]
    v_and_b32 v62, 0xffff0000, v54
    v_lshlrev_b32 v59, 16, v55
    v_mfma_f32_16x16x32_bf16 v[124:127], v[168:171], v[244:247], v[124:127]
    v_and_b32 v63, 0xffff0000, v55
    s_waitcnt lgkmcnt(8)
    v_mfma_f32_16x16x32_bf16 v[112:115], v[172:175], v[228:231], v[112:115]
    v_add_f32 v64, v64, v68
    v_fmac_f32 v56, s30, v64
    v_mfma_f32_16x16x32_bf16 v[116:119], v[172:175], v[232:235], v[116:119]
    v_mul_f32 v64, s32, v56
    v_add_f32 v65, v65, v69
    v_mfma_f32_16x16x32_bf16 v[120:123], v[172:175], v[236:239], v[120:123]
    s_add_u32 m0, s12, 98304
    v_fmac_f32 v57, s30, v65
    v_mfma_f32_16x16x32_bf16 v[124:127], v[172:175], v[240:243], v[124:127]
    v_mul_f32 v65, s32, v57
    s_waitcnt lgkmcnt(0)
    v_mfma_f32_16x16x32_bf16 v[112:115], v[144:147], v[208:211], v[112:115]
    ds_read_b128 v[224:227], v22 offset:3776
    v_add_f32 v66, v66, v70
    v_mfma_f32_16x16x32_bf16 v[116:119], v[144:147], v[212:215], v[116:119]
    ds_read_b128 v[228:231], v22 offset:3264
    v_fmac_f32 v58, s30, v66
    v_mfma_f32_16x16x32_bf16 v[120:123], v[144:147], v[216:219], v[120:123]
    ds_read_b128 v[232:235], v22 offset:2752
    v_mul_f32 v66, s32, v58
    v_mfma_f32_16x16x32_bf16 v[124:127], v[144:147], v[220:223], v[124:127]
    v_add_f32 v67, v67, v71
    v_fmac_f32 v59, s30, v67
    v_mfma_f32_16x16x32_bf16 v[112:115], v[148:151], v[204:207], v[112:115]
    ds_read_b128 v[236:239], v22 offset:2240
    s_mul_i32 s13, s4, 14
    v_mfma_f32_16x16x32_bf16 v[116:119], v[148:151], v[208:211], v[116:119]
    ds_read_b128 v[240:243], v22 offset:1728
    v_mul_f32 v67, s32, v59
    v_mfma_f32_16x16x32_bf16 v[120:123], v[148:151], v[212:215], v[120:123]
    ds_read_b128 v[244:247], v22 offset:1216
    v_cvt_pk_bf16_f32 v88, v64, v65
    v_mfma_f32_16x16x32_bf16 v[124:127], v[148:151], v[216:219], v[124:127]
    v_cvt_pk_bf16_f32 v89, v66, v67
    v_add_f32 v72, v72, v76
    v_mfma_f32_16x16x32_bf16 v[112:115], v[152:155], v[200:203], v[112:115]
    ds_read_b128 v[248:251], v22 offset:704
    v_fmac_f32 v60, s31, v72
    v_mfma_f32_16x16x32_bf16 v[116:119], v[152:155], v[204:207], v[116:119]
    ds_read_b128 v[252:255], v22 offset:192
    v_mul_f32 v72, s33, v60
    v_mfma_f32_16x16x32_bf16 v[120:123], v[152:155], v[208:211], v[120:123]
    buffer_load_dwordx4 v6, s[52:55], s13 offen  lds
    v_mfma_f32_16x16x32_bf16 v[124:127], v[152:155], v[212:215], v[124:127]
    v_add_f32 v73, v73, v77
    v_fmac_f32 v61, s31, v73
    v_mfma_f32_16x16x32_bf16 v[112:115], v[156:159], v[196:199], v[112:115]
    v_mul_f32 v73, s33, v61
    v_add_f32 v74, v74, v78
    v_mfma_f32_16x16x32_bf16 v[116:119], v[156:159], v[200:203], v[116:119]
    v_fmac_f32 v62, s31, v74
    v_mul_f32 v74, s33, v62
    v_mfma_f32_16x16x32_bf16 v[120:123], v[156:159], v[204:207], v[120:123]
    v_add_f32 v75, v75, v79
    v_fmac_f32 v63, s31, v75
    v_mfma_f32_16x16x32_bf16 v[124:127], v[156:159], v[208:211], v[124:127]
    v_mul_f32 v75, s33, v63
    s_waitcnt lgkmcnt(0)
    v_mfma_f32_16x16x32_bf16 v[112:115], v[176:179], v[240:243], v[112:115]
    s_add_u32 s13, s13, 6144
    v_cvt_pk_bf16_f32 v90, v72, v73
    v_mfma_f32_16x16x32_bf16 v[116:119], v[176:179], v[244:247], v[116:119]
    v_cvt_pk_bf16_f32 v91, v74, v75
    v_cvt_pk_bf16_f32 v84, v56, v60
    v_mfma_f32_16x16x32_bf16 v[120:123], v[176:179], v[248:251], v[120:123]
    ds_read_b128 v[208:211], v22 offset:3584
    v_cvt_pk_bf16_f32 v85, v57, v61
    v_mfma_f32_16x16x32_bf16 v[124:127], v[176:179], v[252:255], v[124:127]
    v_cvt_pk_bf16_f32 v86, v58, v62
    v_cvt_pk_bf16_f32 v87, v59, v63
    v_mfma_f32_16x16x32_bf16 v[112:115], v[180:183], v[236:239], v[112:115]
    ds_read_b128 v[212:215], v22 offset:3072
    v_cndmask_b32_dpp v80, v90, v88, vcc quad_perm:[1,0,3,2] row_mask:0xf bank_mask:0xf
    v_mfma_f32_16x16x32_bf16 v[116:119], v[180:183], v[240:243], v[116:119]
    v_cndmask_b32_dpp v81, v91, v89, vcc quad_perm:[1,0,3,2] row_mask:0xf bank_mask:0xf
    s_not_b64 vcc, vcc
    v_mfma_f32_16x16x32_bf16 v[120:123], v[180:183], v[244:247], v[120:123]
    ds_read_b128 v[216:219], v22 offset:2560
    v_cndmask_b32_dpp v82, v88, v90, vcc quad_perm:[1,0,3,2] row_mask:0xf bank_mask:0xf
    v_mfma_f32_16x16x32_bf16 v[124:127], v[180:183], v[248:251], v[124:127]
    buffer_load_dwordx4 v6, s[52:55], s13 offen offset:1024  lds
    v_mfma_f32_16x16x32_bf16 v[112:115], v[184:187], v[232:235], v[112:115]
    ds_read_b128 v[220:223], v22 offset:2048
    v_cndmask_b32_dpp v83, v89, v91, vcc quad_perm:[1,0,3,2] row_mask:0xf bank_mask:0xf
    v_mfma_f32_16x16x32_bf16 v[116:119], v[184:187], v[236:239], v[116:119]
    s_not_b64 vcc, vcc
    v_mfma_f32_16x16x32_bf16 v[120:123], v[184:187], v[240:243], v[120:123]
    buffer_store_dwordx4 v[80:83], v25, s[44:47], s76 offen sc1
    buffer_store_dwordx4 v[84:87], v26, s[44:47], s77 offen sc1
    v_mfma_f32_16x16x32_bf16 v[124:127], v[184:187], v[244:247], v[124:127]
    s_add_u32 s76, s76, 57344
    s_add_u32 s77, s77, 57344
    v_mfma_f32_16x16x32_bf16 v[112:115], v[188:191], v[228:231], v[112:115]
    v_mfma_f32_16x16x32_bf16 v[116:119], v[188:191], v[232:235], v[116:119]
    v_mfma_f32_16x16x32_bf16 v[120:123], v[188:191], v[236:239], v[120:123]
    v_mfma_f32_16x16x32_bf16 v[124:127], v[188:191], v[240:243], v[124:127]
    ds_read_b128 v[240:243], v22 offset:3648
    ds_read_b128 v[244:247], v22 offset:3136
    ds_read_b128 v[248:251], v22 offset:2624
    ds_read_b128 v[252:255], v22 offset:2112
    s_waitcnt vmcnt(6)
    ds_write_b64 v29, v[40:41] offset:4096
    ds_write_b64 v29, v[42:43] offset:4608
    s_mov_b32 m0, s60
    v_lshlrev_b32 v72, 16, v40
    v_and_b32 v73, 0xffff0000, v40
    v_lshlrev_b32 v74, 16, v41
    v_and_b32 v75, 0xffff0000, v41
    v_lshlrev_b32 v76, 16, v44
    v_and_b32 v77, 0xffff0000, v44
    v_pk_fma_f32 v[72:73], v[72:73], v[44:45], v[76:77] op_sel:[0,1,0] op_sel_hi:[1,1,0]
    v_pk_fma_f32 v[74:75], v[74:75], v[46:47], v[76:77] op_sel:[0,0,1] op_sel_hi:[1,0,1]
    v_pk_fma_f32 v[72:73], v[72:73], v[38:39], v[36:37]
    v_pk_fma_f32 v[74:75], v[74:75], v[38:39], v[36:37]
    v_cvt_pk_bf16_f32 v64, v72, v74
    v_cvt_pk_bf16_f32 v65, v73, v75
    ds_write_addtid_b32 v64 offset:6260
    ds_write_addtid_b32 v64 offset:14576
    ds_write_addtid_b32 v65 offset:22900
    ds_write_addtid_b32 v65 offset:31216
    v_mov_b32_dpp v78, v64 wave_shr:1 row_mask:0xf bank_mask:0xf
    v_mov_b32_dpp v79, v65 wave_shr:1 row_mask:0xf bank_mask:0xf
    v_alignbit_b32 v68, v64, v78, 16
    v_alignbit_b32 v69, v65, v79, 16
    v_lshlrev_b32 v72, 16, v42
    v_and_b32 v73, 0xffff0000, v42
    v_lshlrev_b32 v74, 16, v43
    v_and_b32 v75, 0xffff0000, v43
    v_lshlrev_b32 v76, 16, v48
    v_and_b32 v77, 0xffff0000, v48
    v_pk_fma_f32 v[72:73], v[72:73], v[48:49], v[76:77] op_sel:[0,1,0] op_sel_hi:[1,1,0]
    v_pk_fma_f32 v[74:75], v[74:75], v[50:51], v[76:77] op_sel:[0,0,1] op_sel_hi:[1,0,1]
    v_pk_fma_f32 v[72:73], v[72:73], v[38:39], v[36:37]
    v_pk_fma_f32 v[74:75], v[74:75], v[38:39], v[36:37]
    v_mov_b32_dpp v78, v64 wave_ror:1 row_mask:0xf bank_mask:0xf
    v_mov_b32_dpp v79, v65 wave_ror:1 row_mask:0xf bank_mask:0xf
    v_cvt_pk_bf16_f32 v66, v72, v74
    v_cvt_pk_bf16_f32 v67, v73, v75
    s_mov_b64 exec, -2
    ds_write_addtid_b32 v68 offset:2100
    ds_write_addtid_b32 v68 offset:10416
    ds_write_addtid_b32 v69 offset:18740
    ds_write_addtid_b32 v69 offset:27056
    s_mov_b64 exec, -1
    ds_write_addtid_b32 v66 offset:6516
    ds_write_addtid_b32 v66 offset:14832
    ds_write_addtid_b32 v67 offset:23156
    ds_write_addtid_b32 v67 offset:31472
    v_mov_b32_dpp v78, v66 wave_shr:1 row_mask:0xf bank_mask:0xf
    v_mov_b32_dpp v79, v67 wave_shr:1 row_mask:0xf bank_mask:0xf
    v_alignbit_b32 v70, v66, v78, 16
    v_alignbit_b32 v71, v67, v79, 16
    v_lshrrev_b32 v78, 16, v66
    v_lshrrev_b32 v79, 16, v67
    s_mov_b64 exec, 1
    v_mov_b32 v78, v64
    v_mov_b32 v79, v65
    s_mov_b64 exec, -1
    ds_write_addtid_b32 v70 offset:2356
    ds_write_addtid_b32 v70 offset:10672
    ds_write_addtid_b32 v71 offset:18996
    ds_write_addtid_b32 v71 offset:27312
    s_mov_b32 exec_lo, 1
    s_mov_b32 exec_hi, 0x80000000
    ds_write_b16 v30, v78 offset:2100
    ds_write_b16 v30, v78 offset:10416
    ds_write_b16 v30, v79 offset:18740
    ds_write_b16 v30, v79 offset:27056
    s_mov_b64 exec, -1
    s_add_u32 m0, s12, 100352
    s_add_u32 s13, s13, 8192
    buffer_load_dwordx4 v6, s[52:55], s13 offen  lds
    s_add_u32 s13, s13, 6144
    buffer_load_dwordx4 v6, s[52:55], s13 offen offset:1024  lds
    s_add_u32 m0, s12, 102400
    s_add_u32 s13, s13, 8192
    buffer_load_dwordx4 v6, s[52:55], s13 offen  lds
    s_add_u32 s13, s13, 6144
    buffer_load_dwordx4 v6, s[52:55], s13 offen offset:1024  lds
    s_waitcnt lgkmcnt(0)
    s_barrier
    ds_read_b128 v[144:147], v21 offset:2176
    ds_read_b128 v[148:151], v21 offset:2688
    ds_read_b128 v[152:155], v21 offset:3200
    ds_read_b128 v[156:159], v21 offset:3712
    ds_read_b128 v[176:179], v21 offset:2240
    ds_read_b128 v[180:183], v21 offset:2752
    ds_read_b128 v[184:187], v21 offset:3264
    ds_read_b128 v[188:191], v21 offset:3776
    s_waitcnt lgkmcnt(7)
    v_mfma_f32_16x16x32_bf16 v[112:115], v[144:147], v[192:195], v[112:115]
    ds_read_b128 v[128:131], v21 offset:2048
    v_mfma_f32_16x16x32_bf16 v[116:119], v[144:147], v[196:199], v[116:119]
    ds_read_b128 v[132:135], v21 offset:2560
    v_mfma_f32_16x16x32_bf16 v[120:123], v[144:147], v[200:203], v[120:123]
    s_add_u32 m0, s12, 104448
    v_mfma_f32_16x16x32_bf16 v[124:127], v[144:147], v[204:207], v[124:127]
    ds_read_b128 v[136:139], v21 offset:3072
    s_waitcnt lgkmcnt(9)
    v_mfma_f32_16x16x32_bf16 v[116:119], v[148:151], v[192:195], v[116:119]
    ds_read_b128 v[140:143], v21 offset:3584
    v_mfma_f32_16x16x32_bf16 v[120:123], v[148:151], v[196:199], v[120:123]
    v_mfma_f32_16x16x32_bf16 v[124:127], v[148:151], v[200:203], v[124:127]
    ds_read_b128 v[160:163], v21 offset:2112
    s_waitcnt lgkmcnt(9)
    v_mfma_f32_16x16x32_bf16 v[120:123], v[152:155], v[192:195], v[120:123]
    ds_read_b128 v[164:167], v21 offset:2624
    v_mfma_f32_16x16x32_bf16 v[124:127], v[152:155], v[196:199], v[124:127]
    s_add_u32 s13, s13, 8192
    v_mfma_f32_16x16x32_bf16 v[124:127], v[156:159], v[192:195], v[124:127]
    ds_read_b128 v[168:171], v21 offset:3136
    s_waitcnt lgkmcnt(7)
    v_mfma_f32_16x16x32_bf16 v[112:115], v[176:179], v[224:227], v[112:115]
    ds_read_b128 v[172:175], v21 offset:3648
    v_mfma_f32_16x16x32_bf16 v[116:119], v[176:179], v[228:231], v[116:119]
    v_mfma_f32_16x16x32_bf16 v[120:123], v[176:179], v[232:235], v[120:123]
    ds_read_b64_tr_b16 a[16:17], v15 offset:0
    v_mfma_f32_16x16x32_bf16 v[124:127], v[176:179], v[236:239], v[124:127]
    ds_read_b128 v[52:55], v27 offset:56192
    ds_read_b64_tr_b16 a[18:19], v15 offset:512
    v_mfma_f32_16x16x32_bf16 v[116:119], v[180:183], v[224:227], v[116:119]
    buffer_load_dwordx4 v6, s[52:55], s13 offen  lds
    v_mfma_f32_16x16x32_bf16 v[120:123], v[180:183], v[228:231], v[120:123]
    ds_read_b64_tr_b16 a[128:129], v15 offset:16384
    v_mfma_f32_16x16x32_bf16 v[124:127], v[180:183], v[232:235], v[124:127]
    ds_read_b64_tr_b16 a[130:131], v15 offset:16896
    v_mfma_f32_16x16x32_bf16 v[120:123], v[184:187], v[224:227], v[120:123]
    v_mfma_f32_16x16x32_bf16 v[124:127], v[184:187], v[228:231], v[124:127]
    ds_read_b64_tr_b16 a[20:21], v15 offset:2048
    v_mfma_f32_16x16x32_bf16 v[124:127], v[188:191], v[224:227], v[124:127]
    ds_read_b64_tr_b16 a[22:23], v15 offset:2560
    s_waitcnt lgkmcnt(11)
    v_mfma_f32_16x16x32_bf16 v[112:115], v[128:131], v[208:211], v[112:115]
    s_waitcnt vmcnt(5)
    v_mfma_f32_16x16x32_bf16 v[116:119], v[128:131], v[212:215], v[116:119]
    s_mov_b64 exec, 1
    buffer_store_dword v4, off, s[44:47], s14 sc1
    s_mov_b64 exec, -1
    v_mfma_f32_16x16x32_bf16 v[120:123], v[128:131], v[216:219], v[120:123]
    s_add_u32 s14, s14, 114688
L_padS2:
    s_cbranch_execz L_retS
    s_add_u32 s13, s13, 6144
    v_mfma_f32_16x16x32_bf16 v[124:127], v[128:131], v[220:223], v[124:127]
    ds_read_b64_tr_b16 a[132:133], v15 offset:18432
    ds_read_b64_tr_b16 a[134:135], v15 offset:18944
    v_mfma_f32_16x16x32_bf16 v[116:119], v[132:135], v[208:211], v[116:119]
    ds_read_b64_tr_b16 a[24:25], v15 offset:4096
    s_waitcnt lgkmcnt(8)
    v_mfma_f32_16x16x32_bf16 v[120:123], v[132:135], v[212:215], v[120:123]
    ds_read_b64_tr_b16 a[26:27], v15 offset:4608
    v_lshlrev_b32 v56, 16, v52
    v_mfma_f32_16x16x32_bf16 v[124:127], v[132:135], v[216:219], v[124:127]
    v_and_b32 v60, 0xffff0000, v52
    v_lshlrev_b32 v57, 16, v53
    v_mfma_f32_16x16x32_bf16 v[120:123], v[136:139], v[208:211], v[120:123]
    buffer_load_dwordx4 v6, s[52:55], s13 offen offset:1024  lds
    v_mfma_f32_16x16x32_bf16 v[124:127], v[136:139], v[212:215], v[124:127]
    ds_read_b64_tr_b16 a[136:137], v15 offset:20480
    ds_read_b64_tr_b16 a[138:139], v15 offset:20992
    v_mfma_f32_16x16x32_bf16 v[124:127], v[140:143], v[208:211], v[124:127]
    v_and_b32 v61, 0xffff0000, v53
    v_mfma_f32_16x16x32_bf16 v[124:127], v[160:163], v[252:255], v[124:127]
    ds_read_b64_tr_b16 a[28:29], v15 offset:6144
    v_lshlrev_b32 v58, 16, v54
    v_mfma_f32_16x16x32_bf16 v[124:127], v[164:167], v[248:251], v[124:127]
    ds_read_b64_tr_b16 a[30:31], v15 offset:6656
    v_and_b32 v62, 0xffff0000, v54
    v_mfma_f32_16x16x32_bf16 v[124:127], v[168:171], v[244:247], v[124:127]
    v_lshlrev_b32 v59, 16, v55
    v_and_b32 v63, 0xffff0000, v55
    v_mfma_f32_16x16x32_bf16 v[124:127], v[172:175], v[240:243], v[124:127]
    ds_read_b64_tr_b16 a[140:141], v15 offset:22528
    v_mfma_f32_16x16x32_bf16 v[120:123], v[160:163], v[248:251], v[120:123]
    ds_read_b64_tr_b16 a[142:143], v15 offset:23040
    v_mfma_f32_16x16x32_bf16 v[120:123], v[164:167], v[244:247], v[120:123]
    v_mfma_f32_16x16x32_bf16 v[120:123], v[168:171], v[240:243], v[120:123]
    v_mfma_f32_16x16x32_bf16 v[116:119], v[160:163], v[244:247], v[116:119]
    v_mfma_f32_16x16x32_bf16 v[116:119], v[164:167], v[240:243], v[116:119]
    v_mfma_f32_16x16x32_bf16 v[112:115], v[160:163], v[240:243], v[112:115]
    ds_write_b128 v23, v[124:127] offset:19456
    s_nop 3
    ds_write_b128 v23, v[120:123] offset:18432
    s_nop 0
    ds_write_b128 v23, v[116:119] offset:17408
    ds_write_b128 v23, v[112:115] offset:16384
    s_waitcnt lgkmcnt(0)
    s_barrier
    ds_read_b128 v[64:67], v24 offset:16384
    ds_read_b128 v[68:71], v24 offset:20480
    ds_read_b128 v[72:75], v24 offset:24576
    ds_read_b128 v[76:79], v24 offset:28672
    s_add_u32 m0, s12, 32768
    s_mul_i32 s13, s7, 56
    buffer_load_dwordx4 v12, s[48:51], s13 offen offset:0 lds
    s_addk_i32 s13, 27648
    buffer_load_dwordx4 v12, s[48:51], s13 offen offset:1024 lds
    s_addk_i32 s13, 27648
    buffer_load_dwordx4 v12, s[48:51], s13 offen offset:2048 lds
    s_addk_i32 s13, 27648
    buffer_load_dwordx4 v12, s[48:51], s13 offen offset:3072 lds
    s_waitcnt lgkmcnt(2)
    v_pk_add_f32 v[64:65], v[64:65], v[68:69]
    v_pk_fma_f32 v[56:57], v[64:65], s[30:31], v[56:57] op_sel:[0,0,0] op_sel_hi:[1,0,1]
    v_pk_mul_f32 v[64:65], v[56:57], s[32:33] op_sel:[0,0] op_sel_hi:[1,0]
    v_pk_add_f32 v[66:67], v[66:67], v[70:71]
    v_pk_fma_f32 v[58:59], v[66:67], s[30:31], v[58:59] op_sel:[0,0,0] op_sel_hi:[1,0,1]
    v_pk_mul_f32 v[66:67], v[58:59], s[32:33] op_sel:[0,0] op_sel_hi:[1,0]
    v_cvt_pk_bf16_f32 v88, v64, v65
    v_cvt_pk_bf16_f32 v89, v66, v67
    s_waitcnt lgkmcnt(0)
    v_pk_add_f32 v[72:73], v[72:73], v[76:77]
    v_pk_fma_f32 v[60:61], v[72:73], s[30:31], v[60:61] op_sel:[0,1,0] op_sel_hi:[1,1,1]
    v_pk_mul_f32 v[72:73], v[60:61], s[32:33] op_sel:[0,1] op_sel_hi:[1,1]
    v_pk_add_f32 v[74:75], v[74:75], v[78:79]
    v_pk_fma_f32 v[62:63], v[74:75], s[30:31], v[62:63] op_sel:[0,1,0] op_sel_hi:[1,1,1]
    v_pk_mul_f32 v[74:75], v[62:63], s[32:33] op_sel:[0,1] op_sel_hi:[1,1]
    v_cvt_pk_bf16_f32 v90, v72, v73
    v_cvt_pk_bf16_f32 v91, v74, v75
    v_cvt_pk_bf16_f32 v84, v56, v60
    v_cvt_pk_bf16_f32 v85, v57, v61
    v_cvt_pk_bf16_f32 v86, v58, v62
    v_cvt_pk_bf16_f32 v87, v59, v63
    v_cndmask_b32_dpp v80, v90, v88, vcc quad_perm:[1,0,3,2] row_mask:0xf bank_mask:0xf
    v_cndmask_b32_dpp v81, v91, v89, vcc quad_perm:[1,0,3,2] row_mask:0xf bank_mask:0xf
    s_not_b64 vcc, vcc
    v_cndmask_b32_dpp v82, v88, v90, vcc quad_perm:[1,0,3,2] row_mask:0xf bank_mask:0xf
    v_cndmask_b32_dpp v83, v89, v91, vcc quad_perm:[1,0,3,2] row_mask:0xf bank_mask:0xf
    s_not_b64 vcc, vcc
    buffer_store_dwordx4 v[80:83], v25, s[44:47], s76 offen sc1
    buffer_store_dwordx4 v[84:87], v26, s[44:47], s77 offen sc1
X_join:
L_padS3_B:
    s_cbranch_execz L_retS_B
    s_add_u32 m0, s12, 36864
    s_addk_i32 s13, 31744
    buffer_load_dwordx4 v12, s[48:51], s13 offen offset:0 lds
    s_addk_i32 s13, 27648
    buffer_load_dwordx4 v12, s[48:51], s13 offen offset:1024 lds
    s_addk_i32 s13, 27648
    buffer_load_dwordx4 v12, s[48:51], s13 offen offset:2048 lds
    s_addk_i32 s13, 27648
    buffer_load_dwordx4 v12, s[48:51], s13 offen offset:3072 lds
    s_mov_b64 exec, 0
    s_cmp_eq_u32 s64, 0
    s_cbranch_scc1 L_padF0
    s_cmp_eq_u32 s64, 1
    s_cbranch_scc1 L_padF1
    s_cmp_eq_u32 s64, 2
    s_cbranch_scc1 L_padF2
    s_branch L_padF3
L_padF3:
L_retF:
    s_mov_b64 exec, -1
    s_add_u32 m0, s12, 65536
    s_mul_i32 s13, s8, 56
    buffer_load_dwordx4 v12, s[48:51], s13 offen offset:0 lds
    s_mov_b32 s61, s14
    v_lshlrev_b32 v3, 4, v1
    s_mul_i32 s74, s69, 114688
    s_add_u32 s74, s74, 5242880
    v_lshl_add_u32 v2, v0, 4, s74
    v_and_b32 v80, 31, v1
    v_lshlrev_b32 v5, 4, v80
    v_lshrrev_b32 v81, 5, v1
    v_mul_u32_u24 v81, 28672, v81
    v_add_u32 v86, v81, v5
    s_lshl_b32 s16, s69, 11
    s_add_u32 s16, s16, 147456
    s_addk_i32 s13, 27648
    buffer_load_dwordx4 v12, s[48:51], s13 offen offset:1024 lds
    s_lshl2_add_u32 s79, s70, s64
    s_lshl_b32 s21, s79, 9
    s_add_u32 s21, s21, 81920
    s_mul_i32 s75, s69, 224
    s_add_u32 s79, s79, s75
    s_lshl_b32 s17, s79, 11
    s_add_u32 s17, s17, 9437184
    s_lshl2_add_u32 s74, s70, s64
    s_mul_i32 s75, s74, 4682
    s_lshr_b32 s75, s75, 16
    s_lshl1_add_u32 s74, s75, s74
    s_lshl_b32 s75, s69, 8
    s_addk_i32 s13, 27648
    buffer_load_dwordx4 v12, s[48:51], s13 offen offset:2048 lds
    s_add_u32 s74, s74, s75
    s_mul_i32 s14, s74, 16
    s_add_u32 s14, s14, 262144
    s_and_b32 s74, s66, 7
    s_lshr_b32 s75, s67, 1
    s_lshl1_add_u32 s74, s74, s75
    s_lshl_b32 s15, s74, 2
    s_and_b32 s22, s67, 1
    s_lshl2_add_u32 s71, s15, s64
    s_mul_i32 s71, s71, 14
    s_lshl3_add_u32 s18, s71, s22
    s_addk_i32 s13, 27648
    buffer_load_dwordx4 v12, s[48:51], s13 offen offset:3072 lds
    s_lshl_b32 s18, s18, 8
    s_add_u32 s18, s18, 9437184
    s_add_u32 s19, s15, s22
    s_mul_i32 s19, s19, 112
    s_add_u32 s19, s19, s68
    s_lshl_b32 s19, s19, 7
    s_lshl_b32 s20, s68, 9
    s_add_u32 s20, s20, 68608
    v_bfe_u32 v82, v0, 2, 5
    v_and_b32 v80, 3, v0
    v_lshl_add_u32 v82, v82, 3, v80
    s_lshr_b32 s75, s64, 1
    s_add_u32 m0, s12, 69632
    s_addk_i32 s13, 31744
    buffer_load_dwordx4 v12, s[48:51], s13 offen offset:0 lds
    s_add_u32 s74, s15, s75
    s_mul_i32 s74, s74, 7
    s_add_u32 s74, s74, s68
    s_lshl_b32 s74, s74, 6
    s_add_u32 s74, s74, s22
    s_lshl_b32 s74, s74, 6
    s_add_u32 s74, s74, 7340032
    v_lshl_add_u32 v88, v82, 4, s74
    s_lshl2_add_u32 s75, s15, s64
    s_mul_i32 s75, s75, 256
    s_add_u32 s75, s75, 262144
    v_min_u32 v19, 13, v1
    s_addk_i32 s13, 27648
    buffer_load_dwordx4 v12, s[48:51], s13 offen offset:1024 lds
    v_lshl_add_u32 v19, v19, 4, s75
    v_and_b32 v80, 15, v1
    v_lshrrev_b32 v81, 4, v1
    v_lshl_add_u32 v80, v81, 6, v80
    v_lshl_add_u32 v89, v80, 4, s75
    v_and_b32 v80, 7, v0
    v_lshlrev_b32 v87, 4, v80
    v_mov_b32 v36, 0
    v_mov_b32 v37, 0
    v_mov_b32 v38, 0
    v_mov_b32 v39, 0
    s_waitcnt vmcnt(10)
    s_mov_b64 exec, 1
    buffer_store_dword v4, off, s[44:47], s61 sc1
    s_mov_b64 exec, -1
    s_addk_i32 s13, 27648
    buffer_load_dwordx4 v12, s[48:51], s13 offen offset:2048 lds
    s_addk_i32 s13, 27648
    buffer_load_dwordx4 v12, s[48:51], s13 offen offset:3072 lds
    s_add_u32 m0, s12, 131072
    s_mul_i32 s13, s6, 56
    buffer_load_dwordx4 v12, s[48:51], s13 offen  lds
    s_add_u32 s13, s13, 27648
    buffer_load_dwordx4 v12, s[48:51], s13 offen offset:1024  lds
    s_add_u32 m0, s12, 133120
    s_add_u32 s13, s13, 29696
    buffer_load_dwordx4 v12, s[48:51], s13 offen  lds
    s_add_u32 s13, s13, 27648
    buffer_load_dwordx4 v12, s[48:51], s13 offen offset:1024  lds
    s_add_u32 m0, s12, 135168
    s_add_u32 s13, s13, 29696
    buffer_load_dwordx4 v12, s[48:51], s13 offen  lds
    s_add_u32 s13, s13, 27648
    buffer_load_dwordx4 v12, s[48:51], s13 offen offset:1024  lds
    s_add_u32 m0, s12, 137216
    s_add_u32 s13, s13, 29696
    buffer_load_dwordx4 v12, s[48:51], s13 offen  lds
    s_add_u32 s13, s13, 27648
    buffer_load_dwordx4 v12, s[48:51], s13 offen offset:1024  lds
    buffer_load_dword v48, off, s[44:47], s36 sc1
    ds_read_b64_tr_b16 a[224:225], v8 offset:32768
    ds_read_b64_tr_b16 a[226:227], v8 offset:33792
    ds_read_b64_tr_b16 a[228:229], v9 offset:32768
    ds_read_b64_tr_b16 a[230:231], v9 offset:33792
    ds_read_b64_tr_b16 a[232:233], v10 offset:32768
    ds_read_b64_tr_b16 a[234:235], v10 offset:33792
    ds_read_b64_tr_b16 a[236:237], v11 offset:32768
    ds_read_b64_tr_b16 a[238:239], v11 offset:33792
    ds_read_b64_tr_b16 a[240:241], v8 offset:36864
    ds_read_b64_tr_b16 a[242:243], v8 offset:37888
    ds_read_b64_tr_b16 a[244:245], v9 offset:36864
    ds_read_b64_tr_b16 a[246:247], v9 offset:37888
    ds_read_b64_tr_b16 a[248:249], v10 offset:36864
    ds_read_b64_tr_b16 a[250:251], v10 offset:37888
    ds_read_b64_tr_b16 a[252:253], v11 offset:36864
    ds_read_b64_tr_b16 a[254:255], v11 offset:37888
    s_waitcnt lgkmcnt(0)
    s_add_u32 m0, s12, 98304
    s_mul_i32 s13, s9, 56
    buffer_load_dwordx4 v12, s[48:51], s13 offen offset:0 lds
    s_addk_i32 s13, 27648
    buffer_load_dwordx4 v12, s[48:51], s13 offen offset:1024 lds
    s_addk_i32 s13, 27648
    buffer_load_dwordx4 v12, s[48:51], s13 offen offset:2048 lds
    s_addk_i32 s13, 27648
    buffer_load_dwordx4 v12, s[48:51], s13 offen offset:3072 lds
    s_waitcnt vmcnt(4)
    v_cmpx_eq_u32 vcc, s65, v48
    s_nop 0
    s_cmp_eq_u64 exec, -1
    s_mov_b64 exec, -1
    s_cbranch_scc0 L_f2_re
L_f2_ok:
    s_barrier
    s_add_u32 m0, s11, 0
    s_nop 0
    buffer_load_dwordx4 v2, s[44:47], s4 offen sc1 lds
    s_addk_i32 m0, 4096
    s_nop 0
    buffer_load_dwordx4 v2, s[44:47], s5 offen sc1 lds
    s_addk_i32 m0, 4096
    s_nop 0
    buffer_load_dwordx4 v2, s[44:47], s6 offen sc1 lds
    s_addk_i32 m0, 4096
    s_nop 0
    buffer_load_dwordx4 v2, s[44:47], s7 offen sc1 lds
    s_addk_i32 m0, 4096
    s_nop 0
    buffer_load_dwordx4 v2, s[44:47], s8 offen sc1 lds
    s_addk_i32 m0, 4096
    s_nop 0
    buffer_load_dwordx4 v2, s[44:47], s9 offen sc1 lds
    s_addk_i32 m0, 4096
    s_nop 0
    buffer_load_dwordx4 v2, s[44:47], s10 offen sc1 lds
    v_add_u32 v2, 28672, v2
    ds_read_b64_tr_b16 a[32:33], v15 offset:0
    s_add_u32 m0, s12, 102400
    s_addk_i32 s13, 31744
    buffer_load_dwordx4 v12, s[48:51], s13 offen offset:0 lds
    ds_read_b64_tr_b16 a[34:35], v15 offset:512
    ds_read_b64_tr_b16 a[144:145], v15 offset:16384
    ds_read_b64_tr_b16 a[146:147], v15 offset:16896
    ds_read_b64_tr_b16 a[36:37], v15 offset:2048
    ds_read_b64_tr_b16 a[38:39], v15 offset:2560
    ds_read_b64_tr_b16 a[148:149], v15 offset:18432
    ds_read_b64_tr_b16 a[150:151], v15 offset:18944
    ds_read_b64_tr_b16 a[40:41], v15 offset:4096
    ds_read_b64_tr_b16 a[42:43], v15 offset:4608
    ds_read_b64_tr_b16 a[152:153], v15 offset:20480
    ds_read_b64_tr_b16 a[154:155], v15 offset:20992
    ds_read_b64_tr_b16 a[44:45], v15 offset:6144
    s_addk_i32 s13, 27648
    buffer_load_dwordx4 v12, s[48:51], s13 offen offset:1024 lds
    ds_read_b64_tr_b16 a[46:47], v15 offset:6656
    ds_read_b64_tr_b16 a[156:157], v15 offset:22528
    ds_read_b64_tr_b16 a[158:159], v15 offset:23040
    ds_read_b64_tr_b16 a[48:49], v13 offset:32768
    ds_read_b64_tr_b16 a[50:51], v13 offset:33280
    ds_read_b64_tr_b16 a[160:161], v13 offset:49152
    ds_read_b64_tr_b16 a[162:163], v13 offset:49664
    ds_read_b64_tr_b16 a[52:53], v13 offset:34816
    ds_read_b64_tr_b16 a[54:55], v13 offset:35328
    ds_read_b64_tr_b16 a[164:165], v13 offset:51200
    ds_read_b64_tr_b16 a[166:167], v13 offset:51712
    ds_read_b64_tr_b16 a[56:57], v13 offset:36864
    s_addk_i32 s13, 27648
    buffer_load_dwordx4 v12, s[48:51], s13 offen offset:2048 lds
    ds_read_b64_tr_b16 a[58:59], v13 offset:37376
    ds_read_b64_tr_b16 a[168:169], v13 offset:53248
    ds_read_b64_tr_b16 a[170:171], v13 offset:53760
    ds_read_b64_tr_b16 a[60:61], v13 offset:38912
    ds_read_b64_tr_b16 a[62:63], v13 offset:39424
    ds_read_b64_tr_b16 a[172:173], v13 offset:55296
    ds_read_b64_tr_b16 a[174:175], v13 offset:55808
    ds_read_b64_tr_b16 a[64:65], v14 offset:0
    ds_read_b64_tr_b16 a[66:67], v14 offset:512
    ds_read_b64_tr_b16 a[176:177], v14 offset:16384
    ds_read_b64_tr_b16 a[178:179], v14 offset:16896
    ds_read_b64_tr_b16 a[68:69], v14 offset:2048
    s_addk_i32 s13, 27648
    buffer_load_dwordx4 v12, s[48:51], s13 offen offset:3072 lds
    ds_read_b64_tr_b16 a[70:71], v14 offset:2560
    ds_read_b64_tr_b16 a[180:181], v14 offset:18432
    ds_read_b64_tr_b16 a[182:183], v14 offset:18944
    ds_read_b64_tr_b16 a[72:73], v14 offset:4096
    ds_read_b64_tr_b16 a[74:75], v14 offset:4608
    ds_read_b64_tr_b16 a[184:185], v14 offset:20480
    ds_read_b64_tr_b16 a[186:187], v14 offset:20992
    ds_read_b64_tr_b16 a[76:77], v14 offset:6144
    ds_read_b64_tr_b16 a[78:79], v14 offset:6656
    ds_read_b64_tr_b16 a[188:189], v14 offset:22528
    ds_read_b64_tr_b16 a[190:191], v14 offset:23040
    s_waitcnt vmcnt(4)
    s_waitcnt lgkmcnt(0)
    s_barrier
    ds_read_b64_tr_b16 v[56:57], v16 offset:0
    ds_read_b64_tr_b16 v[58:59], v16 offset:256
    ds_read_b64_tr_b16 v[60:61], v16 offset:1024
    ds_read_b64_tr_b16 v[62:63], v16 offset:1280
    ds_read_b64_tr_b16 v[64:65], v16 offset:2048
    ds_read_b64_tr_b16 v[66:67], v16 offset:2304
    ds_read_b64_tr_b16 v[68:69], v16 offset:3072
    ds_read_b64_tr_b16 v[70:71], v16 offset:3328
    s_waitcnt lgkmcnt(4)
    v_mfma_f32_32x32x16_bf16 v[94:109], a[0:3], v[56:59], 0
    s_add_u32 m0, s12, 131072
    s_mul_i32 s13, s10, 56
    buffer_load_dwordx4 v12, s[48:51], s13 offen offset:0 lds
    ds_read_b64_tr_b16 v[72:73], v16 offset:4096
    v_mfma_f32_32x32x16_bf16 v[110:125], a[112:115], v[56:59], 0
    s_addk_i32 s13, 27648
    buffer_load_dwordx4 v12, s[48:51], s13 offen offset:1024 lds
    ds_read_b64_tr_b16 v[74:75], v16 offset:4352
    v_mfma_f32_32x32x16_bf16 v[94:109], a[4:7], v[60:63], v[94:109]
    s_addk_i32 s13, 27648
    buffer_load_dwordx4 v12, s[48:51], s13 offen offset:2048 lds
    ds_read_b64_tr_b16 v[76:77], v16 offset:5120
    v_mfma_f32_32x32x16_bf16 v[110:125], a[116:119], v[60:63], v[110:125]
    s_addk_i32 s13, 27648
    buffer_load_dwordx4 v12, s[48:51], s13 offen offset:3072 lds
    ds_read_b64_tr_b16 v[78:79], v16 offset:5376
    s_waitcnt lgkmcnt(4)
    v_mfma_f32_32x32x16_bf16 v[94:109], a[8:11], v[64:67], v[94:109]
    s_add_u32 m0, s12, 135168
    s_addk_i32 s13, 31744
    buffer_load_dwordx4 v12, s[48:51], s13 offen offset:0 lds
    ds_read_b64_tr_b16 v[56:57], v16 offset:6144
    v_mfma_f32_32x32x16_bf16 v[110:125], a[120:123], v[64:67], v[110:125]
    ds_read_b64_tr_b16 v[58:59], v16 offset:6400
    v_mfma_f32_32x32x16_bf16 v[94:109], a[12:15], v[68:71], v[94:109]
    s_addk_i32 s13, 27648
    buffer_load_dwordx4 v12, s[48:51], s13 offen offset:1024 lds
    ds_read_b64_tr_b16 v[60:61], v16 offset:7168
    v_mfma_f32_32x32x16_bf16 v[110:125], a[124:127], v[68:71], v[110:125]
    s_addk_i32 s13, 27648
    buffer_load_dwordx4 v12, s[48:51], s13 offen offset:2048 lds
    ds_read_b64_tr_b16 v[62:63], v16 offset:7424
    s_waitcnt lgkmcnt(4)
    v_mfma_f32_32x32x16_bf16 v[94:109], a[16:19], v[72:75], v[94:109]
    s_addk_i32 s13, 27648
    buffer_load_dwordx4 v12, s[48:51], s13 offen offset:3072 lds
    ds_read_b64_tr_b16 v[64:65], v16 offset:8192
    v_mfma_f32_32x32x16_bf16 v[110:125], a[128:131], v[72:75], v[110:125]
    ds_read_b64_tr_b16 v[66:67], v16 offset:8448
    v_mov_b32 v12, v88
    v_mfma_f32_32x32x16_bf16 v[94:109], a[20:23], v[76:79], v[94:109]
    ds_read_b64_tr_b16 v[68:69], v16 offset:9216
    s_add_u32 m0, s11, 32768
    v_mfma_f32_32x32x16_bf16 v[110:125], a[132:135], v[76:79], v[110:125]
    ds_read_b64_tr_b16 v[70:71], v16 offset:9472
    s_waitcnt lgkmcnt(4)
    v_mfma_f32_32x32x16_bf16 v[94:109], a[24:27], v[56:59], v[94:109]
    buffer_load_dwordx4 v2, s[44:47], s4 offen sc1 lds
    ds_read_b64_tr_b16 v[72:73], v16 offset:10240
    v_mfma_f32_32x32x16_bf16 v[110:125], a[136:139], v[56:59], v[110:125]
    ds_read_b64_tr_b16 v[74:75], v16 offset:10496
    s_addk_i32 m0, 4096
    v_mfma_f32_32x32x16_bf16 v[94:109], a[28:31], v[60:63], v[94:109]
    buffer_load_dwordx4 v2, s[44:47], s5 offen sc1 lds
    ds_read_b64_tr_b16 v[76:77], v16 offset:11264
    v_mfma_f32_32x32x16_bf16 v[110:125], a[140:143], v[60:63], v[110:125]
    ds_read_b64_tr_b16 v[78:79], v16 offset:11520
    s_addk_i32 m0, 4096
    s_waitcnt lgkmcnt(4)
    v_mfma_f32_32x32x16_bf16 v[94:109], a[32:35], v[64:67], v[94:109]
    buffer_load_dwordx4 v2, s[44:47], s6 offen sc1 lds
    ds_read_b64_tr_b16 v[56:57], v16 offset:12288
    v_mfma_f32_32x32x16_bf16 v[110:125], a[144:147], v[64:67], v[110:125]
    ds_read_b64_tr_b16 v[58:59], v16 offset:12544
    v_mfma_f32_32x32x16_bf16 v[94:109], a[36:39], v[68:71], v[94:109]
    ds_read_b64_tr_b16 v[60:61], v16 offset:13312
    s_addk_i32 m0, 4096
    v_mfma_f32_32x32x16_bf16 v[110:125], a[148:151], v[68:71], v[110:125]
    buffer_load_dwordx4 v2, s[44:47], s7 offen sc1 lds
    ds_read_b64_tr_b16 v[62:63], v16 offset:13568
    s_waitcnt lgkmcnt(4)
    v_mfma_f32_32x32x16_bf16 v[94:109], a[40:43], v[72:75], v[94:109]
    ds_read_b64_tr_b16 v[64:65], v16 offset:14336
    s_addk_i32 m0, 4096
    v_mfma_f32_32x32x16_bf16 v[110:125], a[152:155], v[72:75], v[110:125]
    buffer_load_dwordx4 v2, s[44:47], s8 offen sc1 lds
    ds_read_b64_tr_b16 v[66:67], v16 offset:14592
    v_mfma_f32_32x32x16_bf16 v[94:109], a[44:47], v[76:79], v[94:109]
    ds_read_b64_tr_b16 v[68:69], v16 offset:15360
    s_addk_i32 m0, 4096
    v_mfma_f32_32x32x16_bf16 v[110:125], a[156:159], v[76:79], v[110:125]
    ds_read_b64_tr_b16 v[70:71], v16 offset:15616
    s_waitcnt lgkmcnt(4)
    v_mfma_f32_32x32x16_bf16 v[94:109], a[48:51], v[56:59], v[94:109]
    buffer_load_dwordx4 v2, s[44:47], s9 offen sc1 lds
    ds_read_b64_tr_b16 v[72:73], v16 offset:16384
    v_mfma_f32_32x32x16_bf16 v[110:125], a[160:163], v[56:59], v[110:125]
    ds_read_b64_tr_b16 v[74:75], v16 offset:16640
    s_waitcnt vmcnt(6)
    s_barrier
    s_addk_i32 m0, 4096
    v_mfma_f32_32x32x16_bf16 v[94:109], a[52:55], v[60:63], v[94:109]
    ds_read_b64_tr_b16 v[76:77], v16 offset:17408
    ds_read_b64_tr_b16 a[80:81], v14 offset:32768
    ds_read_b64_tr_b16 a[82:83], v14 offset:33280
    ds_read_b64_tr_b16 a[192:193], v14 offset:49152
    v_mfma_f32_32x32x16_bf16 v[110:125], a[164:167], v[60:63], v[110:125]
    buffer_load_dwordx4 v2, s[44:47], s10 offen sc1 lds
    ds_read_b64_tr_b16 v[78:79], v16 offset:17664
    ds_read_b64_tr_b16 a[194:195], v14 offset:49664
    ds_read_b64_tr_b16 a[84:85], v14 offset:34816
    s_waitcnt lgkmcnt(9)
    v_mfma_f32_32x32x16_bf16 v[94:109], a[56:59], v[64:67], v[94:109]
    buffer_load_dwordx4 v[24:27], v5, s[44:47], s20 offen sc1
    ds_read_b64_tr_b16 v[56:57], v16 offset:18432
    v_add_u32 v2, 28672, v2
    v_mfma_f32_32x32x16_bf16 v[110:125], a[168:171], v[64:67], v[110:125]
    ds_read_b64_tr_b16 v[58:59], v16 offset:18688
    ds_read_b64_tr_b16 a[86:87], v14 offset:35328
    ds_read_b64_tr_b16 a[196:197], v14 offset:51200
    v_mfma_f32_32x32x16_bf16 v[94:109], a[60:63], v[68:71], v[94:109]
    buffer_load_dwordx4 v[28:31], v5, s[44:47], s20 offen offset:3584 sc1
    ds_read_b64_tr_b16 v[60:61], v16 offset:19456
    ds_read_b64_tr_b16 a[198:199], v14 offset:51712
    ds_read_b64_tr_b16 a[88:89], v14 offset:36864
    ds_read_b64_tr_b16 a[90:91], v14 offset:37376
    v_mfma_f32_32x32x16_bf16 v[110:125], a[172:175], v[68:71], v[110:125]
    buffer_load_dwordx4 v[32:35], v86, s[44:47], s21 offen sc1
    ds_read_b64_tr_b16 v[62:63], v16 offset:19712
    ds_read_b64_tr_b16 a[200:201], v14 offset:53248
    ds_read_b64_tr_b16 a[202:203], v14 offset:53760
    s_waitcnt lgkmcnt(13)
    v_mfma_f32_32x32x16_bf16 v[94:109], a[64:67], v[72:75], v[94:109]
    buffer_load_dword v13, v89, s[44:47], 0 offen sc1
    ds_read_b64_tr_b16 v[64:65], v16 offset:20480
    ds_read_b64_tr_b16 a[92:93], v14 offset:38912
    ds_read_b64_tr_b16 a[94:95], v14 offset:39424
    ds_read_b64_tr_b16 a[204:205], v14 offset:55296
    v_mfma_f32_32x32x16_bf16 v[110:125], a[176:179], v[72:75], v[110:125]
    ds_read_b64_tr_b16 v[66:67], v16 offset:20736
    ds_read_b64_tr_b16 a[206:207], v14 offset:55808
    ds_read_b64_tr_b16 a[96:97], v15 offset:0
    ds_read_b64_tr_b16 a[98:99], v15 offset:512
    ds_read_b64_tr_b16 a[208:209], v15 offset:16384
    ds_read_b64_tr_b16 a[210:211], v15 offset:16896
    v_mfma_f32_32x32x16_bf16 v[94:109], a[68:71], v[76:79], v[94:109]
    ds_read_b64_tr_b16 v[68:69], v16 offset:21504
    ds_read_b64_tr_b16 a[100:101], v15 offset:2048
    v_mfma_f32_32x32x16_bf16 v[110:125], a[180:183], v[76:79], v[110:125]
    s_add_u32 m0, s12, 65536
    s_mul_i32 s13, s5, 14
    buffer_load_dwordx4 v6, s[52:55], s13 offen offset:0 lds
    ds_read_b64_tr_b16 v[70:71], v16 offset:21760
    s_waitcnt lgkmcnt(15)
    v_mfma_f32_32x32x16_bf16 v[94:109], a[72:75], v[56:59], v[94:109]
    ds_read_b64_tr_b16 v[72:73], v16 offset:22528
    ds_read_b64_tr_b16 a[102:103], v15 offset:2560
    ds_read_b64_tr_b16 a[212:213], v15 offset:18432
    ds_read_b64_tr_b16 a[214:215], v15 offset:18944
    ds_read_b64_tr_b16 a[104:105], v15 offset:4096
    ds_read_b64_tr_b16 a[106:107], v15 offset:4608
    v_mfma_f32_32x32x16_bf16 v[110:125], a[184:187], v[56:59], v[110:125]
    ds_read_b64_tr_b16 v[74:75], v16 offset:22784
    ds_read_b64_tr_b16 a[216:217], v15 offset:20480
    ds_read_b64_tr_b16 a[218:219], v15 offset:20992
    ds_read_b64_tr_b16 a[108:109], v15 offset:6144
    ds_read_b64_tr_b16 a[110:111], v15 offset:6656
    v_mfma_f32_32x32x16_bf16 v[94:109], a[76:79], v[60:63], v[94:109]
    s_addk_i32 s13, 6144
    buffer_load_dwordx4 v6, s[52:55], s13 offen offset:1024 lds
    ds_read_b64_tr_b16 v[76:77], v16 offset:23552
    ds_read_b64_tr_b16 a[220:221], v15 offset:22528
    ds_read_b64_tr_b16 a[222:223], v15 offset:23040
    v_mfma_f32_32x32x16_bf16 v[110:125], a[188:191], v[60:63], v[110:125]
    ds_read_b64_tr_b16 v[78:79], v16 offset:23808
    s_waitcnt lgkmcnt(15)
    v_mfma_f32_32x32x16_bf16 v[94:109], a[80:83], v[64:67], v[94:109]
    buffer_load_dwordx4 v[40:43], v5, s[44:47], s16 offen offset:0 sc1
    ds_read_b64_tr_b16 v[56:57], v16 offset:24576
    v_mfma_f32_32x32x16_bf16 v[110:125], a[192:195], v[64:67], v[110:125]
    ds_read_b64_tr_b16 v[58:59], v16 offset:24832
    v_mfma_f32_32x32x16_bf16 v[94:109], a[84:87], v[68:71], v[94:109]
    s_addk_i32 s13, 6144
    buffer_load_dwordx4 v6, s[52:55], s13 offen offset:2048 lds
    ds_read_b64_tr_b16 v[60:61], v16 offset:25600
    s_add_u32 s37, s36, 128
    s_load_dword s37, s[44:45], s37
    v_mfma_f32_32x32x16_bf16 v[110:125], a[196:199], v[68:71], v[110:125]
    ds_read_b64_tr_b16 v[62:63], v16 offset:25856
    s_waitcnt lgkmcnt(4)
    v_mfma_f32_32x32x16_bf16 v[94:109], a[88:91], v[72:75], v[94:109]
    ds_read_b64_tr_b16 v[64:65], v16 offset:26624
    v_lshrrev_b32 v14, 4, v1
    v_lshlrev_b32 v14, 9, v14
    v_and_b32 v15, 0xf0, v3
    v_add3_u32 v14, v14, v15, s18
    v_mfma_f32_32x32x16_bf16 v[110:125], a[200:203], v[72:75], v[110:125]
    ds_read_b64_tr_b16 v[66:67], v16 offset:26880
    v_mfma_f32_32x32x16_bf16 v[94:109], a[92:95], v[76:79], v[94:109]
    s_addk_i32 s13, 6144
    buffer_load_dwordx4 v6, s[52:55], s13 offen offset:3072 lds
    ds_read_b64_tr_b16 v[68:69], v16 offset:27648
    v_mfma_f32_32x32x16_bf16 v[110:125], a[204:207], v[76:79], v[110:125]
    ds_read_b64_tr_b16 v[70:71], v16 offset:27904
    s_waitcnt lgkmcnt(4)
    v_mfma_f32_32x32x16_bf16 v[94:109], a[96:99], v[56:59], v[94:109]
    v_mfma_f32_32x32x16_bf16 v[110:125], a[208:211], v[56:59], v[110:125]
    s_waitcnt vmcnt(9)
    s_waitcnt lgkmcnt(0)
    s_barrier
    ds_read_b64_tr_b16 v[72:73], v16 offset:32768
    ds_read_b64_tr_b16 v[74:75], v16 offset:33024
    v_mfma_f32_32x32x16_bf16 v[94:109], a[100:103], v[60:63], v[94:109]
    ds_read_b64_tr_b16 v[76:77], v16 offset:33792
    s_cmp_lg_u32 s37, s65
    s_cbranch_scc1 L_gb_re
L_gb_ok:
    v_mfma_f32_32x32x16_bf16 v[110:125], a[212:215], v[60:63], v[110:125]
    s_add_u32 m0, s12, 69632
    s_addk_i32 s13, 10240
    buffer_load_dwordx4 v6, s[52:55], s13 offen offset:0 lds
    ds_read_b64_tr_b16 v[78:79], v16 offset:34048
    v_mfma_f32_32x32x16_bf16 v[94:109], a[104:107], v[64:67], v[94:109]
    ds_read_b64_tr_b16 v[56:57], v16 offset:34816
    s_waitcnt vmcnt(7)
    v_cmp_ne_u32 vcc, s65, v27
    v_cmp_ne_u32 s[72:73], s65, v31
    s_nop 0
    s_or_b64 vcc, vcc, s[72:73]
    v_cmp_ne_u32 s[72:73], s65, v35
    v_mfma_f32_32x32x16_bf16 v[110:125], a[216:219], v[64:67], v[110:125]
    ds_read_b64_tr_b16 v[58:59], v16 offset:35072
    s_or_b64 vcc, vcc, s[72:73]
    s_cbranch_vccnz L_g_re
L_g_ok:
    v_mfma_f32_32x32x16_bf16 v[94:109], a[108:111], v[68:71], v[94:109]
    ds_read_b64_tr_b16 v[60:61], v16 offset:35840
    v_add_f32 v24, v24, v28
    v_add_f32 v25, v25, v29
    v_cvt_pk_bf16_f32 v24, v24, v25
    v_mov_b32 v35, 0
    v_mfma_f32_32x32x16_bf16 v[110:125], a[220:223], v[68:71], v[110:125]
    ds_read_b64_tr_b16 v[62:63], v16 offset:36096
    s_mov_b32 exec_lo, 0
    v_mov_b32 v36, v32
    v_mov_b32 v32, 0
    s_mov_b32 exec_lo, -1
    s_waitcnt lgkmcnt(4)
    v_mfma_f32_32x32x16_bf16 v[126:141], a[0:3], v[72:75], 0
    s_addk_i32 s13, 6144
    buffer_load_dwordx4 v6, s[52:55], s13 offen offset:1024 lds
    ds_read_b64_tr_b16 v[64:65], v16 offset:36864
    v_mfma_f32_32x32x16_bf16 v[142:157], a[112:115], v[72:75], 0
    ds_read_b64_tr_b16 v[66:67], v16 offset:37120
    s_mov_b32 exec_lo, 0
    v_mov_b32 v37, v33
    v_mov_b32 v33, 0
    s_mov_b32 exec_lo, -1
    v_mfma_f32_32x32x16_bf16 v[126:141], a[4:7], v[76:79], v[126:141]
    ds_read_b64_tr_b16 v[68:69], v16 offset:37888
    s_mov_b32 exec_lo, 0
    v_mov_b32 v38, v34
    v_mov_b32 v34, 0
    s_mov_b32 exec_lo, -1
    v_mfma_f32_32x32x16_bf16 v[142:157], a[116:119], v[76:79], v[142:157]
    ds_read_b64_tr_b16 v[70:71], v16 offset:38144
    ds_bpermute_b32 v20, v87, v24 offset:0
    ds_bpermute_b32 v21, v87, v24 offset:4
    ds_bpermute_b32 v22, v87, v24 offset:8
    ds_bpermute_b32 v23, v87, v24 offset:12
    s_waitcnt lgkmcnt(8)
    v_mfma_f32_32x32x16_bf16 v[126:141], a[8:11], v[56:59], v[126:141]
    s_addk_i32 s13, 6144
    buffer_load_dwordx4 v6, s[52:55], s13 offen offset:2048 lds
L_padF0:
    s_cbranch_execz L_retF
    ds_read_b64_tr_b16 v[72:73], v16 offset:38912
    v_mfma_f32_32x32x16_bf16 v[142:157], a[120:123], v[56:59], v[142:157]
    ds_read_b64_tr_b16 v[74:75], v16 offset:39168
    v_mfma_f32_32x32x16_bf16 v[126:141], a[12:15], v[60:63], v[126:141]
    ds_read_b64_tr_b16 v[76:77], v16 offset:39936
    v_mfma_f32_32x32x16_bf16 v[142:157], a[124:127], v[60:63], v[142:157]
    ds_read_b64_tr_b16 v[78:79], v16 offset:40192
    s_waitcnt lgkmcnt(8)
    v_mfma_f32_32x32x16_bf16 v[126:141], a[16:19], v[64:67], v[126:141]
    ds_read_b64_tr_b16 v[56:57], v16 offset:40960
    s_waitcnt vmcnt(5)
    v_cmp_ne_u32 vcc, s65, v43
    v_mfma_f32_32x32x16_bf16 v[142:157], a[128:131], v[64:67], v[142:157]
    s_addk_i32 s13, 6144
    buffer_load_dwordx4 v6, s[52:55], s13 offen offset:3072 lds
    ds_read_b64_tr_b16 v[58:59], v16 offset:41216
    v_mfma_f32_32x32x16_bf16 v[126:141], a[20:23], v[68:71], v[126:141]
    ds_read_b64_tr_b16 v[60:61], v16 offset:41984
    s_cbranch_vccnz L_s0_re
L_s0_ok:
    v_mov_b32 v43, 0
    v_mfma_f32_32x32x16_bf16 v[142:157], a[132:135], v[68:71], v[142:157]
    ds_read_b64_tr_b16 v[62:63], v16 offset:42240
    v_lshlrev_b32 v84, 16, v42
    v_and_b32 v85, 0xffff0000, v42
    v_mfma_f32_32x32x16_bf16 v[94:109], v[32:35], v[40:43], v[94:109]
    v_add_f32 v84, v84, v85
    v_rcp_f32 v85, v84
    v_mfma_f32_32x32x16_bf16 v[110:125], v[36:39], v[40:43], v[110:125]
    v_mul_f32 v40, v84, v84
    v_mul_f32 v41, 0xbfb8aa3b, v85
    s_waitcnt lgkmcnt(4)
    v_mfma_f32_32x32x16_bf16 v[126:141], a[24:27], v[72:75], v[126:141]
    ds_read_b64_tr_b16 v[64:65], v16 offset:43008
    v_mfma_f32_32x32x16_bf16 v[142:157], a[136:139], v[72:75], v[142:157]
    ds_read_b64_tr_b16 v[66:67], v16 offset:43264
    v_mfma_f32_32x32x16_bf16 v[126:141], a[28:31], v[76:79], v[126:141]
    ds_read_b64_tr_b16 v[68:69], v16 offset:44032
    s_add_u32 m0, s11, 131072
    v_mfma_f32_32x32x16_bf16 v[142:157], a[140:143], v[76:79], v[142:157]
    buffer_load_dwordx4 v2, s[44:47], s4 offen sc1 lds
    ds_read_b64_tr_b16 v[70:71], v16 offset:44288
    s_addk_i32 m0, 4096
    s_waitcnt lgkmcnt(4)
    v_mfma_f32_32x32x16_bf16 v[126:141], a[32:35], v[56:59], v[126:141]
    buffer_load_dwordx4 v2, s[44:47], s5 offen sc1 lds
    ds_read_b64_tr_b16 v[72:73], v16 offset:45056
    v_mul_f32 v80, v41, v94
    v_mul_f32 v81, v41, v95
    v_mul_f32 v82, v41, v96
    v_mfma_f32_32x32x16_bf16 v[142:157], a[144:147], v[56:59], v[142:157]
    ds_read_b64_tr_b16 v[74:75], v16 offset:45312
    s_addk_i32 m0, 4096
    v_mul_f32 v83, v41, v97
    v_exp_f32 v80, v80
    v_mul_f32 v94, v94, v110
    v_mfma_f32_32x32x16_bf16 v[126:141], a[36:39], v[60:63], v[126:141]
    buffer_load_dwordx4 v2, s[44:47], s6 offen sc1 lds
    ds_read_b64_tr_b16 v[76:77], v16 offset:46080
    s_addk_i32 m0, 4096
    v_exp_f32 v81, v81
    v_mfma_f32_32x32x16_bf16 v[142:157], a[148:151], v[60:63], v[142:157]
    buffer_load_dwordx4 v2, s[44:47], s7 offen sc1 lds
    ds_read_b64_tr_b16 v[78:79], v16 offset:46336
    v_mul_f32 v95, v95, v111
    v_mul_f32 v96, v96, v112
    s_waitcnt lgkmcnt(4)
    v_mfma_f32_32x32x16_bf16 v[126:141], a[40:43], v[64:67], v[126:141]
    ds_read_b64_tr_b16 v[56:57], v16 offset:47104
    s_addk_i32 m0, 4096
    v_exp_f32 v82, v82
    v_exp_f32 v83, v83
    v_mfma_f32_32x32x16_bf16 v[142:157], a[152:155], v[64:67], v[142:157]
    buffer_load_dwordx4 v2, s[44:47], s8 offen sc1 lds
    ds_read_b64_tr_b16 v[58:59], v16 offset:47360
    v_mul_f32 v97, v97, v113
    v_fma_f32 v80, v80, v40, v40
    v_fma_f32 v81, v81, v40, v40
    v_mfma_f32_32x32x16_bf16 v[126:141], a[44:47], v[68:71], v[126:141]
    ds_read_b64_tr_b16 v[60:61], v16 offset:48128
    s_addk_i32 m0, 4096
    v_rcp_f32 v80, v80
    v_rcp_f32 v81, v81
    v_mfma_f32_32x32x16_bf16 v[142:157], a[156:159], v[68:71], v[142:157]
    buffer_load_dwordx4 v2, s[44:47], s9 offen sc1 lds
    ds_read_b64_tr_b16 v[62:63], v16 offset:48384
    s_addk_i32 m0, 4096
    v_fma_f32 v82, v82, v40, v40
    s_waitcnt lgkmcnt(4)
    v_mfma_f32_32x32x16_bf16 v[126:141], a[48:51], v[72:75], v[126:141]
    buffer_load_dwordx4 v2, s[44:47], s10 offen sc1 lds
    ds_read_b64_tr_b16 v[64:65], v16 offset:49152
    v_rcp_f32 v82, v82
    v_fma_f32 v83, v83, v40, v40
    v_mfma_f32_32x32x16_bf16 v[142:157], a[160:163], v[72:75], v[142:157]
    ds_read_b64_tr_b16 v[66:67], v16 offset:49408
    v_add_u32 v2, 28672, v2
    v_rcp_f32 v83, v83
    v_mul_f32 v94, v94, v80
    v_mul_f32 v95, v95, v81
    v_mfma_f32_32x32x16_bf16 v[126:141], a[52:55], v[76:79], v[126:141]
    s_add_u32 m0, s12, 98304
    s_mul_i32 s13, s6, 14
    buffer_load_dwordx4 v6, s[52:55], s13 offen offset:0 lds
    ds_read_b64_tr_b16 v[68:69], v16 offset:50176
    v_mul_f32 v96, v96, v82
    v_mfma_f32_32x32x16_bf16 v[142:157], a[164:167], v[76:79], v[142:157]
    buffer_load_dwordx4 v[44:47], v5, s[44:47], s16 offen offset:512 sc1
    ds_read_b64_tr_b16 v[70:71], v16 offset:50432
    v_mul_f32 v97, v97, v83
    v_cvt_pk_bf16_f32 v86, v94, v95
    s_waitcnt lgkmcnt(4)
    v_mfma_f32_32x32x16_bf16 v[126:141], a[56:59], v[56:59], v[126:141]
    s_addk_i32 s13, 6144
    buffer_load_dwordx4 v6, s[52:55], s13 offen offset:1024 lds
    ds_read_b64_tr_b16 v[72:73], v16 offset:51200
    s_waitcnt vmcnt(10)
    ds_read_b64_tr_b16 v[190:191], v8 offset:0
    v_mfma_f32_32x32x16_bf16 v[142:157], a[168:171], v[56:59], v[142:157]
    ds_read_b64_tr_b16 v[74:75], v16 offset:51456
    ds_read_b64_tr_b16 v[192:193], v8 offset:1024
    ds_read_b64_tr_b16 v[194:195], v9 offset:0
    v_cvt_pk_bf16_f32 v87, v96, v97
    v_mul_f32 v80, v41, v98
    v_mul_f32 v81, v41, v99
    v_mfma_f32_32x32x16_bf16 v[126:141], a[60:63], v[60:63], v[126:141]
    s_addk_i32 s13, 6144
    buffer_load_dwordx4 v6, s[52:55], s13 offen offset:2048 lds
    ds_read_b64_tr_b16 v[76:77], v16 offset:52224
    ds_read_b64_tr_b16 v[196:197], v9 offset:1024
    v_mul_f32 v82, v41, v100
    v_mfma_f32_32x32x16_bf16 v[142:157], a[172:175], v[60:63], v[142:157]
    ds_read_b64_tr_b16 v[78:79], v16 offset:52480
    ds_read_b64_tr_b16 v[198:199], v10 offset:0
    v_mul_f32 v83, v41, v101
    v_exp_f32 v80, v80
    s_waitcnt lgkmcnt(9)
    v_mfma_f32_32x32x16_bf16 v[126:141], a[64:67], v[64:67], v[126:141]
    ds_read_b64_tr_b16 v[56:57], v16 offset:53248
    ds_read_b64_tr_b16 v[200:201], v10 offset:1024
    v_mul_f32 v98, v98, v114
    v_exp_f32 v81, v81
    v_mul_f32 v99, v99, v115
    v_mfma_f32_32x32x16_bf16 v[142:157], a[176:179], v[64:67], v[142:157]
    s_addk_i32 s13, 6144
    buffer_load_dwordx4 v6, s[52:55], s13 offen offset:3072 lds
    ds_read_b64_tr_b16 v[58:59], v16 offset:53504
    ds_read_b64_tr_b16 v[202:203], v11 offset:0
    v_mul_f32 v100, v100, v116
    v_mfma_f32_32x32x16_bf16 v[126:141], a[68:71], v[68:71], v[126:141]
    ds_read_b64_tr_b16 v[60:61], v16 offset:54272
    ds_read_b64_tr_b16 v[204:205], v11 offset:1024
    v_exp_f32 v82, v82
    v_exp_f32 v83, v83
    v_mfma_f32_32x32x16_bf16 v[142:157], a[180:183], v[68:71], v[142:157]
    s_add_u32 m0, s12, 102400
    s_addk_i32 s13, 10240
    buffer_load_dwordx4 v6, s[52:55], s13 offen offset:0 lds
    ds_read_b64_tr_b16 v[62:63], v16 offset:54528
    s_waitcnt lgkmcnt(8)
    v_mfma_f32_32x32x16_bf16 v[126:141], a[72:75], v[72:75], v[126:141]
    ds_read_b64_tr_b16 v[64:65], v16 offset:55296
    ds_read_b64_tr_b16 v[206:207], v8 offset:4096
    ds_read_b64_tr_b16 v[208:209], v8 offset:5120
    ds_read_b64_tr_b16 v[210:211], v9 offset:4096
    v_mul_f32 v101, v101, v117
    v_fma_f32 v80, v80, v40, v40
    v_mfma_f32_32x32x16_bf16 v[142:157], a[184:187], v[72:75], v[142:157]
    s_addk_i32 s13, 6144
    buffer_load_dwordx4 v6, s[52:55], s13 offen offset:1024 lds
    ds_read_b64_tr_b16 v[66:67], v16 offset:55552
    ds_read_b64_tr_b16 v[212:213], v9 offset:5120
    v_fma_f32 v81, v81, v40, v40
    v_mfma_f32_32x32x16_bf16 v[126:141], a[76:79], v[76:79], v[126:141]
    ds_read_b64_tr_b16 v[68:69], v16 offset:56320
    ds_read_b64_tr_b16 v[214:215], v10 offset:4096
    v_rcp_f32 v80, v80
    v_rcp_f32 v81, v81
    v_mfma_f32_32x32x16_bf16 v[142:157], a[188:191], v[76:79], v[142:157]
    ds_read_b64_tr_b16 v[70:71], v16 offset:56576
    ds_read_b64_tr_b16 v[216:217], v10 offset:5120
    v_fma_f32 v82, v82, v40, v40
    v_rcp_f32 v82, v82
    s_waitcnt lgkmcnt(10)
    v_mfma_f32_32x32x16_bf16 v[126:141], a[80:83], v[56:59], v[126:141]
    s_addk_i32 s13, 6144
    buffer_load_dwordx4 v6, s[52:55], s13 offen offset:2048 lds
    ds_read_b64_tr_b16 v[72:73], v16 offset:57344
    ds_read_b64_tr_b16 v[218:219], v11 offset:4096
    v_fma_f32 v83, v83, v40, v40
    v_mfma_f32_32x32x16_bf16 v[142:157], a[192:195], v[56:59], v[142:157]
    ds_read_b64_tr_b16 v[74:75], v16 offset:57600
    ds_read_b64_tr_b16 v[220:221], v11 offset:5120
    v_rcp_f32 v83, v83
    v_mul_f32 v98, v98, v80
    v_mul_f32 v99, v99, v81
    v_mfma_f32_32x32x16_bf16 v[126:141], a[84:87], v[60:63], v[126:141]
    s_addk_i32 s13, 6144
    buffer_load_dwordx4 v6, s[52:55], s13 offen offset:3072 lds
    ds_read_b64_tr_b16 v[76:77], v16 offset:58368
    v_mul_f32 v100, v100, v82
    v_mul_f32 v101, v101, v83
    v_mfma_f32_32x32x16_bf16 v[142:157], a[196:199], v[60:63], v[142:157]
    ds_read_b64_tr_b16 v[78:79], v16 offset:58624
    v_cvt_pk_bf16_f32 v88, v98, v99
    v_cvt_pk_bf16_f32 v89, v100, v101
    s_waitcnt lgkmcnt(7)
    v_mfma_f32_32x32x16_bf16 v[126:141], a[88:91], v[64:67], v[126:141]
    buffer_store_dwordx4 v[86:89], v3, s[44:47], s17 offen offset:0 sc1
    ds_read_b64_tr_b16 v[56:57], v16 offset:59392
    v_mul_f32 v80, v41, v102
    v_mul_f32 v81, v41, v103
    v_mul_f32 v82, v41, v104
    v_mul_f32 v83, v41, v105
    v_mfma_f32_32x32x16_bf16 v[142:157], a[200:203], v[64:67], v[142:157]
    s_add_u32 m0, s12, 0
    s_mul_i32 s13, s9, 14
    buffer_load_dwordx4 v6, s[52:55], s13 offen offset:0 lds
    ds_read_b64_tr_b16 v[58:59], v16 offset:59648
    v_mul_f32 v102, v102, v118
    v_mfma_f32_32x32x16_bf16 v[126:141], a[92:95], v[68:71], v[126:141]
    ds_read_b64_tr_b16 v[60:61], v16 offset:60416
    v_exp_f32 v80, v80
    v_exp_f32 v81, v81
    v_mul_f32 v103, v103, v119
    v_mfma_f32_32x32x16_bf16 v[142:157], a[204:207], v[68:71], v[142:157]
    s_addk_i32 s13, 6144
    buffer_load_dwordx4 v6, s[52:55], s13 offen offset:1024 lds
    ds_read_b64_tr_b16 v[62:63], v16 offset:60672
    v_mul_f32 v104, v104, v120
    s_waitcnt lgkmcnt(4)
    v_mfma_f32_32x32x16_bf16 v[126:141], a[96:99], v[72:75], v[126:141]
    v_exp_f32 v82, v82
    v_exp_f32 v83, v83
    v_mul_f32 v105, v105, v121
    v_fma_f32 v80, v80, v40, v40
    v_mfma_f32_32x32x16_bf16 v[142:157], a[208:211], v[72:75], v[142:157]
    s_waitcnt vmcnt(12)
    s_waitcnt lgkmcnt(0)
    s_barrier
    ds_read_b64_tr_b16 v[64:65], v18 offset:0
    ds_read_b64_tr_b16 v[66:67], v18 offset:256
    v_mfma_f32_32x32x16_bf16 v[126:141], a[100:103], v[76:79], v[126:141]
    s_addk_i32 s13, 6144
    buffer_load_dwordx4 v6, s[52:55], s13 offen offset:2048 lds
    ds_read_b64_tr_b16 v[68:69], v18 offset:1024
    v_rcp_f32 v80, v80
    v_mfma_f32_32x32x16_bf16 v[142:157], a[212:215], v[76:79], v[142:157]
    ds_read_b64_tr_b16 v[70:71], v18 offset:1280
    v_fma_f32 v81, v81, v40, v40
    v_rcp_f32 v81, v81
    v_fma_f32 v82, v82, v40, v40
    v_mfma_f32_32x32x16_bf16 v[126:141], a[104:107], v[56:59], v[126:141]
    s_addk_i32 s13, 6144
    buffer_load_dwordx4 v6, s[52:55], s13 offen offset:3072 lds
    ds_read_b64_tr_b16 v[72:73], v18 offset:2048
    v_rcp_f32 v82, v82
    v_mfma_f32_32x32x16_bf16 v[142:157], a[216:219], v[56:59], v[142:157]
    ds_read_b64_tr_b16 v[74:75], v18 offset:2304
    v_fma_f32 v83, v83, v40, v40
    v_rcp_f32 v83, v83
    v_mul_f32 v102, v102, v80
    v_mul_f32 v103, v103, v81
    v_mfma_f32_32x32x16_bf16 v[126:141], a[108:111], v[60:63], v[126:141]
    s_add_u32 m0, s12, 4096
    s_addk_i32 s13, 10240
    buffer_load_dwordx4 v6, s[52:55], s13 offen offset:0 lds
    ds_read_b64_tr_b16 v[76:77], v18 offset:3072
    v_mul_f32 v104, v104, v82
    v_mfma_f32_32x32x16_bf16 v[142:157], a[220:223], v[60:63], v[142:157]
    ds_read_b64_tr_b16 v[78:79], v18 offset:3328
    v_mul_f32 v105, v105, v83
    v_cvt_pk_bf16_f32 v90, v102, v103
    v_cvt_pk_bf16_f32 v91, v104, v105
    v_mul_f32 v80, v41, v106
    s_waitcnt lgkmcnt(4)
    v_mfma_f32_32x32x16_bf16 v[158:173], a[0:3], v[64:67], 0
    s_addk_i32 s13, 6144
    buffer_load_dwordx4 v6, s[52:55], s13 offen offset:1024 lds
    ds_read_b64_tr_b16 v[56:57], v18 offset:4096
    v_mul_f32 v81, v41, v107
    v_mul_f32 v82, v41, v108
    v_mfma_f32_32x32x16_bf16 v[174:189], a[112:115], v[64:67], 0
    ds_read_b64_tr_b16 v[58:59], v18 offset:4352
    v_mul_f32 v83, v41, v109
    v_exp_f32 v80, v80
    v_mul_f32 v106, v106, v122
    v_mul_f32 v107, v107, v123
    v_mfma_f32_32x32x16_bf16 v[158:173], a[4:7], v[68:71], v[158:173]
    ds_read_b64_tr_b16 v[60:61], v18 offset:5120
    s_waitcnt vmcnt(7)
    ds_read_b64_tr_b16 v[222:223], v8 offset:32768
    ds_read_b64_tr_b16 v[224:225], v8 offset:33792
    v_exp_f32 v81, v81
    v_mfma_f32_32x32x16_bf16 v[174:189], a[116:119], v[68:71], v[174:189]
    s_addk_i32 s13, 6144
    buffer_load_dwordx4 v6, s[52:55], s13 offen offset:2048 lds
    ds_read_b64_tr_b16 v[62:63], v18 offset:5376
    ds_read_b64_tr_b16 v[226:227], v9 offset:32768
    s_waitcnt lgkmcnt(7)
    v_mfma_f32_32x32x16_bf16 v[158:173], a[8:11], v[72:75], v[158:173]
    ds_read_b64_tr_b16 v[64:65], v18 offset:6144
    ds_read_b64_tr_b16 v[228:229], v9 offset:33792
    v_exp_f32 v82, v82
    v_mul_f32 v108, v108, v124
    v_mul_f32 v109, v109, v125
    v_mfma_f32_32x32x16_bf16 v[174:189], a[120:123], v[72:75], v[174:189]
    s_addk_i32 s13, 6144
    buffer_load_dwordx4 v6, s[52:55], s13 offen offset:3072 lds
    ds_read_b64_tr_b16 v[66:67], v18 offset:6400
    ds_read_b64_tr_b16 v[230:231], v10 offset:32768
    v_fma_f32 v80, v80, v40, v40
    v_mfma_f32_32x32x16_bf16 v[158:173], a[12:15], v[76:79], v[158:173]
    ds_read_b64_tr_b16 v[68:69], v18 offset:7168
    ds_read_b64_tr_b16 v[232:233], v10 offset:33792
    ds_read_b64_tr_b16 v[234:235], v11 offset:32768
    v_exp_f32 v83, v83
    v_fma_f32 v81, v81, v40, v40
    v_mfma_f32_32x32x16_bf16 v[174:189], a[124:127], v[76:79], v[174:189]
    ds_read_b64_tr_b16 v[70:71], v18 offset:7424
    ds_read_b64_tr_b16 v[236:237], v11 offset:33792
    v_rcp_f32 v80, v80
    v_fma_f32 v82, v82, v40, v40
    s_waitcnt lgkmcnt(10)
    v_mfma_f32_32x32x16_bf16 v[158:173], a[16:19], v[56:59], v[158:173]
    ds_read_b64_tr_b16 v[72:73], v18 offset:8192
    s_add_u32 m0, s11, 65536
    v_rcp_f32 v81, v81
    v_rcp_f32 v82, v82
    v_mfma_f32_32x32x16_bf16 v[174:189], a[128:131], v[56:59], v[174:189]
    buffer_load_dwordx4 v2, s[44:47], s4 offen sc1 lds
    ds_read_b64_tr_b16 v[74:75], v18 offset:8448
    ds_read_b64_tr_b16 v[238:239], v8 offset:36864
    s_addk_i32 m0, 4096
    v_fma_f32 v83, v83, v40, v40
    v_mfma_f32_32x32x16_bf16 v[158:173], a[20:23], v[60:63], v[158:173]
    ds_read_b64_tr_b16 v[76:77], v18 offset:9216
    ds_read_b64_tr_b16 v[240:241], v8 offset:37888
    v_rcp_f32 v83, v83
    v_mul_f32 v106, v106, v80
    v_mul_f32 v107, v107, v81
    v_mfma_f32_32x32x16_bf16 v[174:189], a[132:135], v[60:63], v[174:189]
    buffer_load_dwordx4 v2, s[44:47], s5 offen sc1 lds
    ds_read_b64_tr_b16 v[78:79], v18 offset:9472
    ds_read_b64_tr_b16 v[242:243], v9 offset:36864
    ds_read_b64_tr_b16 v[244:245], v9 offset:37888
    s_waitcnt lgkmcnt(9)
    v_mfma_f32_32x32x16_bf16 v[158:173], a[24:27], v[64:67], v[158:173]
    buffer_load_dwordx4 v[48:51], v5, s[44:47], s16 offen offset:1024 sc1
    ds_read_b64_tr_b16 v[56:57], v18 offset:10240
    s_addk_i32 m0, 4096
    v_mul_f32 v108, v108, v82
    v_mul_f32 v109, v109, v83
    v_mfma_f32_32x32x16_bf16 v[174:189], a[136:139], v[64:67], v[174:189]
    ds_read_b64_tr_b16 v[58:59], v18 offset:10496
    ds_read_b64_tr_b16 v[246:247], v10 offset:36864
    v_cvt_pk_bf16_f32 v92, v106, v107
    v_cvt_pk_bf16_f32 v93, v108, v109
    v_mfma_f32_32x32x16_bf16 v[158:173], a[28:31], v[68:71], v[158:173]
    buffer_store_dwordx4 v[90:93], v3, s[44:47], s17 offen offset:1024 sc1
    buffer_load_dwordx4 v2, s[44:47], s6 offen sc1 lds
    ds_read_b64_tr_b16 v[60:61], v18 offset:11264
    s_addk_i32 m0, 4096
    s_add_u32 s17, s17, 114688
    v_mfma_f32_32x32x16_bf16 v[174:189], a[140:143], v[68:71], v[174:189]
    ds_read_b64_tr_b16 v[62:63], v18 offset:11520
    ds_read_b64_tr_b16 v[248:249], v10 offset:37888
    v_cmp_ne_u32 vcc, s65, v47
    s_waitcnt lgkmcnt(8)
    v_mfma_f32_32x32x16_bf16 v[158:173], a[32:35], v[72:75], v[158:173]
    buffer_load_dwordx4 v2, s[44:47], s7 offen sc1 lds
    ds_read_b64_tr_b16 v[64:65], v18 offset:12288
    ds_read_b64_tr_b16 v[250:251], v11 offset:36864
    s_addk_i32 m0, 4096
    v_mfma_f32_32x32x16_bf16 v[174:189], a[144:147], v[72:75], v[174:189]
    ds_read_b64_tr_b16 v[66:67], v18 offset:12544
    ds_read_b64_tr_b16 v[252:253], v11 offset:37888
    v_xor_b32 v8, 0, v7
    s_cbranch_vccnz L_s1_re
L_s1_ok:
    v_mfma_f32_32x32x16_bf16 v[158:173], a[36:39], v[76:79], v[158:173]
    buffer_load_dwordx4 v2, s[44:47], s8 offen sc1 lds
    ds_read_b64_tr_b16 v[68:69], v18 offset:13312
    v_xor_b32 v9, 32, v7
    s_addk_i32 m0, 4096
    v_mov_b32 v47, 0
    v_mfma_f32_32x32x16_bf16 v[174:189], a[148:151], v[76:79], v[174:189]
    buffer_load_dwordx4 v2, s[44:47], s9 offen sc1 lds
    ds_read_b64_tr_b16 v[70:71], v18 offset:13568
    v_xor_b32 v10, 64, v7
    s_addk_i32 m0, 4096
    s_waitcnt lgkmcnt(7)
    v_mfma_f32_32x32x16_bf16 v[158:173], a[40:43], v[56:59], v[158:173]
    ds_read_b64_tr_b16 v[72:73], v18 offset:14336
    v_xor_b32 v11, 96, v7
    v_lshlrev_b32 v84, 16, v46
    v_and_b32 v85, 0xffff0000, v46
    v_mfma_f32_32x32x16_bf16 v[126:141], v[32:35], v[44:47], v[126:141]
    v_add_f32 v84, v84, v85
    v_rcp_f32 v85, v84
    v_mfma_f32_32x32x16_bf16 v[142:157], v[36:39], v[44:47], v[142:157]
    v_mul_f32 v44, v84, v84
    v_mul_f32 v45, 0xbfb8aa3b, v85
    v_mfma_f32_32x32x16_bf16 v[174:189], a[152:155], v[56:59], v[174:189]
    buffer_load_dwordx4 v2, s[44:47], s10 offen sc1 lds
    ds_read_b64_tr_b16 v[74:75], v18 offset:14592
    v_add_u32 v2, 28672, v2
    v_mfma_f32_32x32x16_bf16 v[158:173], a[44:47], v[60:63], v[158:173]
    s_add_u32 m0, s12, 32768
    s_mul_i32 s13, s7, 14
    buffer_load_dwordx4 v6, s[52:55], s13 offen offset:0 lds
    ds_read_b64_tr_b16 v[76:77], v18 offset:15360
    v_mfma_f32_32x32x16_bf16 v[174:189], a[156:159], v[60:63], v[174:189]
    s_addk_i32 s13, 6144
    buffer_load_dwordx4 v6, s[52:55], s13 offen offset:1024 lds
    ds_read_b64_tr_b16 v[78:79], v18 offset:15616
    v_mul_f32 v80, v45, v126
    s_waitcnt lgkmcnt(4)
    v_mfma_f32_32x32x16_bf16 v[158:173], a[48:51], v[64:67], v[158:173]
    ds_read_b64_tr_b16 v[56:57], v18 offset:16384
    v_mul_f32 v81, v45, v127
    v_mul_f32 v82, v45, v128
    v_mul_f32 v83, v45, v129
    v_exp_f32 v80, v80
    v_mfma_f32_32x32x16_bf16 v[174:189], a[160:163], v[64:67], v[174:189]
    s_addk_i32 s13, 6144
    buffer_load_dwordx4 v6, s[52:55], s13 offen offset:2048 lds
    ds_read_b64_tr_b16 v[58:59], v18 offset:16640
    v_mul_f32 v126, v126, v142
    v_mul_f32 v127, v127, v143
    v_mfma_f32_32x32x16_bf16 v[158:173], a[52:55], v[68:71], v[158:173]
    ds_read_b64_tr_b16 v[60:61], v18 offset:17408
    v_exp_f32 v81, v81
    v_exp_f32 v82, v82
    v_mul_f32 v128, v128, v144
    v_mfma_f32_32x32x16_bf16 v[174:189], a[164:167], v[68:71], v[174:189]
    s_addk_i32 s13, 6144
    buffer_load_dwordx4 v6, s[52:55], s13 offen offset:3072 lds
    ds_read_b64_tr_b16 v[62:63], v18 offset:17664
    v_mul_f32 v129, v129, v145
    s_waitcnt lgkmcnt(4)
    v_mfma_f32_32x32x16_bf16 v[158:173], a[56:59], v[72:75], v[158:173]
    ds_read_b64_tr_b16 v[64:65], v18 offset:18432
    v_exp_f32 v83, v83
    v_fma_f32 v80, v80, v44, v44
    v_rcp_f32 v80, v80
    v_mfma_f32_32x32x16_bf16 v[174:189], a[168:171], v[72:75], v[174:189]
    ds_read_b64_tr_b16 v[66:67], v18 offset:18688
    v_fma_f32 v81, v81, v44, v44
    v_rcp_f32 v81, v81
    v_fma_f32 v82, v82, v44, v44
    v_fma_f32 v83, v83, v44, v44
    v_mfma_f32_32x32x16_bf16 v[158:173], a[60:63], v[76:79], v[158:173]
    s_add_u32 m0, s12, 36864
    s_addk_i32 s13, 10240
    buffer_load_dwordx4 v6, s[52:55], s13 offen offset:0 lds
    ds_read_b64_tr_b16 v[68:69], v18 offset:19456
    v_mul_f32 v126, v126, v80
    v_mfma_f32_32x32x16_bf16 v[174:189], a[172:175], v[76:79], v[174:189]
    buffer_load_dwordx4 v[52:55], v5, s[44:47], s16 offen offset:1536 sc1
    ds_read_b64_tr_b16 v[70:71], v18 offset:19712
    v_rcp_f32 v82, v82
    s_waitcnt lgkmcnt(4)
    v_mfma_f32_32x32x16_bf16 v[158:173], a[64:67], v[56:59], v[158:173]
    ds_read_b64_tr_b16 v[72:73], v18 offset:20480
    v_rcp_f32 v83, v83
    v_mul_f32 v127, v127, v81
    v_mul_f32 v128, v128, v82
    v_mul_f32 v129, v129, v83
    v_mfma_f32_32x32x16_bf16 v[174:189], a[176:179], v[56:59], v[174:189]
    s_addk_i32 s13, 6144
    buffer_load_dwordx4 v6, s[52:55], s13 offen offset:1024 lds
    ds_read_b64_tr_b16 v[74:75], v18 offset:20736
    v_cvt_pk_bf16_f32 v86, v126, v127
    v_cvt_pk_bf16_f32 v87, v128, v129
    v_mfma_f32_32x32x16_bf16 v[158:173], a[68:71], v[60:63], v[158:173]
    ds_read_b64_tr_b16 v[76:77], v18 offset:21504
    s_waitcnt vmcnt(12)
    v_mfma_f32_32x32x16_bf16 v[174:189], a[180:183], v[60:63], v[174:189]
    s_mov_b64 exec, 1
    buffer_store_dword v4, off, s[44:47], s14 sc1
    s_mov_b64 exec, -1
    ds_read_b64_tr_b16 v[78:79], v18 offset:21760
    s_add_u32 s14, s14, 1024
    s_waitcnt lgkmcnt(4)
    v_mfma_f32_32x32x16_bf16 v[158:173], a[72:75], v[64:67], v[158:173]
    s_addk_i32 s13, 6144
    buffer_load_dwordx4 v6, s[52:55], s13 offen offset:2048 lds
    ds_read_b64_tr_b16 v[56:57], v18 offset:22528
    v_mul_f32 v80, v45, v130
    v_mul_f32 v81, v45, v131
    v_mfma_f32_32x32x16_bf16 v[174:189], a[184:187], v[64:67], v[174:189]
    ds_read_b64_tr_b16 v[58:59], v18 offset:22784
    v_mul_f32 v82, v45, v132
    v_mul_f32 v83, v45, v133
    v_exp_f32 v80, v80
    v_mul_f32 v130, v130, v146
    v_mfma_f32_32x32x16_bf16 v[158:173], a[76:79], v[68:71], v[158:173]
    s_addk_i32 s13, 6144
    buffer_load_dwordx4 v6, s[52:55], s13 offen offset:3072 lds
    ds_read_b64_tr_b16 v[60:61], v18 offset:23552
    v_exp_f32 v81, v81
    v_mfma_f32_32x32x16_bf16 v[174:189], a[188:191], v[68:71], v[174:189]
    ds_read_b64_tr_b16 v[62:63], v18 offset:23808
    v_mul_f32 v131, v131, v147
    v_exp_f32 v82, v82
    v_mul_f32 v132, v132, v148
    s_waitcnt lgkmcnt(4)
    v_mfma_f32_32x32x16_bf16 v[158:173], a[80:83], v[72:75], v[158:173]
    ds_read_b64_tr_b16 v[64:65], v18 offset:24576
    v_exp_f32 v83, v83
    v_mul_f32 v133, v133, v149
    v_fma_f32 v80, v80, v44, v44
    v_fma_f32 v81, v81, v44, v44
    v_mfma_f32_32x32x16_bf16 v[174:189], a[192:195], v[72:75], v[174:189]
    s_add_u32 m0, s12, 98304
    s_mul_i32 s13, s8, 14
    buffer_load_dwordx4 v6, s[52:55], s13 offen offset:0 lds
    ds_read_b64_tr_b16 v[66:67], v18 offset:24832
    v_fma_f32 v82, v82, v44, v44
    v_mfma_f32_32x32x16_bf16 v[158:173], a[84:87], v[76:79], v[158:173]
    ds_read_b64_tr_b16 v[68:69], v18 offset:25600
    v_rcp_f32 v80, v80
    v_rcp_f32 v81, v81
    v_fma_f32 v83, v83, v44, v44
    v_mfma_f32_32x32x16_bf16 v[174:189], a[196:199], v[76:79], v[174:189]
    s_addk_i32 s13, 6144
    buffer_load_dwordx4 v6, s[52:55], s13 offen offset:1024 lds
    ds_read_b64_tr_b16 v[70:71], v18 offset:25856
    v_mul_f32 v130, v130, v80
    s_waitcnt lgkmcnt(4)
    v_mfma_f32_32x32x16_bf16 v[158:173], a[88:91], v[56:59], v[158:173]
    ds_read_b64_tr_b16 v[72:73], v18 offset:26624
    v_rcp_f32 v82, v82
    v_rcp_f32 v83, v83
    v_mul_f32 v131, v131, v81
    v_mfma_f32_32x32x16_bf16 v[174:189], a[200:203], v[56:59], v[174:189]
    ds_read_b64_tr_b16 v[74:75], v18 offset:26880
    v_mul_f32 v132, v132, v82
    v_mul_f32 v133, v133, v83
    v_cvt_pk_bf16_f32 v88, v130, v131
    v_cvt_pk_bf16_f32 v89, v132, v133
    v_mfma_f32_32x32x16_bf16 v[158:173], a[92:95], v[60:63], v[158:173]
    buffer_store_dwordx4 v[86:89], v3, s[44:47], s17 offen offset:0 sc1
    s_addk_i32 s13, 6144
    buffer_load_dwordx4 v6, s[52:55], s13 offen offset:2048 lds
    ds_read_b64_tr_b16 v[76:77], v18 offset:27648
    v_mul_f32 v80, v45, v134
    v_mfma_f32_32x32x16_bf16 v[174:189], a[204:207], v[60:63], v[174:189]
    ds_read_b64_tr_b16 v[78:79], v18 offset:27904
    v_mul_f32 v81, v45, v135
    v_mul_f32 v82, v45, v136
    v_mul_f32 v83, v45, v137
    v_mul_f32 v134, v134, v150
    s_waitcnt lgkmcnt(4)
    v_mfma_f32_32x32x16_bf16 v[158:173], a[96:99], v[64:67], v[158:173]
    s_addk_i32 s13, 6144
    buffer_load_dwordx4 v6, s[52:55], s13 offen offset:3072 lds
    v_exp_f32 v80, v80
    v_mul_f32 v135, v135, v151
    v_mfma_f32_32x32x16_bf16 v[174:189], a[208:211], v[64:67], v[174:189]
    s_waitcnt vmcnt(15)
    s_waitcnt lgkmcnt(0)
    s_barrier
    ds_read_b64_tr_b16 v[56:57], v17 offset:0
    ds_read_b64_tr_b16 v[58:59], v17 offset:256
    v_mfma_f32_32x32x16_bf16 v[158:173], a[100:103], v[68:71], v[158:173]
    ds_read_b64_tr_b16 v[60:61], v17 offset:1024
    v_exp_f32 v81, v81
    v_exp_f32 v82, v82
    v_mul_f32 v136, v136, v152
    v_mfma_f32_32x32x16_bf16 v[174:189], a[212:215], v[68:71], v[174:189]
    s_add_u32 m0, s12, 102400
    s_addk_i32 s13, 10240
    buffer_load_dwordx4 v6, s[52:55], s13 offen offset:0 lds
    ds_read_b64_tr_b16 v[62:63], v17 offset:1280
    v_mfma_f32_32x32x16_bf16 v[158:173], a[104:107], v[72:75], v[158:173]
    ds_read_b64_tr_b16 v[64:65], v17 offset:2048
    v_exp_f32 v83, v83
    v_mul_f32 v137, v137, v153
    v_fma_f32 v80, v80, v44, v44
    v_fma_f32 v81, v81, v44, v44
    v_mfma_f32_32x32x16_bf16 v[174:189], a[216:219], v[72:75], v[174:189]
    ds_read_b64_tr_b16 v[66:67], v17 offset:2304
    v_rcp_f32 v80, v80
    v_rcp_f32 v81, v81
    v_fma_f32 v82, v82, v44, v44
    v_mfma_f32_32x32x16_bf16 v[158:173], a[108:111], v[76:79], v[158:173]
    s_addk_i32 s13, 6144
    buffer_load_dwordx4 v6, s[52:55], s13 offen offset:1024 lds
    ds_read_b64_tr_b16 v[68:69], v17 offset:3072
    v_rcp_f32 v82, v82
    v_mfma_f32_32x32x16_bf16 v[174:189], a[220:223], v[76:79], v[174:189]
    ds_read_b64_tr_b16 v[70:71], v17 offset:3328
    v_fma_f32 v83, v83, v44, v44
    v_rcp_f32 v83, v83
    v_mul_f32 v134, v134, v80
    s_waitcnt lgkmcnt(4)
    v_mfma_f32_32x32x16_bf16 v[94:109], a[0:3], v[56:59], 0
    s_addk_i32 s13, 6144
    buffer_load_dwordx4 v6, s[52:55], s13 offen offset:2048 lds
    ds_read_b64_tr_b16 v[72:73], v17 offset:4096
    v_mul_f32 v135, v135, v81
    v_mul_f32 v136, v136, v82
    v_mfma_f32_32x32x16_bf16 v[110:125], a[112:115], v[56:59], 0
    ds_read_b64_tr_b16 v[74:75], v17 offset:4352
    v_mul_f32 v137, v137, v83
    v_cvt_pk_bf16_f32 v90, v134, v135
    v_cvt_pk_bf16_f32 v91, v136, v137
    v_mul_f32 v80, v45, v138
    v_mul_f32 v81, v45, v139
    v_mfma_f32_32x32x16_bf16 v[94:109], a[4:7], v[60:63], v[94:109]
    ds_read_b64_tr_b16 v[76:77], v17 offset:5120
    v_mul_f32 v82, v45, v140
    v_mul_f32 v83, v45, v141
    v_exp_f32 v80, v80
    v_mul_f32 v138, v138, v154
    v_mfma_f32_32x32x16_bf16 v[110:125], a[116:119], v[60:63], v[110:125]
    s_addk_i32 s13, 6144
    buffer_load_dwordx4 v6, s[52:55], s13 offen offset:3072 lds
    ds_read_b64_tr_b16 v[78:79], v17 offset:5376
    v_mul_f32 v139, v139, v155
    s_waitcnt lgkmcnt(4)
    v_mfma_f32_32x32x16_bf16 v[94:109], a[8:11], v[64:67], v[94:109]
    ds_read_b64_tr_b16 v[56:57], v17 offset:6144
    v_exp_f32 v81, v81
    v_exp_f32 v82, v82
    v_mul_f32 v140, v140, v156
    v_mfma_f32_32x32x16_bf16 v[110:125], a[120:123], v[64:67], v[110:125]
    ds_read_b64_tr_b16 v[58:59], v17 offset:6400
    v_exp_f32 v83, v83
    v_mul_f32 v141, v141, v157
    v_fma_f32 v80, v80, v44, v44
    v_fma_f32 v81, v81, v44, v44
    v_mfma_f32_32x32x16_bf16 v[94:109], a[12:15], v[68:71], v[94:109]
    ds_read_b64_tr_b16 v[60:61], v17 offset:7168
    v_rcp_f32 v80, v80
    v_rcp_f32 v81, v81
    v_fma_f32 v82, v82, v44, v44
    v_mfma_f32_32x32x16_bf16 v[110:125], a[124:127], v[68:71], v[110:125]
    ds_read_b64_tr_b16 v[62:63], v17 offset:7424
L_padF1:
    s_cbranch_execz L_retF
    v_rcp_f32 v82, v82
    v_fma_f32 v83, v83, v44, v44
    v_mul_f32 v138, v138, v80
    s_waitcnt lgkmcnt(4)
    v_mfma_f32_32x32x16_bf16 v[94:109], a[16:19], v[72:75], v[94:109]
    ds_read_b64_tr_b16 v[64:65], v17 offset:8192
    v_rcp_f32 v83, v83
    v_mul_f32 v139, v139, v81
    v_mul_f32 v140, v140, v82
    v_mul_f32 v141, v141, v83
    v_mfma_f32_32x32x16_bf16 v[110:125], a[128:131], v[72:75], v[110:125]
    ds_read_b64_tr_b16 v[66:67], v17 offset:8448
    v_cvt_pk_bf16_f32 v92, v138, v139
    v_cvt_pk_bf16_f32 v93, v140, v141
    v_mfma_f32_32x32x16_bf16 v[94:109], a[20:23], v[76:79], v[94:109]
    buffer_store_dwordx4 v[90:93], v3, s[44:47], s17 offen offset:1024 sc1
    ds_read_b64_tr_b16 v[68:69], v17 offset:9216
    s_add_u32 s17, s17, 114688
    v_cmp_ne_u32 vcc, s65, v51
    v_mfma_f32_32x32x16_bf16 v[110:125], a[132:135], v[76:79], v[110:125]
    ds_read_b64_tr_b16 v[70:71], v17 offset:9472
    s_cbranch_vccnz L_s2_re
L_s2_ok:
    s_waitcnt lgkmcnt(4)
    v_mfma_f32_32x32x16_bf16 v[94:109], a[24:27], v[56:59], v[94:109]
    s_add_u32 m0, s12, 131072
    s_mul_i32 s13, s10, 14
    buffer_load_dwordx4 v6, s[52:55], s13 offen offset:0 lds
    ds_read_b64_tr_b16 v[72:73], v17 offset:10240
    v_mov_b32 v51, 0
    v_mfma_f32_32x32x16_bf16 v[110:125], a[136:139], v[56:59], v[110:125]
    ds_read_b64_tr_b16 v[74:75], v17 offset:10496
    v_lshlrev_b32 v84, 16, v50
    v_and_b32 v85, 0xffff0000, v50
    v_mfma_f32_32x32x16_bf16 v[158:173], v[32:35], v[48:51], v[158:173]
    v_add_f32 v84, v84, v85
    v_rcp_f32 v85, v84
    v_mfma_f32_32x32x16_bf16 v[174:189], v[36:39], v[48:51], v[174:189]
    v_mul_f32 v48, v84, v84
    v_mul_f32 v49, 0xbfb8aa3b, v85
    v_mfma_f32_32x32x16_bf16 v[94:109], a[28:31], v[60:63], v[94:109]
    s_addk_i32 s13, 6144
    buffer_load_dwordx4 v6, s[52:55], s13 offen offset:1024 lds
    ds_read_b64_tr_b16 v[76:77], v17 offset:11264
    v_mfma_f32_32x32x16_bf16 v[110:125], a[140:143], v[60:63], v[110:125]
    ds_read_b64_tr_b16 v[78:79], v17 offset:11520
    s_waitcnt lgkmcnt(4)
    v_mfma_f32_32x32x16_bf16 v[94:109], a[32:35], v[64:67], v[94:109]
    ds_read_b64_tr_b16 v[56:57], v17 offset:12288
    v_mul_f32 v80, v49, v158
    v_mul_f32 v81, v49, v159
    v_mul_f32 v82, v49, v160
    v_mul_f32 v83, v49, v161
    v_mul_f32 v158, v158, v174
    v_mfma_f32_32x32x16_bf16 v[110:125], a[144:147], v[64:67], v[110:125]
    s_addk_i32 s13, 6144
    buffer_load_dwordx4 v6, s[52:55], s13 offen offset:2048 lds
    ds_read_b64_tr_b16 v[58:59], v17 offset:12544
    v_exp_f32 v80, v80
    v_mfma_f32_32x32x16_bf16 v[94:109], a[36:39], v[68:71], v[94:109]
    ds_read_b64_tr_b16 v[60:61], v17 offset:13312
    v_exp_f32 v81, v81
    v_mul_f32 v159, v159, v175
    v_exp_f32 v82, v82
    v_mfma_f32_32x32x16_bf16 v[110:125], a[148:151], v[68:71], v[110:125]
    s_addk_i32 s13, 6144
    buffer_load_dwordx4 v6, s[52:55], s13 offen offset:3072 lds
    ds_read_b64_tr_b16 v[62:63], v17 offset:13568
    v_mul_f32 v160, v160, v176
    s_waitcnt lgkmcnt(4)
    v_mfma_f32_32x32x16_bf16 v[94:109], a[40:43], v[72:75], v[94:109]
    ds_read_b64_tr_b16 v[64:65], v17 offset:14336
    v_exp_f32 v83, v83
    v_mul_f32 v161, v161, v177
    v_fma_f32 v80, v80, v48, v48
    v_fma_f32 v81, v81, v48, v48
    v_mfma_f32_32x32x16_bf16 v[110:125], a[152:155], v[72:75], v[110:125]
    ds_read_b64_tr_b16 v[66:67], v17 offset:14592
    v_rcp_f32 v80, v80
    v_rcp_f32 v81, v81
    v_fma_f32 v82, v82, v48, v48
    v_mfma_f32_32x32x16_bf16 v[94:109], a[44:47], v[76:79], v[94:109]
    s_add_u32 m0, s12, 135168
    s_addk_i32 s13, 10240
    buffer_load_dwordx4 v6, s[52:55], s13 offen offset:0 lds
    ds_read_b64_tr_b16 v[68:69], v17 offset:15360
    v_fma_f32 v83, v83, v48, v48
    v_mfma_f32_32x32x16_bf16 v[110:125], a[156:159], v[76:79], v[110:125]
    ds_read_b64_tr_b16 v[70:71], v17 offset:15616
    v_rcp_f32 v82, v82
    v_rcp_f32 v83, v83
    s_waitcnt lgkmcnt(4)
    v_mfma_f32_32x32x16_bf16 v[94:109], a[48:51], v[56:59], v[94:109]
    ds_read_b64_tr_b16 v[72:73], v17 offset:16384
    v_mul_f32 v158, v158, v80
    v_mul_f32 v159, v159, v81
    v_mul_f32 v160, v160, v82
    v_mul_f32 v161, v161, v83
    v_cvt_pk_bf16_f32 v86, v158, v159
    v_mfma_f32_32x32x16_bf16 v[110:125], a[160:163], v[56:59], v[110:125]
    s_addk_i32 s13, 6144
    buffer_load_dwordx4 v6, s[52:55], s13 offen offset:1024 lds
    ds_read_b64_tr_b16 v[74:75], v17 offset:16640
    v_cvt_pk_bf16_f32 v87, v160, v161
    v_mul_f32 v80, v49, v162
    v_mfma_f32_32x32x16_bf16 v[94:109], a[52:55], v[60:63], v[94:109]
    ds_read_b64_tr_b16 v[76:77], v17 offset:17408
    v_mul_f32 v81, v49, v163
    s_mov_b32 s77, 0
    v_mfma_f32_32x32x16_bf16 v[110:125], a[164:167], v[60:63], v[110:125]
    buffer_load_dword v13, v19, s[44:47], s77 offen sc1
    ds_read_b64_tr_b16 v[78:79], v17 offset:17664
    v_mul_f32 v82, v49, v164
    v_mul_f32 v83, v49, v165
    s_waitcnt lgkmcnt(4)
    v_mfma_f32_32x32x16_bf16 v[94:109], a[56:59], v[64:67], v[94:109]
    s_addk_i32 s13, 6144
    buffer_load_dwordx4 v6, s[52:55], s13 offen offset:2048 lds
    ds_read_b64_tr_b16 v[56:57], v17 offset:18432
    v_exp_f32 v80, v80
    v_mfma_f32_32x32x16_bf16 v[110:125], a[168:171], v[64:67], v[110:125]
    ds_read_b64_tr_b16 v[58:59], v17 offset:18688
    v_mul_f32 v162, v162, v178
    v_exp_f32 v81, v81
    v_mul_f32 v163, v163, v179
    v_mul_f32 v164, v164, v180
    v_mfma_f32_32x32x16_bf16 v[94:109], a[60:63], v[68:71], v[94:109]
    s_addk_i32 s13, 6144
    buffer_load_dwordx4 v6, s[52:55], s13 offen offset:3072 lds
    ds_read_b64_tr_b16 v[60:61], v17 offset:19456
    v_exp_f32 v82, v82
    v_mfma_f32_32x32x16_bf16 v[110:125], a[172:175], v[68:71], v[110:125]
    ds_read_b64_tr_b16 v[62:63], v17 offset:19712
    v_exp_f32 v83, v83
    v_mul_f32 v165, v165, v181
    v_fma_f32 v80, v80, v48, v48
    s_waitcnt lgkmcnt(4)
    v_mfma_f32_32x32x16_bf16 v[94:109], a[64:67], v[72:75], v[94:109]
    buffer_load_dwordx4 v[24:27], v12, s[44:47], 0 offen sc1
    ds_read_b64_tr_b16 v[64:65], v17 offset:20480
    v_rcp_f32 v80, v80
    v_fma_f32 v81, v81, v48, v48
    v_mfma_f32_32x32x16_bf16 v[110:125], a[176:179], v[72:75], v[110:125]
    ds_read_b64_tr_b16 v[66:67], v17 offset:20736
    v_rcp_f32 v81, v81
    v_fma_f32 v82, v82, v48, v48
    v_rcp_f32 v82, v82
    v_mfma_f32_32x32x16_bf16 v[94:109], a[68:71], v[76:79], v[94:109]
    ds_read_b64_tr_b16 v[68:69], v17 offset:21504
    v_fma_f32 v83, v83, v48, v48
    v_rcp_f32 v83, v83
    v_mul_f32 v162, v162, v80
    v_mul_f32 v163, v163, v81
    v_mfma_f32_32x32x16_bf16 v[110:125], a[180:183], v[76:79], v[110:125]
    s_mov_b32 s76, 57344
    buffer_load_dwordx4 v[28:31], v12, s[44:47], s76 offen sc1
    ds_read_b64_tr_b16 v[70:71], v17 offset:21760
    v_mul_f32 v164, v164, v82
    s_waitcnt lgkmcnt(4)
    v_mfma_f32_32x32x16_bf16 v[94:109], a[72:75], v[56:59], v[94:109]
    ds_read_b64_tr_b16 v[72:73], v17 offset:22528
    v_mul_f32 v165, v165, v83
    v_cvt_pk_bf16_f32 v88, v162, v163
    v_cvt_pk_bf16_f32 v89, v164, v165
    v_mfma_f32_32x32x16_bf16 v[110:125], a[184:187], v[56:59], v[110:125]
    buffer_store_dwordx4 v[86:89], v3, s[44:47], s17 offen offset:0 sc1
    ds_read_b64_tr_b16 v[74:75], v17 offset:22784
    s_waitcnt vmcnt(12)
    v_mfma_f32_32x32x16_bf16 v[94:109], a[76:79], v[60:63], v[94:109]
    s_mov_b64 exec, 1
    buffer_store_dword v4, off, s[44:47], s14 sc1
    s_mov_b64 exec, -1
    ds_read_b64_tr_b16 v[76:77], v17 offset:23552
    s_add_u32 s14, s14, 1024
    v_mul_f32 v80, v49, v166
    v_mfma_f32_32x32x16_bf16 v[110:125], a[188:191], v[60:63], v[110:125]
    ds_read_b64_tr_b16 v[78:79], v17 offset:23808
    v_mul_f32 v81, v49, v167
    v_mul_f32 v82, v49, v168
    v_mul_f32 v83, v49, v169
    v_mul_f32 v166, v166, v182
    s_waitcnt lgkmcnt(4)
    v_mfma_f32_32x32x16_bf16 v[94:109], a[80:83], v[64:67], v[94:109]
    ds_read_b64_tr_b16 v[56:57], v17 offset:24576
    v_exp_f32 v80, v80
    v_exp_f32 v81, v81
    v_mul_f32 v167, v167, v183
    v_mfma_f32_32x32x16_bf16 v[110:125], a[192:195], v[64:67], v[110:125]
    ds_read_b64_tr_b16 v[58:59], v17 offset:24832
    v_exp_f32 v82, v82
    v_mul_f32 v168, v168, v184
    v_exp_f32 v83, v83
    v_mfma_f32_32x32x16_bf16 v[94:109], a[84:87], v[68:71], v[94:109]
    ds_read_b64_tr_b16 v[60:61], v17 offset:25600
    v_mul_f32 v169, v169, v185
    v_fma_f32 v80, v80, v48, v48
    v_rcp_f32 v80, v80
    v_fma_f32 v81, v81, v48, v48
    v_mfma_f32_32x32x16_bf16 v[110:125], a[196:199], v[68:71], v[110:125]
    ds_read_b64_tr_b16 v[62:63], v17 offset:25856
    v_rcp_f32 v81, v81
    v_fma_f32 v82, v82, v48, v48
    v_fma_f32 v83, v83, v48, v48
    s_waitcnt lgkmcnt(4)
    v_mfma_f32_32x32x16_bf16 v[94:109], a[88:91], v[72:75], v[94:109]
    ds_read_b64_tr_b16 v[64:65], v17 offset:26624
    v_rcp_f32 v82, v82
    v_rcp_f32 v83, v83
    v_mul_f32 v166, v166, v80
    v_mfma_f32_32x32x16_bf16 v[110:125], a[200:203], v[72:75], v[110:125]
    ds_read_b64_tr_b16 v[66:67], v17 offset:26880
    v_mul_f32 v167, v167, v81
    v_mul_f32 v168, v168, v82
    v_mul_f32 v169, v169, v83
    v_cvt_pk_bf16_f32 v90, v166, v167
    v_cvt_pk_bf16_f32 v91, v168, v169
    v_mfma_f32_32x32x16_bf16 v[94:109], a[92:95], v[76:79], v[94:109]
    ds_read_b64_tr_b16 v[68:69], v17 offset:27648
    v_mul_f32 v80, v49, v170
    v_mul_f32 v81, v49, v171
    v_mul_f32 v82, v49, v172
    v_mul_f32 v83, v49, v173
    v_mul_f32 v170, v170, v186
    v_mfma_f32_32x32x16_bf16 v[110:125], a[204:207], v[76:79], v[110:125]
    ds_read_b64_tr_b16 v[70:71], v17 offset:27904
    v_exp_f32 v80, v80
    v_exp_f32 v81, v81
    s_waitcnt lgkmcnt(4)
    v_mfma_f32_32x32x16_bf16 v[94:109], a[96:99], v[56:59], v[94:109]
    v_mul_f32 v171, v171, v187
    v_exp_f32 v82, v82
    v_mul_f32 v172, v172, v188
    v_exp_f32 v83, v83
    v_mfma_f32_32x32x16_bf16 v[110:125], a[208:211], v[56:59], v[110:125]
    v_mul_f32 v173, v173, v189
    v_fma_f32 v80, v80, v48, v48
    v_rcp_f32 v80, v80
    v_fma_f32 v81, v81, v48, v48
    v_fma_f32 v82, v82, v48, v48
    v_mfma_f32_32x32x16_bf16 v[94:109], a[100:103], v[60:63], v[94:109]
    v_rcp_f32 v81, v81
    v_rcp_f32 v82, v82
    v_fma_f32 v83, v83, v48, v48
    v_mul_f32 v170, v170, v80
    v_mfma_f32_32x32x16_bf16 v[110:125], a[212:215], v[60:63], v[110:125]
    v_rcp_f32 v83, v83
    v_mul_f32 v171, v171, v81
    v_mul_f32 v172, v172, v82
    v_mul_f32 v173, v173, v83
    s_waitcnt lgkmcnt(0)
    v_mfma_f32_32x32x16_bf16 v[94:109], a[104:107], v[64:67], v[94:109]
    v_cvt_pk_bf16_f32 v92, v170, v171
    v_cvt_pk_bf16_f32 v93, v172, v173
    v_mfma_f32_32x32x16_bf16 v[110:125], a[216:219], v[64:67], v[110:125]
    buffer_store_dwordx4 v[90:93], v3, s[44:47], s17 offen offset:1024 sc1
    s_add_u32 s17, s17, 114688
    s_waitcnt vmcnt(7)
    v_cmp_ne_u32 s[34:35], s65, v13
    v_mfma_f32_32x32x16_bf16 v[94:109], a[108:111], v[68:71], v[94:109]
    s_cmp_lg_u64 s[34:35], 0
    s_cbranch_scc1 L_p0_re
L_p0_ok:
    v_mfma_f32_32x32x16_bf16 v[110:125], a[220:223], v[68:71], v[110:125]
    buffer_load_dwordx4 a[128:131], v14, s[44:47], s4 offen offset:0 sc1
    buffer_load_dwordx4 a[132:135], v14, s[44:47], s4 offen offset:2048 sc1
    buffer_load_dwordx4 a[136:139], v14, s[44:47], s5 offen offset:0 sc1
    v_cmp_ne_u32 vcc, s65, v55
    buffer_load_dwordx4 a[140:143], v14, s[44:47], s5 offen offset:2048 sc1
    buffer_load_dwordx4 a[144:147], v14, s[44:47], s6 offen offset:0 sc1
    s_cbranch_vccnz L_s3_re
L_s3_ok:
    buffer_load_dwordx4 a[148:151], v14, s[44:47], s6 offen offset:2048 sc1
    buffer_load_dwordx4 a[152:155], v14, s[44:47], s7 offen offset:0 sc1
    v_mov_b32 v55, 0
    v_lshlrev_b32 v84, 16, v54
    v_and_b32 v85, 0xffff0000, v54
    v_mfma_f32_32x32x16_bf16 v[94:109], v[32:35], v[52:55], v[94:109]
    v_add_f32 v84, v84, v85
    v_rcp_f32 v85, v84
    v_mfma_f32_32x32x16_bf16 v[110:125], v[36:39], v[52:55], v[110:125]
    v_mul_f32 v52, v84, v84
    v_mul_f32 v53, 0xbfb8aa3b, v85
    buffer_load_dwordx4 a[156:159], v14, s[44:47], s7 offen offset:2048 sc1
    buffer_load_dwordx4 a[160:163], v14, s[44:47], s8 offen offset:0 sc1
    buffer_load_dwordx4 a[164:167], v14, s[44:47], s8 offen offset:2048 sc1
    ds_read_b64_tr_b16 a[0:1], v8 offset:32768
    ds_read_b64_tr_b16 a[2:3], v8 offset:33792
    ds_read_b64_tr_b16 a[4:5], v9 offset:32768
    ds_read_b64_tr_b16 a[6:7], v9 offset:33792
    ds_read_b64_tr_b16 a[8:9], v10 offset:32768
    ds_read_b64_tr_b16 a[10:11], v10 offset:33792
    ds_read_b64_tr_b16 a[12:13], v11 offset:32768
    ds_read_b64_tr_b16 a[14:15], v11 offset:33792
    ds_read_b64_tr_b16 a[16:17], v8 offset:36864
    ds_read_b64_tr_b16 a[18:19], v8 offset:37888
    ds_read_b64_tr_b16 a[20:21], v9 offset:36864
    ds_read_b64_tr_b16 a[22:23], v9 offset:37888
    ds_read_b64_tr_b16 a[24:25], v10 offset:36864
    ds_read_b64_tr_b16 a[26:27], v10 offset:37888
    ds_read_b64_tr_b16 a[28:29], v11 offset:36864
    ds_read_b64_tr_b16 a[30:31], v11 offset:37888
    v_xor_b32 v8, 65536, v7
    v_xor_b32 v9, 65568, v7
    v_xor_b32 v10, 65600, v7
    v_xor_b32 v11, 65632, v7
    v_mul_f32 v80, v53, v94
    v_mul_f32 v81, v53, v95
    v_mul_f32 v82, v53, v96
    v_mul_f32 v83, v53, v97
    v_exp_f32 v80, v80
    v_mul_f32 v94, v94, v110
    v_exp_f32 v81, v81
    v_mul_f32 v95, v95, v111
    v_exp_f32 v82, v82
    v_mul_f32 v96, v96, v112
    v_exp_f32 v83, v83
    v_mul_f32 v97, v97, v113
    v_fma_f32 v80, v80, v52, v52
    v_rcp_f32 v80, v80
    v_fma_f32 v81, v81, v52, v52
    v_rcp_f32 v81, v81
    v_fma_f32 v82, v82, v52, v52
    v_rcp_f32 v82, v82
    v_fma_f32 v83, v83, v52, v52
    v_rcp_f32 v83, v83
    v_mul_f32 v94, v94, v80
    v_mul_f32 v95, v95, v81
    v_mul_f32 v96, v96, v82
    v_mul_f32 v97, v97, v83
    v_cvt_pk_bf16_f32 v86, v94, v95
    v_cvt_pk_bf16_f32 v87, v96, v97
    s_waitcnt vmcnt(10)
    s_mov_b64 exec, 1
    buffer_store_dword v4, off, s[44:47], s14 sc1
    s_mov_b64 exec, -1
    s_add_u32 s14, s14, 1024
    v_mul_f32 v80, v53, v98
    v_mul_f32 v81, v53, v99
    v_mul_f32 v82, v53, v100
    v_mul_f32 v83, v53, v101
    v_exp_f32 v80, v80
    v_mul_f32 v98, v98, v114
    v_exp_f32 v81, v81
    v_mul_f32 v99, v99, v115
    v_exp_f32 v82, v82
    v_mul_f32 v100, v100, v116
    v_exp_f32 v83, v83
    v_mul_f32 v101, v101, v117
    v_fma_f32 v80, v80, v52, v52
    v_rcp_f32 v80, v80
    v_fma_f32 v81, v81, v52, v52
    v_rcp_f32 v81, v81
    v_fma_f32 v82, v82, v52, v52
    v_rcp_f32 v82, v82
    v_fma_f32 v83, v83, v52, v52
    v_rcp_f32 v83, v83
    v_mul_f32 v98, v98, v80
    v_mul_f32 v99, v99, v81
    v_mul_f32 v100, v100, v82
    v_mul_f32 v101, v101, v83
    v_cvt_pk_bf16_f32 v88, v98, v99
    v_cvt_pk_bf16_f32 v89, v100, v101
    buffer_store_dwordx4 v[86:89], v3, s[44:47], s17 offen offset:0 sc1
    v_mul_f32 v80, v53, v102
    v_mul_f32 v81, v53, v103
    v_mul_f32 v82, v53, v104
    v_mul_f32 v83, v53, v105
    v_exp_f32 v80, v80
    v_mul_f32 v102, v102, v118
    v_exp_f32 v81, v81
    v_mul_f32 v103, v103, v119
    v_exp_f32 v82, v82
    v_mul_f32 v104, v104, v120
    v_exp_f32 v83, v83
    v_mul_f32 v105, v105, v121
    v_fma_f32 v80, v80, v52, v52
    v_rcp_f32 v80, v80
    v_fma_f32 v81, v81, v52, v52
    v_rcp_f32 v81, v81
    v_fma_f32 v82, v82, v52, v52
    v_rcp_f32 v82, v82
    v_fma_f32 v83, v83, v52, v52
    v_rcp_f32 v83, v83
    v_mul_f32 v102, v102, v80
    v_mul_f32 v103, v103, v81
    v_mul_f32 v104, v104, v82
    v_mul_f32 v105, v105, v83
    v_cvt_pk_bf16_f32 v90, v102, v103
    v_cvt_pk_bf16_f32 v91, v104, v105
    v_mul_f32 v80, v53, v106
    v_mul_f32 v81, v53, v107
    v_mul_f32 v82, v53, v108
    v_mul_f32 v83, v53, v109
    v_exp_f32 v80, v80
    v_mul_f32 v106, v106, v122
    v_exp_f32 v81, v81
    v_mul_f32 v107, v107, v123
    v_exp_f32 v82, v82
    v_mul_f32 v108, v108, v124
    v_exp_f32 v83, v83
    v_mul_f32 v109, v109, v125
    v_fma_f32 v80, v80, v52, v52
    v_rcp_f32 v80, v80
    v_fma_f32 v81, v81, v52, v52
    v_rcp_f32 v81, v81
    v_fma_f32 v82, v82, v52, v52
    v_rcp_f32 v82, v82
    v_fma_f32 v83, v83, v52, v52
    v_rcp_f32 v83, v83
    v_mul_f32 v106, v106, v80
    v_mul_f32 v107, v107, v81
    v_mul_f32 v108, v108, v82
    v_mul_f32 v109, v109, v83
    v_cvt_pk_bf16_f32 v92, v106, v107
    v_cvt_pk_bf16_f32 v93, v108, v109
    buffer_store_dwordx4 v[90:93], v3, s[44:47], s17 offen offset:1024 sc1
    s_add_u32 s17, s17, 114688
    s_waitcnt vmcnt(12)
    v_mfma_f32_16x16x32_bf16 v[126:129], a[224:227], a[128:131], 0
    buffer_load_dwordx4 a[168:171], v14, s[44:47], s9 offen offset:0 sc1
    v_mfma_f32_16x16x32_bf16 v[130:133], a[228:231], a[128:131], 0
    v_mfma_f32_16x16x32_bf16 v[134:137], a[232:235], a[128:131], 0
    v_mfma_f32_16x16x32_bf16 v[138:141], a[236:239], a[128:131], 0
    ds_read_b64_tr_b16 a[32:33], v8 offset:32768
    ds_read_b64_tr_b16 a[34:35], v8 offset:33792
    ds_read_b64_tr_b16 a[36:37], v9 offset:32768
    s_waitcnt vmcnt(12)
    v_mfma_f32_16x16x32_bf16 v[126:129], a[240:243], a[132:135], v[126:129]
    buffer_load_dwordx4 a[172:175], v14, s[44:47], s9 offen offset:2048 sc1
    ds_read_b64_tr_b16 a[38:39], v9 offset:33792
    v_mfma_f32_16x16x32_bf16 v[130:133], a[244:247], a[132:135], v[130:133]
    s_mov_b32 s77, 1024
    v_mfma_f32_16x16x32_bf16 v[134:137], a[248:251], a[132:135], v[134:137]
    buffer_load_dword v13, v19, s[44:47], s77 offen sc1
    ds_read_b64_tr_b16 a[40:41], v10 offset:32768
    ds_read_b64_tr_b16 a[42:43], v10 offset:33792
    ds_read_b64_tr_b16 a[44:45], v11 offset:32768
    v_mfma_f32_16x16x32_bf16 v[138:141], a[252:255], a[132:135], v[138:141]
    ds_read_b64_tr_b16 a[46:47], v11 offset:33792
    ds_read_b64_tr_b16 a[48:49], v8 offset:36864
    s_waitcnt vmcnt(13)
    v_mfma_f32_16x16x32_bf16 v[126:129], v[190:193], a[136:139], v[126:129]
    buffer_load_dwordx4 a[176:179], v14, s[44:47], s10 offen offset:0 sc1
    ds_read_b64_tr_b16 a[50:51], v8 offset:37888
    v_mfma_f32_16x16x32_bf16 v[130:133], v[194:197], a[136:139], v[130:133]
    ds_read_b64_tr_b16 a[52:53], v9 offset:36864
    ds_read_b64_tr_b16 a[54:55], v9 offset:37888
    v_mfma_f32_16x16x32_bf16 v[134:137], v[198:201], a[136:139], v[134:137]
    ds_read_b64_tr_b16 a[56:57], v10 offset:36864
    v_mfma_f32_16x16x32_bf16 v[138:141], v[202:205], a[136:139], v[138:141]
    ds_read_b64_tr_b16 a[58:59], v10 offset:37888
    ds_read_b64_tr_b16 a[60:61], v11 offset:36864
    s_waitcnt vmcnt(13)
    v_mfma_f32_16x16x32_bf16 v[126:129], v[206:209], a[140:143], v[126:129]
    buffer_load_dwordx4 a[180:183], v14, s[44:47], s10 offen offset:2048 sc1
    s_waitcnt vmcnt(5)
    v_mfma_f32_16x16x32_bf16 v[130:133], v[210:213], a[140:143], v[130:133]
    s_mov_b64 exec, 1
    buffer_store_dword v4, off, s[44:47], s14 sc1
    s_mov_b64 exec, -1
    s_add_u32 s14, s14, 1024
    v_mfma_f32_16x16x32_bf16 v[134:137], v[214:217], a[140:143], v[134:137]
    ds_read_b64_tr_b16 a[62:63], v11 offset:37888
    v_xor_b32 v8, 0, v7
    v_xor_b32 v9, 32, v7
    v_xor_b32 v10, 64, v7
    v_xor_b32 v11, 96, v7
    v_mfma_f32_16x16x32_bf16 v[138:141], v[218:221], a[140:143], v[138:141]
    v_mfma_f32_16x16x32_bf16 v[126:129], v[222:225], a[144:147], v[126:129]
    ds_read_b64_tr_b16 a[64:65], v8 offset:0
    ds_read_b64_tr_b16 a[66:67], v8 offset:1024
    v_mfma_f32_16x16x32_bf16 v[130:133], v[226:229], a[144:147], v[130:133]
    ds_read_b64_tr_b16 a[68:69], v9 offset:0
    v_mfma_f32_16x16x32_bf16 v[134:137], v[230:233], a[144:147], v[134:137]
    ds_read_b64_tr_b16 a[70:71], v9 offset:1024
    ds_read_b64_tr_b16 a[72:73], v10 offset:0
    v_mfma_f32_16x16x32_bf16 v[138:141], v[234:237], a[144:147], v[138:141]
    ds_read_b64_tr_b16 a[74:75], v10 offset:1024
    v_mfma_f32_16x16x32_bf16 v[126:129], v[238:241], a[148:151], v[126:129]
    ds_read_b64_tr_b16 a[76:77], v11 offset:0
    ds_read_b64_tr_b16 a[78:79], v11 offset:1024
    v_mfma_f32_16x16x32_bf16 v[130:133], v[242:245], a[148:151], v[130:133]
    ds_read_b64_tr_b16 a[80:81], v8 offset:4096
    ds_read_b64_tr_b16 a[82:83], v8 offset:5120
    v_mfma_f32_16x16x32_bf16 v[134:137], v[246:249], a[148:151], v[134:137]
    ds_read_b64_tr_b16 a[84:85], v9 offset:4096
    s_waitcnt lgkmcnt(15)
    v_mfma_f32_16x16x32_bf16 v[138:141], v[250:253], a[148:151], v[138:141]
    s_waitcnt vmcnt(3)
    v_cmp_ne_u32 vcc, s65, v13
    s_nop 0
    s_cbranch_vccnz L_p1_re
L_p1_ok:
    v_mfma_f32_16x16x32_bf16 v[126:129], a[0:3], a[152:155], v[126:129]
    ds_read_b64_tr_b16 a[86:87], v9 offset:5120
    ds_read_b64_tr_b16 a[88:89], v10 offset:4096
    ds_read_b64_tr_b16 a[90:91], v10 offset:5120
    v_mfma_f32_16x16x32_bf16 v[130:133], a[4:7], a[152:155], v[130:133]
    ds_read_b64_tr_b16 a[92:93], v11 offset:4096
    ds_read_b64_tr_b16 a[94:95], v11 offset:5120
    v_mfma_f32_16x16x32_bf16 v[134:137], a[8:11], a[152:155], v[134:137]
    v_add_u32 v14, 114688, v14
    v_xor_b32 v8, 131072, v7
    v_mfma_f32_16x16x32_bf16 v[138:141], a[12:15], a[152:155], v[138:141]
    v_xor_b32 v9, 131104, v7
    v_xor_b32 v10, 131136, v7
    v_mfma_f32_16x16x32_bf16 v[126:129], a[16:19], a[156:159], v[126:129]
    buffer_load_dwordx4 a[184:187], v14, s[44:47], s4 offen offset:0 sc1
    v_xor_b32 v11, 131168, v7
    v_mfma_f32_16x16x32_bf16 v[130:133], a[20:23], a[156:159], v[130:133]
    v_mfma_f32_16x16x32_bf16 v[134:137], a[24:27], a[156:159], v[134:137]
    ds_read_b64_tr_b16 a[96:97], v8 offset:0
    s_waitcnt lgkmcnt(15)
    v_mfma_f32_16x16x32_bf16 v[138:141], a[28:31], a[156:159], v[138:141]
    buffer_load_dwordx4 a[188:191], v14, s[44:47], s4 offen offset:2048 sc1
    ds_read_b64_tr_b16 a[98:99], v8 offset:1024
    ds_read_b64_tr_b16 a[100:101], v9 offset:0
    ds_read_b64_tr_b16 a[102:103], v9 offset:1024
    v_mfma_f32_16x16x32_bf16 v[126:129], a[32:35], a[160:163], v[126:129]
    buffer_load_dwordx4 a[192:195], v14, s[44:47], s5 offen offset:0 sc1
    ds_read_b64_tr_b16 a[104:105], v10 offset:0
    ds_read_b64_tr_b16 a[106:107], v10 offset:1024
    v_mfma_f32_16x16x32_bf16 v[130:133], a[36:39], a[160:163], v[130:133]
    ds_read_b64_tr_b16 a[108:109], v11 offset:0
    v_mfma_f32_16x16x32_bf16 v[134:137], a[40:43], a[160:163], v[134:137]
    buffer_load_dwordx4 a[196:199], v14, s[44:47], s5 offen offset:2048 sc1
    ds_read_b64_tr_b16 a[110:111], v11 offset:1024
    ds_read_b64_tr_b16 a[112:113], v8 offset:4096
    v_mfma_f32_16x16x32_bf16 v[138:141], a[44:47], a[160:163], v[138:141]
    ds_read_b64_tr_b16 a[114:115], v8 offset:5120
    v_mfma_f32_16x16x32_bf16 v[126:129], a[48:51], a[164:167], v[126:129]
    buffer_load_dwordx4 a[200:203], v14, s[44:47], s6 offen offset:0 sc1
    ds_read_b64_tr_b16 a[116:117], v9 offset:4096
    ds_read_b64_tr_b16 a[118:119], v9 offset:5120
    v_and_b32 v80, 15, v1
    v_lshlrev_b32 v80, 8, v80
    v_add_u32 v80, s12, v80
    v_mfma_f32_16x16x32_bf16 v[130:133], a[52:55], a[164:167], v[130:133]
    ds_read_b64_tr_b16 a[120:121], v10 offset:4096
    v_lshrrev_b32 v81, 4, v1
    v_and_b32 v82, 7, v1
    v_xor_b32 v81, v81, v82
    v_lshl_add_u32 v40, v81, 4, v80
    v_add_u32 v40, 65536, v40
    v_xor_b32 v41, 64, v40
    v_mfma_f32_16x16x32_bf16 v[134:137], a[56:59], a[164:167], v[134:137]
    buffer_load_dwordx4 a[204:207], v14, s[44:47], s6 offen offset:2048 sc1
    ds_read_b64_tr_b16 a[122:123], v10 offset:5120
    ds_read_b64_tr_b16 a[124:125], v11 offset:4096
    s_waitcnt lgkmcnt(15)
    v_mfma_f32_16x16x32_bf16 v[138:141], a[60:63], a[164:167], v[138:141]
    ds_read_b64_tr_b16 a[126:127], v11 offset:5120
    v_mfma_f32_16x16x32_bf16 v[126:129], a[64:67], a[168:171], v[126:129]
    buffer_load_dwordx4 a[208:211], v14, s[44:47], s7 offen offset:0 sc1
    v_mfma_f32_16x16x32_bf16 v[130:133], a[68:71], a[168:171], v[130:133]
    v_mfma_f32_16x16x32_bf16 v[134:137], a[72:75], a[168:171], v[134:137]
    v_mfma_f32_16x16x32_bf16 v[138:141], a[76:79], a[168:171], v[138:141]
    v_mfma_f32_16x16x32_bf16 v[126:129], a[80:83], a[172:175], v[126:129]
    buffer_load_dwordx4 a[212:215], v14, s[44:47], s7 offen offset:2048 sc1
    v_mfma_f32_16x16x32_bf16 v[130:133], a[84:87], a[172:175], v[130:133]
    v_mfma_f32_16x16x32_bf16 v[134:137], a[88:91], a[172:175], v[134:137]
    s_waitcnt lgkmcnt(0)
    v_mfma_f32_16x16x32_bf16 v[138:141], a[92:95], a[172:175], v[138:141]
    s_waitcnt vmcnt(10)
    v_mfma_f32_16x16x32_bf16 v[126:129], a[96:99], a[176:179], v[126:129]
    buffer_load_dwordx4 a[216:219], v14, s[44:47], s8 offen offset:0 sc1
    v_mfma_f32_16x16x32_bf16 v[130:133], a[100:103], a[176:179], v[130:133]
    s_mov_b32 s77, 2048
    v_mfma_f32_16x16x32_bf16 v[134:137], a[104:107], a[176:179], v[134:137]
    buffer_load_dword v13, v19, s[44:47], s77 offen sc1
    v_mfma_f32_16x16x32_bf16 v[138:141], a[108:111], a[176:179], v[138:141]
    s_waitcnt vmcnt(11)
    v_mfma_f32_16x16x32_bf16 v[126:129], a[112:115], a[180:183], v[126:129]
    buffer_load_dwordx4 a[220:223], v14, s[44:47], s8 offen offset:2048 sc1
    v_mfma_f32_16x16x32_bf16 v[130:133], a[116:119], a[180:183], v[130:133]
    v_mfma_f32_16x16x32_bf16 v[134:137], a[120:123], a[180:183], v[134:137]
    s_barrier
    v_mfma_f32_16x16x32_bf16 v[138:141], a[124:127], a[180:183], v[138:141]
    s_waitcnt vmcnt(10)
    v_mfma_f32_16x16x32_bf16 v[142:145], a[224:227], a[184:187], 0
    buffer_load_dwordx4 a[128:131], v14, s[44:47], s9 offen offset:0 sc1
    v_mfma_f32_16x16x32_bf16 v[146:149], a[228:231], a[184:187], 0
    v_mfma_f32_16x16x32_bf16 v[150:153], a[232:235], a[184:187], 0
    v_mfma_f32_16x16x32_bf16 v[154:157], a[236:239], a[184:187], 0
    s_waitcnt vmcnt(10)
    v_mfma_f32_16x16x32_bf16 v[142:145], a[240:243], a[188:191], v[142:145]
    buffer_load_dwordx4 a[132:135], v14, s[44:47], s9 offen offset:2048 sc1
    v_mfma_f32_16x16x32_bf16 v[146:149], a[244:247], a[188:191], v[146:149]
    v_lshrrev_b32 v80, 3, v0
    v_and_b32 v81, 7, v80
    v_mfma_f32_16x16x32_bf16 v[150:153], a[248:251], a[188:191], v[150:153]
    v_lshlrev_b32 v44, 1, v82
    v_xor_b32 v44, v44, v81
    v_mfma_f32_16x16x32_bf16 v[154:157], a[252:255], a[188:191], v[154:157]
    v_lshlrev_b32 v44, 4, v44
    s_waitcnt vmcnt(10)
    v_mfma_f32_16x16x32_bf16 v[142:145], v[190:193], a[192:195], v[142:145]
    buffer_load_dwordx4 a[136:139], v14, s[44:47], s10 offen offset:0 sc1
    v_mfma_f32_16x16x32_bf16 v[146:149], v[194:197], a[192:195], v[146:149]
    ds_write_b128 v40, v[126:129] offset:0
    v_mfma_f32_16x16x32_bf16 v[150:153], v[198:201], a[192:195], v[150:153]
    v_lshl_add_u32 v44, v80, 8, v44
    v_add_u32 v44, 65536, v44
    v_mfma_f32_16x16x32_bf16 v[154:157], v[202:205], a[192:195], v[154:157]
    v_xor_b32 v45, 16, v44
    s_waitcnt vmcnt(10)
    v_mfma_f32_16x16x32_bf16 v[142:145], v[206:209], a[196:199], v[142:145]
    buffer_load_dwordx4 a[140:143], v14, s[44:47], s10 offen offset:2048 sc1
    v_mfma_f32_16x16x32_bf16 v[146:149], v[210:213], a[196:199], v[146:149]
    ds_write_b128 v41, v[130:133] offset:0
    v_mfma_f32_16x16x32_bf16 v[150:153], v[214:217], a[196:199], v[150:153]
    v_and_b32 v81, 16, v80
    v_add_u32 v80, v80, v81
    v_mfma_f32_16x16x32_bf16 v[154:157], v[218:221], a[196:199], v[154:157]
    s_waitcnt vmcnt(5)
    v_mfma_f32_16x16x32_bf16 v[142:145], v[222:225], a[200:203], v[142:145]
    v_cmp_ne_u32 vcc, s65, v13
    v_mul_u32_u24 v46, 896, v80
    v_mfma_f32_16x16x32_bf16 v[146:149], v[226:229], a[200:203], v[146:149]
    s_cbranch_vccnz L_p2_re
L_p2_ok:
    v_mfma_f32_16x16x32_bf16 v[150:153], v[230:233], a[200:203], v[150:153]
    ds_write_b128 v40, v[134:137] offset:128
    v_mfma_f32_16x16x32_bf16 v[154:157], v[234:237], a[200:203], v[154:157]
    v_add_u32 v14, 114688, v14
    v_mfma_f32_16x16x32_bf16 v[142:145], v[238:241], a[204:207], v[142:145]
    buffer_load_dwordx4 a[144:147], v14, s[44:47], s4 offen offset:0 sc1
    v_mfma_f32_16x16x32_bf16 v[146:149], v[242:245], a[204:207], v[146:149]
    ds_write_b128 v41, v[138:141] offset:128
    v_mfma_f32_16x16x32_bf16 v[150:153], v[246:249], a[204:207], v[150:153]
    buffer_load_dwordx4 a[148:151], v14, s[44:47], s4 offen offset:2048 sc1
    v_mfma_f32_16x16x32_bf16 v[154:157], v[250:253], a[204:207], v[154:157]
    v_lshl_add_u32 v46, v82, 4, v46
    v_mfma_f32_16x16x32_bf16 v[142:145], a[0:3], a[208:211], v[142:145]
    buffer_load_dwordx4 a[152:155], v14, s[44:47], s5 offen offset:0 sc1
    v_mfma_f32_16x16x32_bf16 v[146:149], a[4:7], a[208:211], v[146:149]
    v_lshlrev_b32 v72, 16, v20
    v_and_b32 v73, 0xffff0000, v20
    v_mfma_f32_16x16x32_bf16 v[150:153], a[8:11], a[208:211], v[150:153]
    v_lshlrev_b32 v74, 16, v21
    v_and_b32 v75, 0xffff0000, v21
    v_mfma_f32_16x16x32_bf16 v[154:157], a[12:15], a[208:211], v[154:157]
    v_lshlrev_b32 v76, 16, v22
    v_mfma_f32_16x16x32_bf16 v[142:145], a[16:19], a[212:215], v[142:145]
L_padF2:
    s_cbranch_execz L_retF
    buffer_load_dwordx4 a[156:159], v14, s[44:47], s5 offen offset:2048 sc1
    v_mfma_f32_16x16x32_bf16 v[146:149], a[20:23], a[212:215], v[146:149]
    v_and_b32 v77, 0xffff0000, v22
    v_lshlrev_b32 v78, 16, v23
    v_mfma_f32_16x16x32_bf16 v[150:153], a[24:27], a[212:215], v[150:153]
    v_and_b32 v79, 0xffff0000, v23
    v_lshrrev_b32 v80, 7, v0
    v_mfma_f32_16x16x32_bf16 v[154:157], a[28:31], a[212:215], v[154:157]
    v_and_b32 v81, 3, v0
    v_mfma_f32_16x16x32_bf16 v[142:145], a[32:35], a[216:219], v[142:145]
    buffer_load_dwordx4 a[160:163], v14, s[44:47], s6 offen offset:0 sc1
    v_mfma_f32_16x16x32_bf16 v[146:149], a[36:39], a[216:219], v[146:149]
    v_lshl_add_u32 v80, v80, 2, v81
    v_mul_u32_u24 v80, 576, v80
    v_mfma_f32_16x16x32_bf16 v[150:153], a[40:43], a[216:219], v[150:153]
    v_and_b32 v81, 0x7c, v0
    v_add_u32 v80, v80, v81
    v_mfma_f32_16x16x32_bf16 v[154:157], a[44:47], a[216:219], v[154:157]
    v_add_u32 v42, 131072, v80
    s_waitcnt vmcnt(9)
    v_mfma_f32_16x16x32_bf16 v[142:145], a[48:51], a[220:223], v[142:145]
    buffer_load_dwordx4 a[164:167], v14, s[44:47], s6 offen offset:2048 sc1
    v_mfma_f32_16x16x32_bf16 v[146:149], a[52:55], a[220:223], v[146:149]
    v_lshrrev_b32 v80, 3, v0
    v_mul_u32_u24 v80, 144, v80
    v_mfma_f32_16x16x32_bf16 v[150:153], a[56:59], a[220:223], v[150:153]
    v_lshl_add_u32 v80, v82, 4, v80
    v_add_u32 v43, 131072, v80
    v_mfma_f32_16x16x32_bf16 v[154:157], a[60:63], a[220:223], v[154:157]
    ds_write_b32 v42, v24 offset:0
    s_waitcnt vmcnt(9)
    v_mfma_f32_16x16x32_bf16 v[142:145], a[64:67], a[128:131], v[142:145]
    ds_write_b32 v42, v25 offset:144
    ds_write_b32 v42, v26 offset:288
    v_mfma_f32_16x16x32_bf16 v[146:149], a[68:71], a[128:131], v[146:149]
    ds_write_b32 v42, v27 offset:432
    ds_write_b32 v42, v28 offset:4608
    v_mfma_f32_16x16x32_bf16 v[150:153], a[72:75], a[128:131], v[150:153]
    ds_write_b32 v42, v29 offset:4752
    ds_write_b32 v42, v30 offset:4896
    v_mfma_f32_16x16x32_bf16 v[154:157], a[76:79], a[128:131], v[154:157]
    ds_write_b32 v42, v31 offset:5040
    s_waitcnt vmcnt(8)
    v_mfma_f32_16x16x32_bf16 v[142:145], a[80:83], a[132:135], v[142:145]
    buffer_load_dwordx4 a[168:171], v14, s[44:47], s7 offen offset:0 sc1
    v_mfma_f32_16x16x32_bf16 v[146:149], a[84:87], a[132:135], v[146:149]
    s_mov_b32 s77, 3072
    v_mfma_f32_16x16x32_bf16 v[150:153], a[88:91], a[132:135], v[150:153]
    buffer_load_dword v13, v19, s[44:47], s77 offen sc1
    v_mfma_f32_16x16x32_bf16 v[154:157], a[92:95], a[132:135], v[154:157]
    s_waitcnt vmcnt(9)
    v_mfma_f32_16x16x32_bf16 v[142:145], a[96:99], a[136:139], v[142:145]
    buffer_load_dwordx4 a[172:175], v14, s[44:47], s7 offen offset:2048 sc1
    v_mfma_f32_16x16x32_bf16 v[146:149], a[100:103], a[136:139], v[146:149]
    buffer_load_dwordx4 a[176:179], v14, s[44:47], s8 offen offset:0 sc1
    v_mfma_f32_16x16x32_bf16 v[150:153], a[104:107], a[136:139], v[150:153]
    v_mfma_f32_16x16x32_bf16 v[154:157], a[108:111], a[136:139], v[154:157]
    s_waitcnt vmcnt(10)
    v_mfma_f32_16x16x32_bf16 v[142:145], a[112:115], a[140:143], v[142:145]
    buffer_load_dwordx4 a[180:183], v14, s[44:47], s8 offen offset:2048 sc1
    v_mfma_f32_16x16x32_bf16 v[146:149], a[116:119], a[140:143], v[146:149]
    v_mfma_f32_16x16x32_bf16 v[150:153], a[120:123], a[140:143], v[150:153]
    v_mfma_f32_16x16x32_bf16 v[154:157], a[124:127], a[140:143], v[154:157]
    s_waitcnt vmcnt(10)
    v_mfma_f32_16x16x32_bf16 v[158:161], a[224:227], a[144:147], 0
    buffer_load_dwordx4 a[184:187], v14, s[44:47], s9 offen offset:0 sc1
    v_mfma_f32_16x16x32_bf16 v[162:165], a[228:231], a[144:147], 0
    v_mfma_f32_16x16x32_bf16 v[166:169], a[232:235], a[144:147], 0
    v_mfma_f32_16x16x32_bf16 v[170:173], a[236:239], a[144:147], 0
    s_waitcnt vmcnt(10)
    v_mfma_f32_16x16x32_bf16 v[158:161], a[240:243], a[148:151], v[158:161]
    buffer_load_dwordx4 a[188:191], v14, s[44:47], s9 offen offset:2048 sc1
    v_mfma_f32_16x16x32_bf16 v[162:165], a[244:247], a[148:151], v[162:165]
    v_mfma_f32_16x16x32_bf16 v[166:169], a[248:251], a[148:151], v[166:169]
    v_mfma_f32_16x16x32_bf16 v[170:173], a[252:255], a[148:151], v[170:173]
    s_waitcnt vmcnt(10)
    v_mfma_f32_16x16x32_bf16 v[158:161], v[190:193], a[152:155], v[158:161]
    buffer_load_dwordx4 a[192:195], v14, s[44:47], s10 offen offset:0 sc1
    v_mfma_f32_16x16x32_bf16 v[162:165], v[194:197], a[152:155], v[162:165]
    ds_write_b128 v40, v[142:145] offset:4096
    v_mfma_f32_16x16x32_bf16 v[166:169], v[198:201], a[152:155], v[166:169]
    v_mfma_f32_16x16x32_bf16 v[170:173], v[202:205], a[152:155], v[170:173]
    s_waitcnt vmcnt(10)
    v_mfma_f32_16x16x32_bf16 v[158:161], v[206:209], a[156:159], v[158:161]
    buffer_load_dwordx4 a[196:199], v14, s[44:47], s10 offen offset:2048 sc1
    v_mfma_f32_16x16x32_bf16 v[162:165], v[210:213], a[156:159], v[162:165]
    ds_write_b128 v41, v[146:149] offset:4096
    v_mfma_f32_16x16x32_bf16 v[166:169], v[214:217], a[156:159], v[166:169]
    v_mfma_f32_16x16x32_bf16 v[170:173], v[218:221], a[156:159], v[170:173]
    s_waitcnt vmcnt(10)
    v_mfma_f32_16x16x32_bf16 v[158:161], v[222:225], a[160:163], v[158:161]
    v_mfma_f32_16x16x32_bf16 v[162:165], v[226:229], a[160:163], v[162:165]
    ds_write_b128 v40, v[150:153] offset:4224
    v_mfma_f32_16x16x32_bf16 v[166:169], v[230:233], a[160:163], v[166:169]
    v_mfma_f32_16x16x32_bf16 v[170:173], v[234:237], a[160:163], v[170:173]
    s_waitcnt vmcnt(7)
    v_mfma_f32_16x16x32_bf16 v[158:161], v[238:241], a[164:167], v[158:161]
    v_cmp_ne_u32 vcc, s65, v13
    v_mfma_f32_16x16x32_bf16 v[162:165], v[242:245], a[164:167], v[162:165]
    s_cbranch_vccnz L_p3_re
L_p3_ok:
    v_mfma_f32_16x16x32_bf16 v[166:169], v[246:249], a[164:167], v[166:169]
    ds_write_b128 v41, v[154:157] offset:4224
    v_mfma_f32_16x16x32_bf16 v[170:173], v[250:253], a[164:167], v[170:173]
    v_add_u32 v14, 114688, v14
    v_mfma_f32_16x16x32_bf16 v[158:161], a[0:3], a[168:171], v[158:161]
    buffer_load_dwordx4 a[200:203], v14, s[44:47], s4 offen offset:0 sc1
    v_mfma_f32_16x16x32_bf16 v[162:165], a[4:7], a[168:171], v[162:165]
    v_mfma_f32_16x16x32_bf16 v[166:169], a[8:11], a[168:171], v[166:169]
    buffer_load_dwordx4 a[204:207], v14, s[44:47], s4 offen offset:2048 sc1
    v_mfma_f32_16x16x32_bf16 v[170:173], a[12:15], a[168:171], v[170:173]
    s_waitcnt vmcnt(8)
    v_mfma_f32_16x16x32_bf16 v[158:161], a[16:19], a[172:175], v[158:161]
    buffer_load_dwordx4 a[208:211], v14, s[44:47], s5 offen offset:0 sc1
    v_mfma_f32_16x16x32_bf16 v[162:165], a[20:23], a[172:175], v[162:165]
    s_waitcnt lgkmcnt(0)
    s_barrier
    ds_read_b128 v[94:97], v44 offset:0
    v_mfma_f32_16x16x32_bf16 v[166:169], a[24:27], a[172:175], v[166:169]
    buffer_load_dwordx4 a[212:215], v14, s[44:47], s5 offen offset:2048 sc1
    v_mfma_f32_16x16x32_bf16 v[170:173], a[28:31], a[172:175], v[170:173]
    ds_read_b128 v[98:101], v45 offset:0
    s_waitcnt vmcnt(9)
    v_mfma_f32_16x16x32_bf16 v[158:161], a[32:35], a[176:179], v[158:161]
    ds_read_b128 v[102:105], v44 offset:8192
    v_mfma_f32_16x16x32_bf16 v[162:165], a[36:39], a[176:179], v[162:165]
    buffer_load_dwordx4 a[216:219], v14, s[44:47], s6 offen offset:0 sc1
    v_mfma_f32_16x16x32_bf16 v[166:169], a[40:43], a[176:179], v[166:169]
    ds_read_b128 v[106:109], v45 offset:8192
    ds_read_b128 v[110:113], v44 offset:16384
    v_mfma_f32_16x16x32_bf16 v[170:173], a[44:47], a[176:179], v[170:173]
    ds_read_b128 v[114:117], v45 offset:16384
    s_waitcnt vmcnt(9)
    v_mfma_f32_16x16x32_bf16 v[158:161], a[48:51], a[180:183], v[158:161]
    ds_read_b128 v[118:121], v44 offset:24576
    v_mfma_f32_16x16x32_bf16 v[162:165], a[52:55], a[180:183], v[162:165]
    buffer_load_dwordx4 a[220:223], v14, s[44:47], s6 offen offset:2048 sc1
    v_mfma_f32_16x16x32_bf16 v[166:169], a[56:59], a[180:183], v[166:169]
    ds_read_b128 v[122:125], v45 offset:24576
    ds_read_b128 v[24:27], v43 offset:0
    v_mfma_f32_16x16x32_bf16 v[170:173], a[60:63], a[180:183], v[170:173]
    ds_read_b128 v[28:31], v43 offset:4608
    s_waitcnt vmcnt(9)
    v_mfma_f32_16x16x32_bf16 v[158:161], a[64:67], a[184:187], v[158:161]
    buffer_load_dwordx4 a[128:131], v14, s[44:47], s7 offen offset:0 sc1
    v_mfma_f32_16x16x32_bf16 v[162:165], a[68:71], a[184:187], v[162:165]
    v_mfma_f32_16x16x32_bf16 v[166:169], a[72:75], a[184:187], v[166:169]
    v_mfma_f32_16x16x32_bf16 v[170:173], a[76:79], a[184:187], v[170:173]
    s_waitcnt vmcnt(9)
    v_mfma_f32_16x16x32_bf16 v[158:161], a[80:83], a[188:191], v[158:161]
    buffer_load_dwordx4 a[132:135], v14, s[44:47], s7 offen offset:2048 sc1
    v_mfma_f32_16x16x32_bf16 v[162:165], a[84:87], a[188:191], v[162:165]
    v_mfma_f32_16x16x32_bf16 v[166:169], a[88:91], a[188:191], v[166:169]
    s_waitcnt lgkmcnt(0)
    v_lshlrev_b32 v56, 16, v24
    v_mfma_f32_16x16x32_bf16 v[170:173], a[92:95], a[188:191], v[170:173]
    v_and_b32 v57, 0xffff0000, v24
    s_waitcnt vmcnt(9)
    v_mfma_f32_16x16x32_bf16 v[158:161], a[96:99], a[192:195], v[158:161]
    buffer_load_dwordx4 a[136:139], v14, s[44:47], s8 offen offset:0 sc1
    v_mfma_f32_16x16x32_bf16 v[162:165], a[100:103], a[192:195], v[162:165]
    v_lshlrev_b32 v58, 16, v25
    v_and_b32 v59, 0xffff0000, v25
    v_mfma_f32_16x16x32_bf16 v[166:169], a[104:107], a[192:195], v[166:169]
    v_lshlrev_b32 v60, 16, v26
    v_and_b32 v61, 0xffff0000, v26
    v_mfma_f32_16x16x32_bf16 v[170:173], a[108:111], a[192:195], v[170:173]
    v_lshlrev_b32 v62, 16, v27
    s_waitcnt vmcnt(9)
    v_mfma_f32_16x16x32_bf16 v[158:161], a[112:115], a[196:199], v[158:161]
    buffer_load_dwordx4 a[140:143], v14, s[44:47], s8 offen offset:2048 sc1
    v_mfma_f32_16x16x32_bf16 v[162:165], a[116:119], a[196:199], v[162:165]
    v_and_b32 v63, 0xffff0000, v27
    v_add_f32 v94, v94, v102
    v_mfma_f32_16x16x32_bf16 v[166:169], a[120:123], a[196:199], v[166:169]
    v_add_f32 v110, v110, v118
    v_add_f32 v94, v94, v110
    v_mfma_f32_16x16x32_bf16 v[170:173], a[124:127], a[196:199], v[170:173]
    v_fmac_f32 v56, v94, v72
    s_waitcnt vmcnt(9)
    v_mfma_f32_16x16x32_bf16 v[174:177], a[224:227], a[200:203], 0
    buffer_load_dwordx4 a[144:147], v14, s[44:47], s9 offen offset:0 sc1
    v_mfma_f32_16x16x32_bf16 v[178:181], a[228:231], a[200:203], 0
    v_add_f32 v95, v95, v103
    v_add_f32 v111, v111, v119
    v_mfma_f32_16x16x32_bf16 v[182:185], a[232:235], a[200:203], 0
    v_add_f32 v95, v95, v111
    v_fmac_f32 v57, v95, v73
    v_mfma_f32_16x16x32_bf16 v[186:189], a[236:239], a[200:203], 0
    v_add_f32 v96, v96, v104
    s_waitcnt vmcnt(9)
    v_mfma_f32_16x16x32_bf16 v[174:177], a[240:243], a[204:207], v[174:177]
    buffer_load_dwordx4 a[148:151], v14, s[44:47], s9 offen offset:2048 sc1
    v_mfma_f32_16x16x32_bf16 v[178:181], a[244:247], a[204:207], v[178:181]
    v_add_f32 v112, v112, v120
    v_add_f32 v96, v96, v112
    v_mfma_f32_16x16x32_bf16 v[182:185], a[248:251], a[204:207], v[182:185]
    v_fmac_f32 v58, v96, v74
    v_add_f32 v97, v97, v105
    v_mfma_f32_16x16x32_bf16 v[186:189], a[252:255], a[204:207], v[186:189]
    v_add_f32 v113, v113, v121
    s_waitcnt vmcnt(9)
    v_mfma_f32_16x16x32_bf16 v[174:177], v[190:193], a[208:211], v[174:177]
    buffer_load_dwordx4 a[152:155], v14, s[44:47], s10 offen offset:0 sc1
    v_mfma_f32_16x16x32_bf16 v[178:181], v[194:197], a[208:211], v[178:181]
    ds_write_b128 v40, v[158:161] offset:32768
    v_mfma_f32_16x16x32_bf16 v[182:185], v[198:201], a[208:211], v[182:185]
    v_add_f32 v97, v97, v113
    v_fmac_f32 v59, v97, v75
    v_mfma_f32_16x16x32_bf16 v[186:189], v[202:205], a[208:211], v[186:189]
    v_add_f32 v98, v98, v106
    s_waitcnt vmcnt(9)
    v_mfma_f32_16x16x32_bf16 v[174:177], v[206:209], a[212:215], v[174:177]
    buffer_load_dwordx4 a[156:159], v14, s[44:47], s10 offen offset:2048 sc1
    v_mfma_f32_16x16x32_bf16 v[178:181], v[210:213], a[212:215], v[178:181]
    ds_write_b128 v41, v[162:165] offset:32768
    v_mfma_f32_16x16x32_bf16 v[182:185], v[214:217], a[212:215], v[182:185]
    v_add_f32 v114, v114, v122
    v_add_f32 v98, v98, v114
    v_mfma_f32_16x16x32_bf16 v[186:189], v[218:221], a[212:215], v[186:189]
    v_fmac_f32 v60, v98, v76
    s_waitcnt vmcnt(9)
    v_mfma_f32_16x16x32_bf16 v[174:177], v[222:225], a[216:219], v[174:177]
    v_add_f32 v99, v99, v107
    v_add_f32 v115, v115, v123
    v_mfma_f32_16x16x32_bf16 v[178:181], v[226:229], a[216:219], v[178:181]
    ds_write_b128 v40, v[166:169] offset:32896
    v_mfma_f32_16x16x32_bf16 v[182:185], v[230:233], a[216:219], v[182:185]
    v_add_f32 v99, v99, v115
    v_fmac_f32 v61, v99, v77
    v_mfma_f32_16x16x32_bf16 v[186:189], v[234:237], a[216:219], v[186:189]
    v_add_f32 v100, v100, v108
    s_waitcnt vmcnt(8)
    v_mfma_f32_16x16x32_bf16 v[174:177], v[238:241], a[220:223], v[174:177]
    v_add_f32 v116, v116, v124
    v_add_f32 v100, v100, v116
    v_mfma_f32_16x16x32_bf16 v[178:181], v[242:245], a[220:223], v[178:181]
    ds_write_b128 v41, v[170:173] offset:32896
    v_mfma_f32_16x16x32_bf16 v[182:185], v[246:249], a[220:223], v[182:185]
    v_fmac_f32 v62, v100, v78
    v_add_f32 v101, v101, v109
    v_mfma_f32_16x16x32_bf16 v[186:189], v[250:253], a[220:223], v[186:189]
    v_add_f32 v117, v117, v125
    s_waitcnt vmcnt(7)
    v_mfma_f32_16x16x32_bf16 v[174:177], a[0:3], a[128:131], v[174:177]
    v_add_f32 v101, v101, v117
    v_fmac_f32 v63, v101, v79
    v_mfma_f32_16x16x32_bf16 v[178:181], a[4:7], a[128:131], v[178:181]
    v_cvt_pk_bf16_f32 v86, v56, v57
    v_cvt_pk_bf16_f32 v87, v58, v59
    v_mfma_f32_16x16x32_bf16 v[182:185], a[8:11], a[128:131], v[182:185]
    v_cvt_pk_bf16_f32 v88, v60, v61
    v_cvt_pk_bf16_f32 v89, v62, v63
    v_mfma_f32_16x16x32_bf16 v[186:189], a[12:15], a[128:131], v[186:189]
    buffer_store_dwordx4 v[86:89], v46, s[56:59], s19 offen sc1 nt
    s_waitcnt vmcnt(7)
    v_mfma_f32_16x16x32_bf16 v[174:177], a[16:19], a[132:135], v[174:177]
    s_add_u32 s19, s19, 917504
    v_lshlrev_b32 v64, 16, v28
    v_mfma_f32_16x16x32_bf16 v[178:181], a[20:23], a[132:135], v[178:181]
    v_and_b32 v65, 0xffff0000, v28
    v_lshlrev_b32 v66, 16, v29
    v_mfma_f32_16x16x32_bf16 v[182:185], a[24:27], a[132:135], v[182:185]
    v_and_b32 v67, 0xffff0000, v29
    v_lshlrev_b32 v68, 16, v30
    v_mfma_f32_16x16x32_bf16 v[186:189], a[28:31], a[132:135], v[186:189]
    v_and_b32 v69, 0xffff0000, v30
    s_waitcnt vmcnt(6)
    v_mfma_f32_16x16x32_bf16 v[174:177], a[32:35], a[136:139], v[174:177]
    v_lshlrev_b32 v70, 16, v31
    v_and_b32 v71, 0xffff0000, v31
    v_mfma_f32_16x16x32_bf16 v[178:181], a[36:39], a[136:139], v[178:181]
    v_mfma_f32_16x16x32_bf16 v[182:185], a[40:43], a[136:139], v[182:185]
    v_mfma_f32_16x16x32_bf16 v[186:189], a[44:47], a[136:139], v[186:189]
    s_waitcnt vmcnt(5)
    v_mfma_f32_16x16x32_bf16 v[174:177], a[48:51], a[140:143], v[174:177]
    v_mfma_f32_16x16x32_bf16 v[178:181], a[52:55], a[140:143], v[178:181]
    v_mfma_f32_16x16x32_bf16 v[182:185], a[56:59], a[140:143], v[182:185]
    v_mfma_f32_16x16x32_bf16 v[186:189], a[60:63], a[140:143], v[186:189]
    s_waitcnt vmcnt(4)
    v_mfma_f32_16x16x32_bf16 v[174:177], a[64:67], a[144:147], v[174:177]
    v_mfma_f32_16x16x32_bf16 v[178:181], a[68:71], a[144:147], v[178:181]
    v_mfma_f32_16x16x32_bf16 v[182:185], a[72:75], a[144:147], v[182:185]
    v_mfma_f32_16x16x32_bf16 v[186:189], a[76:79], a[144:147], v[186:189]
    s_waitcnt vmcnt(1)
    v_mfma_f32_16x16x32_bf16 v[174:177], a[80:83], a[148:151], v[174:177]
    v_mfma_f32_16x16x32_bf16 v[174:177], a[96:99], a[152:155], v[174:177]
    v_mfma_f32_16x16x32_bf16 v[174:177], a[112:115], a[156:159], v[174:177]
    v_mfma_f32_16x16x32_bf16 v[178:181], a[84:87], a[148:151], v[178:181]
    v_mfma_f32_16x16x32_bf16 v[178:181], a[100:103], a[152:155], v[178:181]
    v_mfma_f32_16x16x32_bf16 v[178:181], a[116:119], a[156:159], v[178:181]
    v_mfma_f32_16x16x32_bf16 v[182:185], a[88:91], a[148:151], v[182:185]
    v_mfma_f32_16x16x32_bf16 v[182:185], a[104:107], a[152:155], v[182:185]
    v_mfma_f32_16x16x32_bf16 v[182:185], a[120:123], a[156:159], v[182:185]
    v_mfma_f32_16x16x32_bf16 v[186:189], a[92:95], a[148:151], v[186:189]
    v_mfma_f32_16x16x32_bf16 v[186:189], a[108:111], a[152:155], v[186:189]
    v_mfma_f32_16x16x32_bf16 v[186:189], a[124:127], a[156:159], v[186:189]
    ds_write_b128 v40, v[174:177] offset:36864
    s_nop 0
    ds_write_b128 v41, v[178:181] offset:36864
    s_nop 1
    ds_write_b128 v40, v[182:185] offset:36992
    s_nop 1
    ds_write_b128 v41, v[186:189] offset:36992
    s_waitcnt lgkmcnt(0)
    s_barrier
    ds_read_b128 v[94:97], v44 offset:32768
    ds_read_b128 v[98:101], v45 offset:32768
    ds_read_b128 v[102:105], v44 offset:40960
    ds_read_b128 v[106:109], v45 offset:40960
    ds_read_b128 v[110:113], v44 offset:49152
    ds_read_b128 v[114:117], v45 offset:49152
    ds_read_b128 v[118:121], v44 offset:57344
    ds_read_b128 v[122:125], v45 offset:57344
    s_waitcnt lgkmcnt(0)
    v_pk_add_f32 v[94:95], v[94:95], v[102:103]
    v_pk_add_f32 v[110:111], v[110:111], v[118:119]
    v_pk_add_f32 v[94:95], v[94:95], v[110:111]
    v_pk_fma_f32 v[64:65], v[94:95], v[72:73], v[64:65]
    v_pk_add_f32 v[96:97], v[96:97], v[104:105]
    v_pk_add_f32 v[112:113], v[112:113], v[120:121]
    v_pk_add_f32 v[96:97], v[96:97], v[112:113]
    v_pk_fma_f32 v[66:67], v[96:97], v[74:75], v[66:67]
    v_pk_add_f32 v[98:99], v[98:99], v[106:107]
    v_pk_add_f32 v[114:115], v[114:115], v[122:123]
    v_pk_add_f32 v[98:99], v[98:99], v[114:115]
    v_pk_fma_f32 v[68:69], v[98:99], v[76:77], v[68:69]
    v_pk_add_f32 v[100:101], v[100:101], v[108:109]
    v_pk_add_f32 v[116:117], v[116:117], v[124:125]
    v_pk_add_f32 v[100:101], v[100:101], v[116:117]
    v_pk_fma_f32 v[70:71], v[100:101], v[78:79], v[70:71]
    v_cvt_pk_bf16_f32 v90, v64, v65
    v_cvt_pk_bf16_f32 v91, v66, v67
    v_cvt_pk_bf16_f32 v92, v68, v69
    v_cvt_pk_bf16_f32 v93, v70, v71
    buffer_store_dwordx4 v[90:93], v46, s[56:59], s19 offen sc1 nt
    s_add_u32 s19, s19, 917504
    s_cmp_lg_u32 s2, 32
    s_cbranch_scc1 L_noep
    v_mov_b32 v2, s65
    v_mov_b32 v3, 0
    buffer_store_dword v2, v3, s[44:47], 0 offen sc1
L_noep:
    s_endpgm
    .p2align 12
L_varB:
    buffer_load_dword v5, v101, s[40:43], 0 offen
    s_mov_b64 exec, 0
    s_cmp_eq_u32 s64, 0
    s_cbranch_scc1 L_padS0_B
    s_cmp_eq_u32 s64, 1
    s_cbranch_scc1 L_padS1_B
    s_cmp_eq_u32 s64, 2
    s_cbranch_scc1 L_padS2_B
    s_branch L_padS3_B
L_padS2_B:
L_retS_B:
    s_mov_b64 exec, -1
    s_waitcnt lgkmcnt(0)
    s_add_u32 s65, s65, 1
    s_lshl_b32 s74, s72, 16
    s_and_b32 s75, s72, 0xffff0000
    s_lshl_b32 s76, s73, 16
    s_and_b32 s77, s73, 0xffff0000
    s_cmp_lt_u32 s64, 2
    s_cselect_b32 s72, s74, s75
    s_cselect_b32 s73, s76, s77
    v_mov_b32 v98, 0x3fb8aa3b
    v_mul_f32 v102, s72, v98
    v_exp_f32 v102, v102
    s_nop 0
    v_cvt_pk_bf16_f32 v102, v102, v102
    v_lshlrev_b32 v102, 16, v102
    s_waitcnt vmcnt(4)
    v_lshlrev_b32 v174, 16, v66
    v_lshlrev_b32 v175, 16, v67
    v_lshlrev_b32 v176, 16, v68
    v_lshlrev_b32 v177, 16, v69
    v_lshlrev_b32 v178, 16, v70
    v_lshlrev_b32 v179, 16, v71
    v_mul_f32 v174, v102, v174
    v_mul_f32 v175, v102, v175
    v_mul_f32 v174, 0x3fb8aa3b, v174
    v_mul_f32 v175, 0.15915494, v175
    v_mul_f32 v176, v102, v176
    v_mul_f32 v177, v102, v177
    v_mul_f32 v98, 0x41000000, v174
    v_mul_f32 v99, 0x41000000, v175
    v_exp_f32 v98, v98
    v_fract_f32 v99, v99
    v_cos_f32 v188, v99
    v_sin_f32 v189, v99
    v_mul_f32 v188, v188, v98
    v_mul_f32 v189, v189, v98
    v_exp_f32 v98, v174
    v_fract_f32 v99, v175
    v_cos_f32 v182, v99
    v_sin_f32 v183, v99
    v_mul_f32 v182, v182, v98
    v_mul_f32 v183, v183, v98
    v_mul_f32 v98, 0x43800000, v174
    v_mul_f32 v99, 0x43800000, v175
    v_exp_f32 v98, v98
    v_fract_f32 v99, v99
    v_cos_f32 v190, v99
    v_sin_f32 v191, v99
    v_mul_f32 v190, v190, v98
    v_mul_f32 v191, v191, v98
    .p2align 3
    v_pk_mul_f32 v[184:185], v[182:183], v[182:183] op_sel:[0,0] op_sel_hi:[1,0]
    v_pk_fma_f32 v[184:185], v[182:183], v[182:183], v[184:185] op_sel:[1,1,0] op_sel_hi:[0,1,1] neg_lo:[0,1,0]
    v_cvt_pk_bf16_f32 v200, v188, v189
    v_pk_mul_f32 v[180:181], v[178:179], v[176:177] op_sel:[0,0] op_sel_hi:[1,0]
    v_pk_fma_f32 v[180:181], v[178:179], v[176:177], v[180:181] op_sel:[1,1,0] op_sel_hi:[0,1,1] neg_lo:[0,1,0]
    v_pk_mul_f32 v[186:187], v[184:185], v[184:185] op_sel:[0,0] op_sel_hi:[1,0]
    v_pk_fma_f32 v[186:187], v[184:185], v[184:185], v[186:187] op_sel:[1,1,0] op_sel_hi:[0,1,1] neg_lo:[0,1,0]
    v_cvt_pk_bf16_f32 v201, v180, -v181
    v_pk_mul_f32 v[192:193], v[188:189], v[188:189] op_sel:[0,0] op_sel_hi:[1,0]
    v_pk_fma_f32 v[192:193], v[188:189], v[188:189], v[192:193] op_sel:[1,1,0] op_sel_hi:[0,1,1] neg_lo:[0,1,0]
    v_cvt_pk_bf16_f32 v202, v192, v193
    v_pk_mul_f32 v[194:195], v[192:193], v[188:189] op_sel:[0,0] op_sel_hi:[1,0]
    v_pk_fma_f32 v[194:195], v[192:193], v[188:189], v[194:195] op_sel:[1,1,0] op_sel_hi:[0,1,1] neg_lo:[0,1,0]
    v_cvt_pk_bf16_f32 v203, v194, v195
    buffer_load_dword v54, v31, s[40:43], s79 offen
    ds_write_addtid_b32 v200 offset:272
    ds_write_addtid_b32 v201 offset:8704
    ds_write_addtid_b32 v202 offset:544
    ds_write_addtid_b32 v203 offset:816
    .p2align 3
    v_pk_mul_f32 v[192:193], v[194:195], v[188:189] op_sel:[0,0] op_sel_hi:[1,0]
    v_pk_fma_f32 v[192:193], v[194:195], v[188:189], v[192:193] op_sel:[1,1,0] op_sel_hi:[0,1,1] neg_lo:[0,1,0]
    v_cvt_pk_bf16_f32 v204, v192, v193
    v_pk_mul_f32 v[194:195], v[192:193], v[188:189] op_sel:[0,0] op_sel_hi:[1,0]
    v_pk_fma_f32 v[194:195], v[192:193], v[188:189], v[194:195] op_sel:[1,1,0] op_sel_hi:[0,1,1] neg_lo:[0,1,0]
    v_cvt_pk_bf16_f32 v205, v194, v195
    v_pk_mul_f32 v[192:193], v[194:195], v[188:189] op_sel:[0,0] op_sel_hi:[1,0]
    v_pk_fma_f32 v[192:193], v[194:195], v[188:189], v[192:193] op_sel:[1,1,0] op_sel_hi:[0,1,1] neg_lo:[0,1,0]
    v_cvt_pk_bf16_f32 v206, v192, v193
    v_pk_mul_f32 v[194:195], v[192:193], v[188:189] op_sel:[0,0] op_sel_hi:[1,0]
    v_pk_fma_f32 v[194:195], v[192:193], v[188:189], v[194:195] op_sel:[1,1,0] op_sel_hi:[0,1,1] neg_lo:[0,1,0]
    v_cvt_pk_bf16_f32 v207, v194, v195
    ds_write_addtid_b32 v204 offset:1088
    ds_write_addtid_b32 v205 offset:1360
    ds_write_addtid_b32 v206 offset:1632
    ds_write_addtid_b32 v207 offset:1904
    .p2align 3
    v_pk_mul_f32 v[192:193], v[194:195], v[188:189] op_sel:[0,0] op_sel_hi:[1,0]
    v_pk_fma_f32 v[192:193], v[194:195], v[188:189], v[192:193] op_sel:[1,1,0] op_sel_hi:[0,1,1] neg_lo:[0,1,0]
    v_cvt_pk_bf16_f32 v200, v192, v193
    v_pk_mul_f32 v[194:195], v[192:193], v[188:189] op_sel:[0,0] op_sel_hi:[1,0]
    v_pk_fma_f32 v[194:195], v[192:193], v[188:189], v[194:195] op_sel:[1,1,0] op_sel_hi:[0,1,1] neg_lo:[0,1,0]
    v_cvt_pk_bf16_f32 v201, v194, v195
    v_pk_mul_f32 v[192:193], v[194:195], v[188:189] op_sel:[0,0] op_sel_hi:[1,0]
    v_pk_fma_f32 v[192:193], v[194:195], v[188:189], v[192:193] op_sel:[1,1,0] op_sel_hi:[0,1,1] neg_lo:[0,1,0]
    v_cvt_pk_bf16_f32 v202, v192, v193
    v_pk_mul_f32 v[194:195], v[192:193], v[188:189] op_sel:[0,0] op_sel_hi:[1,0]
    v_pk_fma_f32 v[194:195], v[192:193], v[188:189], v[194:195] op_sel:[1,1,0] op_sel_hi:[0,1,1] neg_lo:[0,1,0]
    v_cvt_pk_bf16_f32 v203, v194, v195
    ds_write_addtid_b32 v200 offset:2176
    ds_write_addtid_b32 v201 offset:2448
    ds_write_addtid_b32 v202 offset:2720
    ds_write_addtid_b32 v203 offset:2992
    .p2align 3
    v_pk_mul_f32 v[192:193], v[194:195], v[188:189] op_sel:[0,0] op_sel_hi:[1,0]
    v_pk_fma_f32 v[192:193], v[194:195], v[188:189], v[192:193] op_sel:[1,1,0] op_sel_hi:[0,1,1] neg_lo:[0,1,0]
    v_cvt_pk_bf16_f32 v204, v192, v193
    v_pk_mul_f32 v[194:195], v[192:193], v[188:189] op_sel:[0,0] op_sel_hi:[1,0]
    v_pk_fma_f32 v[194:195], v[192:193], v[188:189], v[194:195] op_sel:[1,1,0] op_sel_hi:[0,1,1] neg_lo:[0,1,0]
    v_cvt_pk_bf16_f32 v205, v194, v195
    v_pk_mul_f32 v[192:193], v[194:195], v[188:189] op_sel:[0,0] op_sel_hi:[1,0]
    v_pk_fma_f32 v[192:193], v[194:195], v[188:189], v[192:193] op_sel:[1,1,0] op_sel_hi:[0,1,1] neg_lo:[0,1,0]
    v_cvt_pk_bf16_f32 v206, v192, v193
    v_pk_mul_f32 v[194:195], v[192:193], v[188:189] op_sel:[0,0] op_sel_hi:[1,0]
    v_pk_fma_f32 v[194:195], v[192:193], v[188:189], v[194:195] op_sel:[1,1,0] op_sel_hi:[0,1,1] neg_lo:[0,1,0]
    v_cvt_pk_bf16_f32 v207, v194, v195
    ds_write_addtid_b32 v204 offset:3264
    ds_write_addtid_b32 v205 offset:3536
    ds_write_addtid_b32 v206 offset:3808
    ds_write_addtid_b32 v207 offset:4080
    .p2align 3
    v_pk_mul_f32 v[192:193], v[194:195], v[188:189] op_sel:[0,0] op_sel_hi:[1,0]
    v_pk_fma_f32 v[192:193], v[194:195], v[188:189], v[192:193] op_sel:[1,1,0] op_sel_hi:[0,1,1] neg_lo:[0,1,0]
    v_cvt_pk_bf16_f32 v200, v192, v193
    v_pk_mul_f32 v[194:195], v[192:193], v[188:189] op_sel:[0,0] op_sel_hi:[1,0]
    v_pk_fma_f32 v[194:195], v[192:193], v[188:189], v[194:195] op_sel:[1,1,0] op_sel_hi:[0,1,1] neg_lo:[0,1,0]
    v_cvt_pk_bf16_f32 v201, v194, v195
    v_pk_mul_f32 v[192:193], v[194:195], v[188:189] op_sel:[0,0] op_sel_hi:[1,0]
    v_pk_fma_f32 v[192:193], v[194:195], v[188:189], v[192:193] op_sel:[1,1,0] op_sel_hi:[0,1,1] neg_lo:[0,1,0]
    v_cvt_pk_bf16_f32 v202, v192, v193
    v_pk_mul_f32 v[194:195], v[192:193], v[188:189] op_sel:[0,0] op_sel_hi:[1,0]
    v_pk_fma_f32 v[194:195], v[192:193], v[188:189], v[194:195] op_sel:[1,1,0] op_sel_hi:[0,1,1] neg_lo:[0,1,0]
    v_cvt_pk_bf16_f32 v203, v194, v195
    s_waitcnt vmcnt(2)
    v_mov_b32 v214, 0x3f803f80
    v_mov_b32 v212, 0
    v_mov_b32 v213, 0
    v_dot2c_f32_bf16 v212, v88, v214
    v_dot2c_f32_bf16 v213, v88, v88
    v_dot2c_f32_bf16 v212, v89, v214
    v_dot2c_f32_bf16 v213, v89, v89
    v_dot2c_f32_bf16 v212, v90, v214
    v_dot2c_f32_bf16 v213, v90, v90
    v_dot2c_f32_bf16 v212, v91, v214
    v_dot2c_f32_bf16 v213, v91, v91
    v_dot2c_f32_bf16 v212, v92, v214
    v_dot2c_f32_bf16 v213, v92, v92
    v_dot2c_f32_bf16 v212, v93, v214
    v_dot2c_f32_bf16 v213, v93, v93
    v_dot2c_f32_bf16 v212, v94, v214
    v_dot2c_f32_bf16 v213, v94, v94
    v_dot2c_f32_bf16 v212, v95, v214
    v_dot2c_f32_bf16 v213, v95, v95
    s_nop 1
    v_add_f32_dpp v212, v212, v212 row_shr:1 row_mask:0xf bank_mask:0xf bound_ctrl:1
    v_add_f32_dpp v213, v213, v213 row_shr:1 row_mask:0xf bank_mask:0xf bound_ctrl:1
    s_nop 0
    v_add_f32_dpp v212, v212, v212 row_shr:2 row_mask:0xf bank_mask:0xf bound_ctrl:1
    v_add_f32_dpp v213, v213, v213 row_shr:2 row_mask:0xf bank_mask:0xf bound_ctrl:1
    s_nop 0
    v_add_f32_dpp v212, v212, v212 row_shr:4 row_mask:0xf bank_mask:0xf bound_ctrl:1
    v_add_f32_dpp v213, v213, v213 row_shr:4 row_mask:0xf bank_mask:0xf bound_ctrl:1
    s_nop 0
    v_add_f32_dpp v212, v212, v212 row_shr:8 row_mask:0xf bank_mask:0xf bound_ctrl:1
    v_add_f32_dpp v213, v213, v213 row_shr:8 row_mask:0xf bank_mask:0xf bound_ctrl:1
    s_nop 0
    v_add_f32_dpp v212, v212, v212 row_bcast:15 row_mask:0xa bank_mask:0xf
    v_add_f32_dpp v213, v213, v213 row_bcast:15 row_mask:0xa bank_mask:0xf
    v_mul_f32 v212, 0x3b124925, v212
    v_mul_f32 v215, v212, v212
    v_mov_b32 v214, 0x3b124925
    v_fma_f32 v213, v213, v214, -v215
    v_max_f32 v213, 0, v213
    v_add_f32 v213, 0x3727c5ac, v213
    v_rsq_f32 v210, v213
    v_mov_b32 v211, s65
    v_mul_f32 v212, v212, v210
    v_readlane_b32 s75, v210, 31
    v_readlane_b32 s76, v212, 31
    s_lshl_b32 s74, s36, 4
    s_add_u32 s74, s74, 4096
    v_mov_b32 v209, s75
    v_cvt_pk_bf16_f32 v208, -s76, -v212
    s_mov_b32 exec_lo, 0
    s_mov_b32 exec_hi, 0x80000000
    buffer_store_dwordx4 v[208:211], off, s[44:47], s74 sc1
    s_mov_b64 exec, -1
    buffer_load_dword v55, v31, s[40:43], s79 offen offset:896
    s_add_u32 s79, s79, 114688
    ds_write_addtid_b32 v200 offset:4352
    ds_write_addtid_b32 v201 offset:4624
    ds_write_addtid_b32 v202 offset:4896
    ds_write_addtid_b32 v203 offset:5168
    .p2align 3
    v_pk_mul_f32 v[192:193], v[194:195], v[188:189] op_sel:[0,0] op_sel_hi:[1,0]
    v_pk_fma_f32 v[192:193], v[194:195], v[188:189], v[192:193] op_sel:[1,1,0] op_sel_hi:[0,1,1] neg_lo:[0,1,0]
    v_cvt_pk_bf16_f32 v204, v192, v193
    v_pk_mul_f32 v[194:195], v[192:193], v[188:189] op_sel:[0,0] op_sel_hi:[1,0]
    v_pk_fma_f32 v[194:195], v[192:193], v[188:189], v[194:195] op_sel:[1,1,0] op_sel_hi:[0,1,1] neg_lo:[0,1,0]
    v_cvt_pk_bf16_f32 v205, v194, v195
    v_pk_mul_f32 v[192:193], v[194:195], v[188:189] op_sel:[0,0] op_sel_hi:[1,0]
    v_pk_fma_f32 v[192:193], v[194:195], v[188:189], v[192:193] op_sel:[1,1,0] op_sel_hi:[0,1,1] neg_lo:[0,1,0]
    v_cvt_pk_bf16_f32 v206, v192, v193
    v_pk_mul_f32 v[194:195], v[192:193], v[188:189] op_sel:[0,0] op_sel_hi:[1,0]
    v_pk_fma_f32 v[194:195], v[192:193], v[188:189], v[194:195] op_sel:[1,1,0] op_sel_hi:[0,1,1] neg_lo:[0,1,0]
    v_cvt_pk_bf16_f32 v207, v194, v195
    ds_write_addtid_b32 v204 offset:5440
    ds_write_addtid_b32 v205 offset:5712
    ds_write_addtid_b32 v206 offset:5984
    ds_write_addtid_b32 v207 offset:6256
    .p2align 3
    v_pk_mul_f32 v[192:193], v[194:195], v[188:189] op_sel:[0,0] op_sel_hi:[1,0]
    v_pk_fma_f32 v[192:193], v[194:195], v[188:189], v[192:193] op_sel:[1,1,0] op_sel_hi:[0,1,1] neg_lo:[0,1,0]
    v_cvt_pk_bf16_f32 v200, v192, v193
    v_pk_mul_f32 v[194:195], v[192:193], v[188:189] op_sel:[0,0] op_sel_hi:[1,0]
    v_pk_fma_f32 v[194:195], v[192:193], v[188:189], v[194:195] op_sel:[1,1,0] op_sel_hi:[0,1,1] neg_lo:[0,1,0]
    v_cvt_pk_bf16_f32 v201, v194, v195
    v_pk_mul_f32 v[192:193], v[194:195], v[188:189] op_sel:[0,0] op_sel_hi:[1,0]
    v_pk_fma_f32 v[192:193], v[194:195], v[188:189], v[192:193] op_sel:[1,1,0] op_sel_hi:[0,1,1] neg_lo:[0,1,0]
    v_cvt_pk_bf16_f32 v202, v192, v193
    v_pk_mul_f32 v[194:195], v[192:193], v[188:189] op_sel:[0,0] op_sel_hi:[1,0]
    v_pk_fma_f32 v[194:195], v[192:193], v[188:189], v[194:195] op_sel:[1,1,0] op_sel_hi:[0,1,1] neg_lo:[0,1,0]
    v_cvt_pk_bf16_f32 v203, v194, v195
    ds_write_addtid_b32 v200 offset:6528
    ds_write_addtid_b32 v201 offset:6800
    ds_write_addtid_b32 v202 offset:7072
    ds_write_addtid_b32 v203 offset:7344
    .p2align 3
    v_pk_mul_f32 v[192:193], v[194:195], v[188:189] op_sel:[0,0] op_sel_hi:[1,0]
    v_pk_fma_f32 v[192:193], v[194:195], v[188:189], v[192:193] op_sel:[1,1,0] op_sel_hi:[0,1,1] neg_lo:[0,1,0]
    v_cvt_pk_bf16_f32 v204, v192, v193
    v_pk_mul_f32 v[194:195], v[192:193], v[188:189] op_sel:[0,0] op_sel_hi:[1,0]
    v_pk_fma_f32 v[194:195], v[192:193], v[188:189], v[194:195] op_sel:[1,1,0] op_sel_hi:[0,1,1] neg_lo:[0,1,0]
    v_cvt_pk_bf16_f32 v205, v194, v195
    v_pk_mul_f32 v[192:193], v[194:195], v[188:189] op_sel:[0,0] op_sel_hi:[1,0]
    v_pk_fma_f32 v[192:193], v[194:195], v[188:189], v[192:193] op_sel:[1,1,0] op_sel_hi:[0,1,1] neg_lo:[0,1,0]
    v_cvt_pk_bf16_f32 v206, v192, v193
    v_pk_mul_f32 v[194:195], v[192:193], v[188:189] op_sel:[0,0] op_sel_hi:[1,0]
    v_pk_fma_f32 v[194:195], v[192:193], v[188:189], v[194:195] op_sel:[1,1,0] op_sel_hi:[0,1,1] neg_lo:[0,1,0]
    v_cvt_pk_bf16_f32 v207, v194, v195
    ds_write_addtid_b32 v204 offset:7616
    ds_write_addtid_b32 v205 offset:7888
    ds_write_addtid_b32 v206 offset:8160
    ds_write_addtid_b32 v207 offset:8432
    .p2align 3
    v_pk_mul_f32 v[194:195], v[180:181], v[182:183] op_sel:[0,0] op_sel_hi:[1,0]
    v_pk_fma_f32 v[194:195], v[180:181], v[182:183], v[194:195] op_sel:[1,1,0] op_sel_hi:[0,1,1] neg_lo:[0,1,0]
    v_cvt_pk_bf16_f32 v200, v194, -v195
    v_pk_mul_f32 v[192:193], v[194:195], v[182:183] op_sel:[0,0] op_sel_hi:[1,0]
    v_pk_fma_f32 v[192:193], v[194:195], v[182:183], v[192:193] op_sel:[1,1,0] op_sel_hi:[0,1,1] neg_lo:[0,1,0]
    v_cvt_pk_bf16_f32 v201, v192, -v193
    v_pk_mul_f32 v[194:195], v[192:193], v[182:183] op_sel:[0,0] op_sel_hi:[1,0]
    v_pk_fma_f32 v[194:195], v[192:193], v[182:183], v[194:195] op_sel:[1,1,0] op_sel_hi:[0,1,1] neg_lo:[0,1,0]
    v_cvt_pk_bf16_f32 v202, v194, -v195
    v_pk_mul_f32 v[192:193], v[194:195], v[182:183] op_sel:[0,0] op_sel_hi:[1,0]
    v_pk_fma_f32 v[192:193], v[194:195], v[182:183], v[192:193] op_sel:[1,1,0] op_sel_hi:[0,1,1] neg_lo:[0,1,0]
    v_cvt_pk_bf16_f32 v203, v192, -v193
    ds_read_b128 v[142:145], v105 offset:0
    ds_read_b128 v[146:149], v105 offset:32
    ds_write_addtid_b32 v200 offset:8976
    ds_write_addtid_b32 v201 offset:9248
    ds_write_addtid_b32 v202 offset:9520
    ds_write_addtid_b32 v203 offset:9792
    .p2align 3
    v_pk_mul_f32 v[194:195], v[192:193], v[182:183] op_sel:[0,0] op_sel_hi:[1,0]
    v_pk_fma_f32 v[194:195], v[192:193], v[182:183], v[194:195] op_sel:[1,1,0] op_sel_hi:[0,1,1] neg_lo:[0,1,0]
    v_cvt_pk_bf16_f32 v204, v194, -v195
    v_pk_mul_f32 v[192:193], v[194:195], v[182:183] op_sel:[0,0] op_sel_hi:[1,0]
    v_pk_fma_f32 v[192:193], v[194:195], v[182:183], v[192:193] op_sel:[1,1,0] op_sel_hi:[0,1,1] neg_lo:[0,1,0]
    v_cvt_pk_bf16_f32 v205, v192, -v193
    v_pk_mul_f32 v[194:195], v[192:193], v[182:183] op_sel:[0,0] op_sel_hi:[1,0]
    v_pk_fma_f32 v[194:195], v[192:193], v[182:183], v[194:195] op_sel:[1,1,0] op_sel_hi:[0,1,1] neg_lo:[0,1,0]
    v_cvt_pk_bf16_f32 v206, v194, -v195
    v_pk_mul_f32 v[198:199], v[180:181], v[190:191] op_sel:[0,0] op_sel_hi:[1,0]
    v_pk_fma_f32 v[198:199], v[180:181], v[190:191], v[198:199] op_sel:[1,1,0] op_sel_hi:[0,1,1] neg_lo:[0,1,0]
    v_cvt_pk_bf16_f32 v207, v198, -v199
    buffer_load_dword v56, v31, s[40:43], s79 offen
    ds_read_b128 v[150:153], v105 offset:64
    ds_write_addtid_b32 v204 offset:10064
    ds_write_addtid_b32 v205 offset:10336
    ds_write_addtid_b32 v206 offset:10608
    ds_write_addtid_b32 v207 offset:10880
    .p2align 3
    v_pk_mul_f32 v[194:195], v[198:199], v[184:185] op_sel:[0,0] op_sel_hi:[1,0]
    v_pk_fma_f32 v[194:195], v[198:199], v[184:185], v[194:195] op_sel:[1,1,0] op_sel_hi:[0,1,1] neg_lo:[0,1,0]
    v_cvt_pk_bf16_f32 v200, v194, -v195
    v_pk_mul_f32 v[192:193], v[194:195], v[184:185] op_sel:[0,0] op_sel_hi:[1,0]
    v_pk_fma_f32 v[192:193], v[194:195], v[184:185], v[192:193] op_sel:[1,1,0] op_sel_hi:[0,1,1] neg_lo:[0,1,0]
    v_cvt_pk_bf16_f32 v201, v192, -v193
    v_pk_mul_f32 v[194:195], v[192:193], v[184:185] op_sel:[0,0] op_sel_hi:[1,0]
    v_pk_fma_f32 v[194:195], v[192:193], v[184:185], v[194:195] op_sel:[1,1,0] op_sel_hi:[0,1,1] neg_lo:[0,1,0]
    v_cvt_pk_bf16_f32 v202, v194, -v195
    v_pk_mul_f32 v[192:193], v[194:195], v[184:185] op_sel:[0,0] op_sel_hi:[1,0]
    v_pk_fma_f32 v[192:193], v[194:195], v[184:185], v[192:193] op_sel:[1,1,0] op_sel_hi:[0,1,1] neg_lo:[0,1,0]
    v_cvt_pk_bf16_f32 v203, v192, -v193
    ds_read_b128 v[154:157], v105 offset:96
    ds_write_addtid_b32 v200 offset:11152
    ds_write_addtid_b32 v201 offset:11968
    ds_write_addtid_b32 v201 offset:11424
    ds_write_addtid_b32 v202 offset:12240
    ds_write_addtid_b32 v203 offset:12512
    .p2align 3
    v_pk_mul_f32 v[196:197], v[198:199], v[190:191] op_sel:[0,0] op_sel_hi:[1,0]
    v_pk_fma_f32 v[196:197], v[198:199], v[190:191], v[196:197] op_sel:[1,1,0] op_sel_hi:[0,1,1] neg_lo:[0,1,0]
    v_cvt_pk_bf16_f32 v204, v196, -v197
    v_pk_mul_f32 v[194:195], v[196:197], v[186:187] op_sel:[0,0] op_sel_hi:[1,0]
    v_pk_fma_f32 v[194:195], v[196:197], v[186:187], v[194:195] op_sel:[1,1,0] op_sel_hi:[0,1,1] neg_lo:[0,1,0]
    v_cvt_pk_bf16_f32 v205, v194, -v195
    v_pk_mul_f32 v[192:193], v[194:195], v[186:187] op_sel:[0,0] op_sel_hi:[1,0]
    v_pk_fma_f32 v[192:193], v[194:195], v[186:187], v[192:193] op_sel:[1,1,0] op_sel_hi:[0,1,1] neg_lo:[0,1,0]
    v_cvt_pk_bf16_f32 v206, v192, -v193
    v_pk_mul_f32 v[198:199], v[196:197], v[190:191] op_sel:[0,0] op_sel_hi:[1,0]
    v_pk_fma_f32 v[198:199], v[196:197], v[190:191], v[198:199] op_sel:[1,1,0] op_sel_hi:[0,1,1] neg_lo:[0,1,0]
    v_cvt_pk_bf16_f32 v207, v198, -v199
    ds_read_b128 v[158:161], v105 offset:128
    ds_read_b128 v[162:165], v105 offset:160
    ds_write_addtid_b32 v204 offset:11696
    ds_write_addtid_b32 v205 offset:13056
    ds_write_addtid_b32 v206 offset:13328
    ds_write_addtid_b32 v207 offset:12784
    .p2align 3
    v_pk_mul_f32 v[194:195], v[198:199], v[186:187] op_sel:[0,0] op_sel_hi:[1,0]
    v_pk_fma_f32 v[194:195], v[198:199], v[186:187], v[194:195] op_sel:[1,1,0] op_sel_hi:[0,1,1] neg_lo:[0,1,0]
    v_cvt_pk_bf16_f32 v200, v194, -v195
    v_pk_mul_f32 v[192:193], v[194:195], v[186:187] op_sel:[0,0] op_sel_hi:[1,0]
    v_pk_fma_f32 v[192:193], v[194:195], v[186:187], v[192:193] op_sel:[1,1,0] op_sel_hi:[0,1,1] neg_lo:[0,1,0]
    v_cvt_pk_bf16_f32 v201, v192, -v193
    v_pk_mul_f32 v[196:197], v[198:199], v[190:191] op_sel:[0,0] op_sel_hi:[1,0]
    v_pk_fma_f32 v[196:197], v[198:199], v[190:191], v[196:197] op_sel:[1,1,0] op_sel_hi:[0,1,1] neg_lo:[0,1,0]
    v_cvt_pk_bf16_f32 v202, v196, -v197
    v_pk_mul_f32 v[194:195], v[196:197], v[188:189] op_sel:[0,0] op_sel_hi:[1,0]
    v_pk_fma_f32 v[194:195], v[196:197], v[188:189], v[194:195] op_sel:[1,1,0] op_sel_hi:[0,1,1] neg_lo:[0,1,0]
    v_cvt_pk_bf16_f32 v203, v194, -v195
    ds_read_b128 v[166:169], v105 offset:192
    ds_write_addtid_b32 v200 offset:14144
    ds_write_addtid_b32 v201 offset:14416
    ds_write_addtid_b32 v202 offset:13600
    ds_write_addtid_b32 v203 offset:13872
    .p2align 3
    v_pk_mul_f32 v[198:199], v[196:197], v[190:191] op_sel:[0,0] op_sel_hi:[1,0]
    v_pk_fma_f32 v[198:199], v[196:197], v[190:191], v[198:199] op_sel:[1,1,0] op_sel_hi:[0,1,1] neg_lo:[0,1,0]
    v_cvt_pk_bf16_f32 v204, v198, -v199
    v_pk_mul_f32 v[194:195], v[198:199], v[188:189] op_sel:[0,0] op_sel_hi:[1,0]
    v_pk_fma_f32 v[194:195], v[198:199], v[188:189], v[194:195] op_sel:[1,1,0] op_sel_hi:[0,1,1] neg_lo:[0,1,0]
    v_cvt_pk_bf16_f32 v205, v194, -v195
    v_pk_mul_f32 v[196:197], v[198:199], v[190:191] op_sel:[0,0] op_sel_hi:[1,0]
    v_pk_fma_f32 v[196:197], v[198:199], v[190:191], v[196:197] op_sel:[1,1,0] op_sel_hi:[0,1,1] neg_lo:[0,1,0]
    v_cvt_pk_bf16_f32 v206, v196, -v197
    v_pk_mul_f32 v[194:195], v[196:197], v[188:189] op_sel:[0,0] op_sel_hi:[1,0]
    v_pk_fma_f32 v[194:195], v[196:197], v[188:189], v[194:195] op_sel:[1,1,0] op_sel_hi:[0,1,1] neg_lo:[0,1,0]
    v_cvt_pk_bf16_f32 v207, v194, -v195
    ds_read_b128 v[170:173], v105 offset:224
    ds_write_addtid_b32 v204 offset:15232
    ds_write_addtid_b32 v205 offset:15504
    ds_write_addtid_b32 v206 offset:14688
    ds_write_addtid_b32 v207 offset:14960
    .p2align 3
    v_pk_mul_f32 v[198:199], v[196:197], v[190:191] op_sel:[0,0] op_sel_hi:[1,0]
    v_pk_fma_f32 v[198:199], v[196:197], v[190:191], v[198:199] op_sel:[1,1,0] op_sel_hi:[0,1,1] neg_lo:[0,1,0]
    v_cvt_pk_bf16_f32 v200, v198, -v199
    v_pk_mul_f32 v[194:195], v[198:199], v[188:189] op_sel:[0,0] op_sel_hi:[1,0]
    v_pk_fma_f32 v[194:195], v[198:199], v[188:189], v[194:195] op_sel:[1,1,0] op_sel_hi:[0,1,1] neg_lo:[0,1,0]
    v_cvt_pk_bf16_f32 v201, v194, -v195
    ds_write_addtid_b32 v200 offset:15776
    ds_write_addtid_b32 v201 offset:16048
    ds_read_b128 v[110:113], v104 offset:0
    ds_read_b128 v[114:117], v104 offset:32
    ds_read_b128 v[118:121], v104 offset:64
    ds_read_b128 v[122:125], v104 offset:96
    ds_read_b128 v[126:129], v104 offset:128
    ds_read_b128 v[130:133], v104 offset:160
    ds_read_b128 v[134:137], v104 offset:192
    ds_read_b128 v[138:141], v104 offset:224
    v_and_b32 v174, 0xffff0000, v66
    v_and_b32 v175, 0xffff0000, v67
    v_and_b32 v176, 0xffff0000, v68
    v_and_b32 v177, 0xffff0000, v69
    v_and_b32 v178, 0xffff0000, v70
    v_and_b32 v179, 0xffff0000, v71
    v_mul_f32 v174, v102, v174
    v_mul_f32 v175, v102, v175
    v_mul_f32 v174, 0x3fb8aa3b, v174
    v_mul_f32 v175, 0.15915494, v175
    s_waitcnt lgkmcnt(7)
    v_mfma_f32_32x32x16_bf16 v[72:87], v[110:113], v[142:145], 0
    v_mul_f32 v176, v102, v176
    v_mul_f32 v177, v102, v177
    v_mul_f32 v98, 0x41000000, v174
    v_mul_f32 v99, 0x41000000, v175
    s_waitcnt lgkmcnt(6)
    v_mfma_f32_32x32x16_bf16 v[72:87], v[114:117], v[146:149], v[72:87]
    v_exp_f32 v98, v98
    v_fract_f32 v99, v99
    v_cos_f32 v188, v99
    s_waitcnt lgkmcnt(5)
    v_mfma_f32_32x32x16_bf16 v[72:87], v[118:121], v[150:153], v[72:87]
    v_sin_f32 v189, v99
    v_mul_f32 v188, v188, v98
    s_waitcnt lgkmcnt(4)
    v_mfma_f32_32x32x16_bf16 v[72:87], v[122:125], v[154:157], v[72:87]
    v_mul_f32 v189, v189, v98
    v_exp_f32 v98, v174
    v_fract_f32 v99, v175
    s_waitcnt lgkmcnt(3)
    v_mfma_f32_32x32x16_bf16 v[72:87], v[126:129], v[158:161], v[72:87]
    v_cos_f32 v182, v99
    v_sin_f32 v183, v99
    s_waitcnt lgkmcnt(2)
    v_mfma_f32_32x32x16_bf16 v[72:87], v[130:133], v[162:165], v[72:87]
    v_mul_f32 v182, v182, v98
    v_mul_f32 v183, v183, v98
    v_mul_f32 v98, 0x43800000, v174
    v_mul_f32 v99, 0x43800000, v175
    s_waitcnt lgkmcnt(1)
    v_mfma_f32_32x32x16_bf16 v[72:87], v[134:137], v[166:169], v[72:87]
    v_exp_f32 v98, v98
    v_fract_f32 v99, v99
    v_cos_f32 v190, v99
    s_waitcnt lgkmcnt(0)
    v_mfma_f32_32x32x16_bf16 v[72:87], v[138:141], v[170:173], v[72:87]
    v_sin_f32 v191, v99
    v_mul_f32 v190, v190, v98
    v_mul_f32 v191, v191, v98
    .p2align 3
    v_pk_mul_f32 v[184:185], v[182:183], v[182:183] op_sel:[0,0] op_sel_hi:[1,0]
    v_pk_fma_f32 v[184:185], v[182:183], v[182:183], v[184:185] op_sel:[1,1,0] op_sel_hi:[0,1,1] neg_lo:[0,1,0]
    v_cvt_pk_bf16_f32 v200, v188, v189
    v_pk_mul_f32 v[180:181], v[178:179], v[176:177] op_sel:[0,0] op_sel_hi:[1,0]
    v_pk_fma_f32 v[180:181], v[178:179], v[176:177], v[180:181] op_sel:[1,1,0] op_sel_hi:[0,1,1] neg_lo:[0,1,0]
    v_pk_mul_f32 v[186:187], v[184:185], v[184:185] op_sel:[0,0] op_sel_hi:[1,0]
    v_pk_fma_f32 v[186:187], v[184:185], v[184:185], v[186:187] op_sel:[1,1,0] op_sel_hi:[0,1,1] neg_lo:[0,1,0]
    v_cvt_pk_bf16_f32 v201, v180, -v181
    v_pk_mul_f32 v[192:193], v[188:189], v[188:189] op_sel:[0,0] op_sel_hi:[1,0]
    v_pk_fma_f32 v[192:193], v[188:189], v[188:189], v[192:193] op_sel:[1,1,0] op_sel_hi:[0,1,1] neg_lo:[0,1,0]
    v_cvt_pk_bf16_f32 v202, v192, v193
    v_pk_mul_f32 v[194:195], v[192:193], v[188:189] op_sel:[0,0] op_sel_hi:[1,0]
    v_pk_fma_f32 v[194:195], v[192:193], v[188:189], v[194:195] op_sel:[1,1,0] op_sel_hi:[0,1,1] neg_lo:[0,1,0]
    v_cvt_pk_bf16_f32 v203, v194, v195
    buffer_load_dword v57, v31, s[40:43], s79 offen offset:896
    s_add_u32 s79, s79, 802816
    ds_write_addtid_b32 v200 offset:272
    ds_write_addtid_b32 v201 offset:8704
    ds_write_addtid_b32 v202 offset:544
    ds_write_addtid_b32 v203 offset:816
    .p2align 3
    v_pk_mul_f32 v[192:193], v[194:195], v[188:189] op_sel:[0,0] op_sel_hi:[1,0]
    v_pk_fma_f32 v[192:193], v[194:195], v[188:189], v[192:193] op_sel:[1,1,0] op_sel_hi:[0,1,1] neg_lo:[0,1,0]
    v_cvt_pk_bf16_f32 v204, v192, v193
    v_pk_mul_f32 v[194:195], v[192:193], v[188:189] op_sel:[0,0] op_sel_hi:[1,0]
    v_pk_fma_f32 v[194:195], v[192:193], v[188:189], v[194:195] op_sel:[1,1,0] op_sel_hi:[0,1,1] neg_lo:[0,1,0]
    v_cvt_pk_bf16_f32 v205, v194, v195
    v_pk_mul_f32 v[192:193], v[194:195], v[188:189] op_sel:[0,0] op_sel_hi:[1,0]
    v_pk_fma_f32 v[192:193], v[194:195], v[188:189], v[192:193] op_sel:[1,1,0] op_sel_hi:[0,1,1] neg_lo:[0,1,0]
    v_cvt_pk_bf16_f32 v206, v192, v193
    v_pk_mul_f32 v[194:195], v[192:193], v[188:189] op_sel:[0,0] op_sel_hi:[1,0]
    v_pk_fma_f32 v[194:195], v[192:193], v[188:189], v[194:195] op_sel:[1,1,0] op_sel_hi:[0,1,1] neg_lo:[0,1,0]
    v_cvt_pk_bf16_f32 v207, v194, v195
    ds_write_addtid_b32 v204 offset:1088
    ds_write_addtid_b32 v205 offset:1360
    ds_write_addtid_b32 v206 offset:1632
    ds_write_addtid_b32 v207 offset:1904
    .p2align 3
    v_pk_mul_f32 v[192:193], v[194:195], v[188:189] op_sel:[0,0] op_sel_hi:[1,0]
    v_pk_fma_f32 v[192:193], v[194:195], v[188:189], v[192:193] op_sel:[1,1,0] op_sel_hi:[0,1,1] neg_lo:[0,1,0]
    v_cvt_pk_bf16_f32 v200, v192, v193
    v_pk_mul_f32 v[194:195], v[192:193], v[188:189] op_sel:[0,0] op_sel_hi:[1,0]
    v_pk_fma_f32 v[194:195], v[192:193], v[188:189], v[194:195] op_sel:[1,1,0] op_sel_hi:[0,1,1] neg_lo:[0,1,0]
    v_cvt_pk_bf16_f32 v201, v194, v195
    v_pk_mul_f32 v[192:193], v[194:195], v[188:189] op_sel:[0,0] op_sel_hi:[1,0]
    v_pk_fma_f32 v[192:193], v[194:195], v[188:189], v[192:193] op_sel:[1,1,0] op_sel_hi:[0,1,1] neg_lo:[0,1,0]
    v_cvt_pk_bf16_f32 v202, v192, v193
    v_pk_mul_f32 v[194:195], v[192:193], v[188:189] op_sel:[0,0] op_sel_hi:[1,0]
    v_pk_fma_f32 v[194:195], v[192:193], v[188:189], v[194:195] op_sel:[1,1,0] op_sel_hi:[0,1,1] neg_lo:[0,1,0]
    v_cvt_pk_bf16_f32 v203, v194, v195
    ds_write_addtid_b32 v200 offset:2176
    ds_write_addtid_b32 v201 offset:2448
    ds_write_addtid_b32 v202 offset:2720
    ds_write_addtid_b32 v203 offset:2992
    .p2align 3
    v_pk_mul_f32 v[192:193], v[194:195], v[188:189] op_sel:[0,0] op_sel_hi:[1,0]
    v_pk_fma_f32 v[192:193], v[194:195], v[188:189], v[192:193] op_sel:[1,1,0] op_sel_hi:[0,1,1] neg_lo:[0,1,0]
    v_cvt_pk_bf16_f32 v204, v192, v193
    v_pk_mul_f32 v[194:195], v[192:193], v[188:189] op_sel:[0,0] op_sel_hi:[1,0]
    v_pk_fma_f32 v[194:195], v[192:193], v[188:189], v[194:195] op_sel:[1,1,0] op_sel_hi:[0,1,1] neg_lo:[0,1,0]
    v_cvt_pk_bf16_f32 v205, v194, v195
    v_pk_mul_f32 v[192:193], v[194:195], v[188:189] op_sel:[0,0] op_sel_hi:[1,0]
    v_pk_fma_f32 v[192:193], v[194:195], v[188:189], v[192:193] op_sel:[1,1,0] op_sel_hi:[0,1,1] neg_lo:[0,1,0]
    v_cvt_pk_bf16_f32 v206, v192, v193
    v_pk_mul_f32 v[194:195], v[192:193], v[188:189] op_sel:[0,0] op_sel_hi:[1,0]
    v_pk_fma_f32 v[194:195], v[192:193], v[188:189], v[194:195] op_sel:[1,1,0] op_sel_hi:[0,1,1] neg_lo:[0,1,0]
    v_cvt_pk_bf16_f32 v207, v194, v195
    buffer_load_dword v40, v31, s[40:43], s79 offen
    ds_write_addtid_b32 v204 offset:3264
    ds_write_addtid_b32 v205 offset:3536
    ds_write_addtid_b32 v206 offset:3808
    ds_write_addtid_b32 v207 offset:4080
    .p2align 3
    v_pk_mul_f32 v[192:193], v[194:195], v[188:189] op_sel:[0,0] op_sel_hi:[1,0]
    v_pk_fma_f32 v[192:193], v[194:195], v[188:189], v[192:193] op_sel:[1,1,0] op_sel_hi:[0,1,1] neg_lo:[0,1,0]
    v_cvt_pk_bf16_f32 v200, v192, v193
    v_pk_mul_f32 v[194:195], v[192:193], v[188:189] op_sel:[0,0] op_sel_hi:[1,0]
    v_pk_fma_f32 v[194:195], v[192:193], v[188:189], v[194:195] op_sel:[1,1,0] op_sel_hi:[0,1,1] neg_lo:[0,1,0]
    v_cvt_pk_bf16_f32 v201, v194, v195
    v_pk_mul_f32 v[192:193], v[194:195], v[188:189] op_sel:[0,0] op_sel_hi:[1,0]
    v_pk_fma_f32 v[192:193], v[194:195], v[188:189], v[192:193] op_sel:[1,1,0] op_sel_hi:[0,1,1] neg_lo:[0,1,0]
    v_cvt_pk_bf16_f32 v202, v192, v193
    v_pk_mul_f32 v[194:195], v[192:193], v[188:189] op_sel:[0,0] op_sel_hi:[1,0]
    v_pk_fma_f32 v[194:195], v[192:193], v[188:189], v[194:195] op_sel:[1,1,0] op_sel_hi:[0,1,1] neg_lo:[0,1,0]
    v_cvt_pk_bf16_f32 v203, v194, v195
    ds_write_addtid_b32 v200 offset:4352
    ds_write_addtid_b32 v201 offset:4624
    ds_write_addtid_b32 v202 offset:4896
    ds_write_addtid_b32 v203 offset:5168
    .p2align 3
    v_pk_mul_f32 v[192:193], v[194:195], v[188:189] op_sel:[0,0] op_sel_hi:[1,0]
    v_pk_fma_f32 v[192:193], v[194:195], v[188:189], v[192:193] op_sel:[1,1,0] op_sel_hi:[0,1,1] neg_lo:[0,1,0]
    v_cvt_pk_bf16_f32 v204, v192, v193
    v_pk_mul_f32 v[194:195], v[192:193], v[188:189] op_sel:[0,0] op_sel_hi:[1,0]
    v_pk_fma_f32 v[194:195], v[192:193], v[188:189], v[194:195] op_sel:[1,1,0] op_sel_hi:[0,1,1] neg_lo:[0,1,0]
    v_cvt_pk_bf16_f32 v205, v194, v195
    v_pk_mul_f32 v[192:193], v[194:195], v[188:189] op_sel:[0,0] op_sel_hi:[1,0]
    v_pk_fma_f32 v[192:193], v[194:195], v[188:189], v[192:193] op_sel:[1,1,0] op_sel_hi:[0,1,1] neg_lo:[0,1,0]
    v_cvt_pk_bf16_f32 v206, v192, v193
    v_pk_mul_f32 v[194:195], v[192:193], v[188:189] op_sel:[0,0] op_sel_hi:[1,0]
    v_pk_fma_f32 v[194:195], v[192:193], v[188:189], v[194:195] op_sel:[1,1,0] op_sel_hi:[0,1,1] neg_lo:[0,1,0]
    v_cvt_pk_bf16_f32 v207, v194, v195
    ds_write_addtid_b32 v204 offset:5440
    ds_write_addtid_b32 v205 offset:5712
    ds_write_addtid_b32 v206 offset:5984
    ds_write_addtid_b32 v207 offset:6256
    .p2align 3
    v_pk_mul_f32 v[192:193], v[194:195], v[188:189] op_sel:[0,0] op_sel_hi:[1,0]
    v_pk_fma_f32 v[192:193], v[194:195], v[188:189], v[192:193] op_sel:[1,1,0] op_sel_hi:[0,1,1] neg_lo:[0,1,0]
    v_cvt_pk_bf16_f32 v200, v192, v193
    v_pk_mul_f32 v[194:195], v[192:193], v[188:189] op_sel:[0,0] op_sel_hi:[1,0]
    v_pk_fma_f32 v[194:195], v[192:193], v[188:189], v[194:195] op_sel:[1,1,0] op_sel_hi:[0,1,1] neg_lo:[0,1,0]
    v_cvt_pk_bf16_f32 v201, v194, v195
    v_pk_mul_f32 v[192:193], v[194:195], v[188:189] op_sel:[0,0] op_sel_hi:[1,0]
    v_pk_fma_f32 v[192:193], v[194:195], v[188:189], v[192:193] op_sel:[1,1,0] op_sel_hi:[0,1,1] neg_lo:[0,1,0]
    v_cvt_pk_bf16_f32 v202, v192, v193
    v_pk_mul_f32 v[194:195], v[192:193], v[188:189] op_sel:[0,0] op_sel_hi:[1,0]
    v_pk_fma_f32 v[194:195], v[192:193], v[188:189], v[194:195] op_sel:[1,1,0] op_sel_hi:[0,1,1] neg_lo:[0,1,0]
    v_cvt_pk_bf16_f32 v203, v194, v195
    ds_write_addtid_b32 v200 offset:6528
    ds_write_addtid_b32 v201 offset:6800
    ds_write_addtid_b32 v202 offset:7072
    ds_write_addtid_b32 v203 offset:7344
    .p2align 3
    v_pk_mul_f32 v[192:193], v[194:195], v[188:189] op_sel:[0,0] op_sel_hi:[1,0]
    v_pk_fma_f32 v[192:193], v[194:195], v[188:189], v[192:193] op_sel:[1,1,0] op_sel_hi:[0,1,1] neg_lo:[0,1,0]
    v_cvt_pk_bf16_f32 v204, v192, v193
    v_pk_mul_f32 v[194:195], v[192:193], v[188:189] op_sel:[0,0] op_sel_hi:[1,0]
    v_pk_fma_f32 v[194:195], v[192:193], v[188:189], v[194:195] op_sel:[1,1,0] op_sel_hi:[0,1,1] neg_lo:[0,1,0]
    v_cvt_pk_bf16_f32 v205, v194, v195
    v_pk_mul_f32 v[192:193], v[194:195], v[188:189] op_sel:[0,0] op_sel_hi:[1,0]
    v_pk_fma_f32 v[192:193], v[194:195], v[188:189], v[192:193] op_sel:[1,1,0] op_sel_hi:[0,1,1] neg_lo:[0,1,0]
    v_cvt_pk_bf16_f32 v206, v192, v193
    v_pk_mul_f32 v[194:195], v[192:193], v[188:189] op_sel:[0,0] op_sel_hi:[1,0]
    v_pk_fma_f32 v[194:195], v[192:193], v[188:189], v[194:195] op_sel:[1,1,0] op_sel_hi:[0,1,1] neg_lo:[0,1,0]
    v_cvt_pk_bf16_f32 v207, v194, v195
    buffer_load_dword v41, v31, s[40:43], s79 offen offset:896
    s_add_u32 s79, s79, 114688
    ds_write_addtid_b32 v204 offset:7616
    ds_write_addtid_b32 v205 offset:7888
    ds_write_addtid_b32 v206 offset:8160
    ds_write_addtid_b32 v207 offset:8432
    .p2align 3
    v_pk_mul_f32 v[194:195], v[180:181], v[182:183] op_sel:[0,0] op_sel_hi:[1,0]
    v_pk_fma_f32 v[194:195], v[180:181], v[182:183], v[194:195] op_sel:[1,1,0] op_sel_hi:[0,1,1] neg_lo:[0,1,0]
    v_cvt_pk_bf16_f32 v200, v194, -v195
    v_pk_mul_f32 v[192:193], v[194:195], v[182:183] op_sel:[0,0] op_sel_hi:[1,0]
    v_pk_fma_f32 v[192:193], v[194:195], v[182:183], v[192:193] op_sel:[1,1,0] op_sel_hi:[0,1,1] neg_lo:[0,1,0]
    v_cvt_pk_bf16_f32 v201, v192, -v193
    v_pk_mul_f32 v[194:195], v[192:193], v[182:183] op_sel:[0,0] op_sel_hi:[1,0]
    v_pk_fma_f32 v[194:195], v[192:193], v[182:183], v[194:195] op_sel:[1,1,0] op_sel_hi:[0,1,1] neg_lo:[0,1,0]
    v_cvt_pk_bf16_f32 v202, v194, -v195
    v_pk_mul_f32 v[192:193], v[194:195], v[182:183] op_sel:[0,0] op_sel_hi:[1,0]
    v_pk_fma_f32 v[192:193], v[194:195], v[182:183], v[192:193] op_sel:[1,1,0] op_sel_hi:[0,1,1] neg_lo:[0,1,0]
    v_cvt_pk_bf16_f32 v203, v192, -v193
    ds_read_b128 v[142:145], v105 offset:0
    ds_read_b128 v[146:149], v105 offset:32
L_padS0_B:
    s_cbranch_execz L_retS_B
    ds_write_addtid_b32 v200 offset:8976
    ds_write_addtid_b32 v201 offset:9248
    ds_write_addtid_b32 v202 offset:9520
    ds_write_addtid_b32 v203 offset:9792
    .p2align 3
    v_pk_mul_f32 v[194:195], v[192:193], v[182:183] op_sel:[0,0] op_sel_hi:[1,0]
    v_pk_fma_f32 v[194:195], v[192:193], v[182:183], v[194:195] op_sel:[1,1,0] op_sel_hi:[0,1,1] neg_lo:[0,1,0]
    v_cvt_pk_bf16_f32 v204, v194, -v195
    v_pk_mul_f32 v[192:193], v[194:195], v[182:183] op_sel:[0,0] op_sel_hi:[1,0]
    v_pk_fma_f32 v[192:193], v[194:195], v[182:183], v[192:193] op_sel:[1,1,0] op_sel_hi:[0,1,1] neg_lo:[0,1,0]
    v_cvt_pk_bf16_f32 v205, v192, -v193
    v_pk_mul_f32 v[194:195], v[192:193], v[182:183] op_sel:[0,0] op_sel_hi:[1,0]
    v_pk_fma_f32 v[194:195], v[192:193], v[182:183], v[194:195] op_sel:[1,1,0] op_sel_hi:[0,1,1] neg_lo:[0,1,0]
    v_cvt_pk_bf16_f32 v206, v194, -v195
    v_pk_mul_f32 v[198:199], v[180:181], v[190:191] op_sel:[0,0] op_sel_hi:[1,0]
    v_pk_fma_f32 v[198:199], v[180:181], v[190:191], v[198:199] op_sel:[1,1,0] op_sel_hi:[0,1,1] neg_lo:[0,1,0]
    v_cvt_pk_bf16_f32 v207, v198, -v199
    ds_read_b128 v[150:153], v105 offset:64
    ds_write_addtid_b32 v204 offset:10064
    ds_write_addtid_b32 v205 offset:10336
    ds_write_addtid_b32 v206 offset:10608
    ds_write_addtid_b32 v207 offset:10880
    .p2align 3
    v_pk_mul_f32 v[194:195], v[198:199], v[184:185] op_sel:[0,0] op_sel_hi:[1,0]
    v_pk_fma_f32 v[194:195], v[198:199], v[184:185], v[194:195] op_sel:[1,1,0] op_sel_hi:[0,1,1] neg_lo:[0,1,0]
    v_cvt_pk_bf16_f32 v200, v194, -v195
    v_pk_mul_f32 v[192:193], v[194:195], v[184:185] op_sel:[0,0] op_sel_hi:[1,0]
    v_pk_fma_f32 v[192:193], v[194:195], v[184:185], v[192:193] op_sel:[1,1,0] op_sel_hi:[0,1,1] neg_lo:[0,1,0]
    v_cvt_pk_bf16_f32 v201, v192, -v193
    v_pk_mul_f32 v[194:195], v[192:193], v[184:185] op_sel:[0,0] op_sel_hi:[1,0]
    v_pk_fma_f32 v[194:195], v[192:193], v[184:185], v[194:195] op_sel:[1,1,0] op_sel_hi:[0,1,1] neg_lo:[0,1,0]
    v_cvt_pk_bf16_f32 v202, v194, -v195
    v_pk_mul_f32 v[192:193], v[194:195], v[184:185] op_sel:[0,0] op_sel_hi:[1,0]
    v_pk_fma_f32 v[192:193], v[194:195], v[184:185], v[192:193] op_sel:[1,1,0] op_sel_hi:[0,1,1] neg_lo:[0,1,0]
    v_cvt_pk_bf16_f32 v203, v192, -v193
    s_add_u32 m0, s12, 98304
    s_mul_i32 s13, s4, 56
    buffer_load_dwordx4 v12, s[48:51], s13 offen  lds
    s_add_u32 s13, s13, 27648
    buffer_load_dwordx4 v12, s[48:51], s13 offen offset:1024  lds
    s_mov_b32 m0, s38
    ds_read_b128 v[154:157], v105 offset:96
    ds_write_addtid_b32 v200 offset:11152
    ds_write_addtid_b32 v201 offset:11968
    ds_write_addtid_b32 v201 offset:11424
    ds_write_addtid_b32 v202 offset:12240
    ds_write_addtid_b32 v203 offset:12512
    .p2align 3
    v_pk_mul_f32 v[196:197], v[198:199], v[190:191] op_sel:[0,0] op_sel_hi:[1,0]
    v_pk_fma_f32 v[196:197], v[198:199], v[190:191], v[196:197] op_sel:[1,1,0] op_sel_hi:[0,1,1] neg_lo:[0,1,0]
    v_cvt_pk_bf16_f32 v204, v196, -v197
    v_pk_mul_f32 v[194:195], v[196:197], v[186:187] op_sel:[0,0] op_sel_hi:[1,0]
    v_pk_fma_f32 v[194:195], v[196:197], v[186:187], v[194:195] op_sel:[1,1,0] op_sel_hi:[0,1,1] neg_lo:[0,1,0]
    v_cvt_pk_bf16_f32 v205, v194, -v195
    v_pk_mul_f32 v[192:193], v[194:195], v[186:187] op_sel:[0,0] op_sel_hi:[1,0]
    v_pk_fma_f32 v[192:193], v[194:195], v[186:187], v[192:193] op_sel:[1,1,0] op_sel_hi:[0,1,1] neg_lo:[0,1,0]
    v_cvt_pk_bf16_f32 v206, v192, -v193
    v_pk_mul_f32 v[198:199], v[196:197], v[190:191] op_sel:[0,0] op_sel_hi:[1,0]
    v_pk_fma_f32 v[198:199], v[196:197], v[190:191], v[198:199] op_sel:[1,1,0] op_sel_hi:[0,1,1] neg_lo:[0,1,0]
    v_cvt_pk_bf16_f32 v207, v198, -v199
    ds_read_b128 v[158:161], v105 offset:128
    ds_read_b128 v[162:165], v105 offset:160
    ds_write_addtid_b32 v204 offset:11696
    ds_write_addtid_b32 v205 offset:13056
    ds_write_addtid_b32 v206 offset:13328
    ds_write_addtid_b32 v207 offset:12784
    .p2align 3
    v_pk_mul_f32 v[194:195], v[198:199], v[186:187] op_sel:[0,0] op_sel_hi:[1,0]
    v_pk_fma_f32 v[194:195], v[198:199], v[186:187], v[194:195] op_sel:[1,1,0] op_sel_hi:[0,1,1] neg_lo:[0,1,0]
    v_cvt_pk_bf16_f32 v200, v194, -v195
    v_pk_mul_f32 v[192:193], v[194:195], v[186:187] op_sel:[0,0] op_sel_hi:[1,0]
    v_pk_fma_f32 v[192:193], v[194:195], v[186:187], v[192:193] op_sel:[1,1,0] op_sel_hi:[0,1,1] neg_lo:[0,1,0]
    v_cvt_pk_bf16_f32 v201, v192, -v193
    v_pk_mul_f32 v[196:197], v[198:199], v[190:191] op_sel:[0,0] op_sel_hi:[1,0]
    v_pk_fma_f32 v[196:197], v[198:199], v[190:191], v[196:197] op_sel:[1,1,0] op_sel_hi:[0,1,1] neg_lo:[0,1,0]
    v_cvt_pk_bf16_f32 v202, v196, -v197
    v_pk_mul_f32 v[194:195], v[196:197], v[188:189] op_sel:[0,0] op_sel_hi:[1,0]
    v_pk_fma_f32 v[194:195], v[196:197], v[188:189], v[194:195] op_sel:[1,1,0] op_sel_hi:[0,1,1] neg_lo:[0,1,0]
    v_cvt_pk_bf16_f32 v203, v194, -v195
    ds_read_b128 v[166:169], v105 offset:192
    ds_write_addtid_b32 v200 offset:14144
    ds_write_addtid_b32 v201 offset:14416
    ds_write_addtid_b32 v202 offset:13600
    ds_write_addtid_b32 v203 offset:13872
    .p2align 3
    v_pk_mul_f32 v[198:199], v[196:197], v[190:191] op_sel:[0,0] op_sel_hi:[1,0]
    v_pk_fma_f32 v[198:199], v[196:197], v[190:191], v[198:199] op_sel:[1,1,0] op_sel_hi:[0,1,1] neg_lo:[0,1,0]
    v_cvt_pk_bf16_f32 v204, v198, -v199
    v_pk_mul_f32 v[194:195], v[198:199], v[188:189] op_sel:[0,0] op_sel_hi:[1,0]
    v_pk_fma_f32 v[194:195], v[198:199], v[188:189], v[194:195] op_sel:[1,1,0] op_sel_hi:[0,1,1] neg_lo:[0,1,0]
    v_cvt_pk_bf16_f32 v205, v194, -v195
    v_pk_mul_f32 v[196:197], v[198:199], v[190:191] op_sel:[0,0] op_sel_hi:[1,0]
    v_pk_fma_f32 v[196:197], v[198:199], v[190:191], v[196:197] op_sel:[1,1,0] op_sel_hi:[0,1,1] neg_lo:[0,1,0]
    v_cvt_pk_bf16_f32 v206, v196, -v197
    v_pk_mul_f32 v[194:195], v[196:197], v[188:189] op_sel:[0,0] op_sel_hi:[1,0]
    v_pk_fma_f32 v[194:195], v[196:197], v[188:189], v[194:195] op_sel:[1,1,0] op_sel_hi:[0,1,1] neg_lo:[0,1,0]
    v_cvt_pk_bf16_f32 v207, v194, -v195
    ds_read_b128 v[170:173], v105 offset:224
    ds_write_addtid_b32 v204 offset:15232
    ds_write_addtid_b32 v205 offset:15504
    ds_write_addtid_b32 v206 offset:14688
    ds_write_addtid_b32 v207 offset:14960
    .p2align 3
    v_pk_mul_f32 v[198:199], v[196:197], v[190:191] op_sel:[0,0] op_sel_hi:[1,0]
    v_pk_fma_f32 v[198:199], v[196:197], v[190:191], v[198:199] op_sel:[1,1,0] op_sel_hi:[0,1,1] neg_lo:[0,1,0]
    v_cvt_pk_bf16_f32 v200, v198, -v199
    v_pk_mul_f32 v[194:195], v[198:199], v[188:189] op_sel:[0,0] op_sel_hi:[1,0]
    v_pk_fma_f32 v[194:195], v[198:199], v[188:189], v[194:195] op_sel:[1,1,0] op_sel_hi:[0,1,1] neg_lo:[0,1,0]
    v_cvt_pk_bf16_f32 v201, v194, -v195
    ds_write_addtid_b32 v200 offset:15776
    ds_write_addtid_b32 v201 offset:16048
    ds_read_b128 v[110:113], v104 offset:0
    ds_read_b128 v[114:117], v104 offset:32
    ds_read_b128 v[118:121], v104 offset:64
    ds_read_b128 v[122:125], v104 offset:96
    ds_read_b128 v[126:129], v104 offset:128
    ds_read_b128 v[130:133], v104 offset:160
    ds_read_b128 v[134:137], v104 offset:192
    ds_read_b128 v[138:141], v104 offset:224
    v_mov_b32 v200, 0
    v_mov_b32 v201, 0
    s_mul_i32 s74, s64, 3136
    s_add_u32 s74, s74, s68
    s_lshl_b32 s74, s74, 7
    v_and_b32 v98, 6, v96
    v_xor_b32 v98, v98, v97
    v_lshlrev_b32 v98, 4, v98
    v_mul_u32_u24 v6, 896, v96
    v_add3_u32 v6, v6, v98, s74
    s_lshr_b32 s76, s64, 1
    s_lshl_b32 s75, s23, 8
    s_mul_i32 s74, s76, 16640
    s_add_u32 s74, s74, s75
    s_add_u32 s74, s74, 65024
    s_add_u32 s75, s75, s39
    s_add_u32 s75, s75, 5024
    v_lshrrev_b32 v98, 4, v1
    v_bfe_u32 v99, v1, 2, 2
    v_add_u32 v99, v99, v98
    s_waitcnt lgkmcnt(7)
    v_mfma_f32_32x32x16_bf16 v[72:87], v[110:113], v[142:145], v[72:87]
    v_and_b32 v100, 3, v1
    v_mul_u32_u24 v174, 4160, v100
    v_lshl_add_u32 v21, v99, 4, v174
    v_add_u32 v21, s74, v21
    v_lshl_add_u32 v22, v98, 4, s75
    s_waitcnt lgkmcnt(6)
    v_mfma_f32_32x32x16_bf16 v[72:87], v[114:117], v[146:149], v[72:87]
    s_add_u32 m0, s12, 100352
    s_add_u32 s13, s13, 29696
    v_lshlrev_b32 v99, 6, v97
    v_sub_u32 v22, v22, v99
    v_and_b32 v99, 1, v96
    s_waitcnt lgkmcnt(5)
    v_mfma_f32_32x32x16_bf16 v[72:87], v[118:121], v[150:153], v[72:87]
    buffer_load_dwordx4 v12, s[48:51], s13 offen  lds
    s_add_u32 s13, s13, 27648
    v_mul_u32_u24 v99, 4576, v99
    v_sub_u32 v22, v22, v99
    s_waitcnt lgkmcnt(4)
    v_mfma_f32_32x32x16_bf16 v[72:87], v[122:125], v[154:157], v[72:87]
    buffer_load_dwordx4 v12, s[48:51], s13 offen offset:1024  lds
    s_add_u32 m0, s12, 102400
    s_add_u32 s13, s13, 29696
    v_lshrrev_b32 v98, 4, v0
    s_waitcnt lgkmcnt(3)
    v_mfma_f32_32x32x16_bf16 v[72:87], v[126:129], v[158:161], v[72:87]
    buffer_load_dwordx4 v12, s[48:51], s13 offen  lds
    s_add_u32 s13, s13, 27648
    v_and_b32 v99, 1, v96
    v_lshl_add_u32 v98, v98, 2, v99
    s_waitcnt lgkmcnt(2)
    v_mfma_f32_32x32x16_bf16 v[72:87], v[130:133], v[162:165], v[72:87]
    buffer_load_dwordx4 v12, s[48:51], s13 offen offset:1024  lds
    s_add_u32 m0, s12, 104448
    s_add_u32 s13, s13, 29696
    v_mul_u32_u24 v98, 28672, v98
    s_waitcnt lgkmcnt(1)
    v_mfma_f32_32x32x16_bf16 v[72:87], v[134:137], v[166:169], v[72:87]
    buffer_load_dwordx4 v12, s[48:51], s13 offen  lds
    s_add_u32 s13, s13, 27648
    v_lshl_add_u32 v26, v97, 4, v98
    v_lshrrev_b32 v99, 1, v97
    s_waitcnt lgkmcnt(0)
    v_mfma_f32_32x32x16_bf16 v[72:87], v[138:141], v[170:173], v[72:87]
    buffer_load_dwordx4 v12, s[48:51], s13 offen offset:1024  lds
    v_lshl_add_u32 v98, v99, 4, v98
    v_and_b32 v99, 1, v97
    v_lshl_add_u32 v25, v99, 6, v98
    v_xor_b32 v99, v97, v96
    v_lshl_add_u32 v99, v97, 3, v99
    s_lshl_b32 s74, s64, 12
    v_lshl_add_u32 v23, v99, 4, s74
    v_mul_u32_u24 v53, 4160, v96
    v_lshl_add_u32 v53, v97, 3, v53
    v_add_u32 v53, 65024, v53
    v_lshrrev_b32 v29, 1, v52
    v_add_u32 v29, 52096, v29
    s_lshl_b32 s60, s64, 9
    s_add_u32 s60, s60, 65024
    s_add_u32 s75, s60, 512
    s_add_u32 s74, s60, 2
    v_mov_b32 v30, s75
    s_nop 0
    v_writelane_b32 v30, s74, 0
    v_lshlrev_b32 v27, 4, v0
    v_xor_b32 v98, v0, v96
    v_lshlrev_b32 v24, 4, v98
    s_lshl_b32 s36, s69, 8
    s_add_u32 s36, s36, 196608
    v_mov_b32 v4, s65
    s_mul_i32 s14, s64, 224
    s_add_u32 s14, s14, s66
    s_lshl_b32 s14, s14, 7
    s_add_u32 s14, s14, 786432
    s_mov_b32 s52, s28
    s_mov_b32 s53, s29
    s_mov_b32 s54, 1605632
    s_mov_b32 s55, 0x00020000
    s_cmp_lg_u32 s23, 0
    s_cbranch_scc1 L_expB_B
    ds_write_b128 v106, v[82:85]
    s_mov_b64 exec, 1
    v_add_f32 v72, s73, v72
    s_mov_b64 exec, -1
    s_mov_b32 s56, s34
    s_mov_b32 s57, s35
    s_mov_b32 s58, 1835008
    s_mov_b32 s59, 0x00020000
    v_lshrrev_b32 v99, 5, v1
    v_bfe_u32 v98, v1, 4, 1
    v_and_b32 v100, 3, v1
    v_lshlrev_b32 v100, 3, v100
    v_lshl_add_u32 v100, v98, 5, v100
    v_bfe_u32 v98, v1, 2, 2
    v_lshl_add_u32 v174, v99, 3, v98
    v_lshl_add_u32 v16, v174, 6, v100
    v_and_b32 v98, 8, v1
    v_lshl_add_u32 v100, v98, 3, v100
    v_bfe_u32 v175, v1, 2, 3
    v_lshl_add_u32 v99, v99, 4, v175
    s_waitcnt lgkmcnt(0)
    s_barrier
    ds_read_b128 v[176:179], v107 offset:13248
    ds_read_b128 v[180:183], v107 offset:14272
    ds_read_b128 v[184:187], v107 offset:15296
    v_lshrrev_b32 v175, 1, v175
    v_lshlrev_b32 v175, 5, v175
    v_lshl_add_u32 v175, v99, 7, v175
    v_and_b32 v99, 3, v1
    v_lshl_add_u32 v175, v99, 3, v175
    v_add_u32 v7, s12, v175
    v_xor_b32 v8, 65536, v7
    v_xor_b32 v9, 65568, v7
    v_xor_b32 v10, 65600, v7
    v_xor_b32 v11, 65632, v7
    s_lshr_b32 s74, s64, 1
    s_lshl_b32 s74, s74, 7
    s_add_u32 s74, s74, s23
    s_lshl_b32 s74, s74, 6
    v_lshl_add_u32 v13, v174, 7, v100
    v_xor_b32 v13, s74, v13
    v_add_u32 v17, 65536, v16
    v_add_u32 v14, 65536, v13
    v_add_u32 v18, 65536, v17
    v_add_u32 v15, 65536, v14
    s_waitcnt lgkmcnt(0)
    v_pk_add_f32 v[72:73], v[72:73], v[176:177]
    v_pk_add_f32 v[74:75], v[74:75], v[178:179]
    v_pk_add_f32 v[76:77], v[76:77], v[180:181]
    v_pk_add_f32 v[78:79], v[78:79], v[182:183]
    v_pk_add_f32 v[80:81], v[80:81], v[184:185]
    v_cvt_pk_bf16_f32 v192, v75, v74
    v_cvt_pk_bf16_f32 v193, v73, v72
    v_cvt_pk_bf16_f32 v194, v78, v77
    v_cvt_pk_bf16_f32 v195, v76, v76
    v_cvt_pk_bf16_f32 v196, v81, v81
    v_cvt_pk_bf16_f32 v197, v80, v80
    v_cvt_pk_bf16_f32 v198, v80, v79
    v_cvt_pk_bf16_f32 v199, v79, v79
    ds_write_b64 v108, v[192:193] offset:4088
    ds_write_b64 v108, v[194:195] offset:3576
    ds_write_b64 v109, v[196:197] offset:3056
    ds_write_b64 v109, v[198:199] offset:3064
    ds_write_b64 v108, v[192:193] offset:8656
    ds_write_b64 v108, v[194:195] offset:8144
    ds_write_b64 v109, v[196:197] offset:7624
    ds_write_b64 v109, v[198:199] offset:7632
    s_branch L_expD_B
L_expB_B:
    ds_write_b128 v106, v[72:75] offset:13248
    ds_write_b128 v106, v[76:79] offset:14272
    ds_write_b128 v106, v[80:83] offset:15296
    s_mov_b32 vcc_lo, 0xaaaaaaaa
    s_mov_b32 vcc_hi, 0xaaaaaaaa
    s_mov_b32 s56, s34
    s_mov_b32 s57, s35
    s_mov_b32 s58, 1835008
    s_mov_b32 s59, 0x00020000
    v_lshrrev_b32 v99, 5, v1
    v_bfe_u32 v98, v1, 4, 1
    v_and_b32 v100, 3, v1
    v_lshlrev_b32 v100, 3, v100
    v_lshl_add_u32 v100, v98, 5, v100
    v_bfe_u32 v98, v1, 2, 2
    v_lshl_add_u32 v174, v99, 3, v98
    v_lshl_add_u32 v16, v174, 6, v100
    v_and_b32 v98, 8, v1
    v_lshl_add_u32 v100, v98, 3, v100
    v_bfe_u32 v175, v1, 2, 3
    v_lshl_add_u32 v99, v99, 4, v175
    s_waitcnt lgkmcnt(0)
    s_barrier
    ds_read_b128 v[176:179], v107
    v_lshrrev_b32 v175, 1, v175
    v_lshlrev_b32 v175, 5, v175
    v_lshl_add_u32 v175, v99, 7, v175
    v_and_b32 v99, 3, v1
    v_lshl_add_u32 v175, v99, 3, v175
    v_add_u32 v7, s12, v175
    v_xor_b32 v8, 65536, v7
    v_xor_b32 v9, 65568, v7
    v_xor_b32 v10, 65600, v7
    v_xor_b32 v11, 65632, v7
    s_lshr_b32 s74, s64, 1
    s_lshl_b32 s74, s74, 7
    s_add_u32 s74, s74, s23
    s_lshl_b32 s74, s74, 6
    v_lshl_add_u32 v13, v174, 7, v100
    v_xor_b32 v13, s74, v13
    v_add_u32 v17, 65536, v16
    v_add_u32 v14, 65536, v13
    v_add_u32 v18, 65536, v17
    v_add_u32 v15, 65536, v14
    s_waitcnt lgkmcnt(0)
    v_pk_add_f32 v[82:83], v[82:83], v[176:177]
    v_pk_add_f32 v[84:85], v[84:85], v[178:179]
    v_cndmask_b32 v202, v82, v83, vcc
    v_cvt_pk_bf16_f32 v192, v83, v83
    v_cvt_pk_bf16_f32 v193, v83, v202
    v_cvt_pk_bf16_f32 v194, v82, v82
    v_cvt_pk_bf16_f32 v195, v82, v82
    v_cndmask_b32 v202, v84, v85, vcc
    v_cvt_pk_bf16_f32 v196, v85, v85
    v_cvt_pk_bf16_f32 v197, v85, v202
    v_cvt_pk_bf16_f32 v198, v84, v84
    v_cvt_pk_bf16_f32 v199, v84, v84
    ds_write_b64 v109, v[192:193] offset:2032
    ds_write_b64 v109, v[194:195] offset:2040
    ds_write_b64 v109, v[196:197] offset:1520
    ds_write_b64 v109, v[198:199] offset:1528
    ds_write_b64 v109, v[192:193] offset:6600
    ds_write_b64 v109, v[194:195] offset:6608
    ds_write_b64 v109, v[196:197] offset:6088
    ds_write_b64 v109, v[198:199] offset:6096
L_expD_B:
    s_mul_i32 s74, s23, 4568
    s_add_u32 m0, s74, s39
    s_nop 0
    ds_write_addtid_b32 v200 offset:4096
    ds_write_addtid_b32 v200 offset:4304
    buffer_load_dwordx4 v[32:35], v20, s[44:47], 0 offen sc1
    s_mov_b32 s37, 4096
    buffer_load_dwordx4 v[58:61], v52, s[44:47], s37 offen offset:0 sc1
    buffer_load_dwordx4 v[62:65], v52, s[44:47], s37 offen offset:1024 sc1
    s_mov_b32 s37, 12288
    buffer_load_dwordx4 v[44:47], v52, s[44:47], s37 offen offset:0 sc1
    buffer_load_dwordx4 v[48:51], v52, s[44:47], s37 offen offset:1024 sc1
    s_waitcnt vmcnt(5)
    s_cmp_eq_u32 s64, 0
    s_barrier
    s_cbranch_scc0 L_nozero_B
    ds_write_b64 v53, v[200:201]
L_nozero_B:
    s_add_u32 m0, s12, 131072
    s_mul_i32 s13, s5, 56
    buffer_load_dwordx4 v12, s[48:51], s13 offen  lds
    s_add_u32 s13, s13, 27648
    buffer_load_dwordx4 v12, s[48:51], s13 offen offset:1024  lds
    s_waitcnt vmcnt(6)
    v_cmpx_eq_u32 vcc, s65, v35
    s_nop 0
    s_cmp_eq_u64 exec, -1
    s_mov_b64 exec, -1
    s_cbranch_scc0 L_m1_re_B
L_m1_ok_B:
    s_nop 0
    v_add_f32_dpp v32, v32, v32 quad_perm:[1,0,3,2] row_mask:0xf bank_mask:0xf
    v_add_f32_dpp v33, v33, v33 quad_perm:[1,0,3,2] row_mask:0xf bank_mask:0xf
    v_cvt_pk_bf16_f32 v34, v32, v33
    v_lshlrev_b32 v32, 16, v34
    v_and_b32 v33, 0xffff0000, v34
    v_add_f32 v32, v32, v28
    v_add_f32 v33, v33, v28
    v_cvt_pk_bf16_f32 v34, v32, v33
    v_lshlrev_b32 v32, 16, v34
    v_and_b32 v33, 0xffff0000, v34
    v_and_b32 v66, 2, v1
    v_mul_u32_u24 v66, 3584, v66
    v_mov_b32_dpp v36, v32 quad_perm:[0,0,0,0] row_mask:0xf bank_mask:0xf
    v_mov_b32_dpp v38, v32 quad_perm:[2,2,2,2] row_mask:0xf bank_mask:0xf
    v_mov_b32_dpp v37, v33 quad_perm:[0,0,0,0] row_mask:0xf bank_mask:0xf
    v_mov_b32_dpp v39, v33 quad_perm:[2,2,2,2] row_mask:0xf bank_mask:0xf
    v_add_u32 v20, v20, v66
    v_add_u32 v20, 14336, v20
    s_waitcnt vmcnt(2)
    v_cmpx_eq_u32 vcc, s65, v61
    v_cmpx_eq_u32 vcc, s65, v65
    v_cmpx_eq_u32 vcc, s65, v47
    v_cmpx_eq_u32 vcc, s65, v51
    s_nop 0
    s_cmp_eq_u64 exec, -1
    s_mov_b64 exec, -1
    s_cbranch_scc0 L_h1_re_B
L_h1_ok_B:
    ds_write_b64 v29, v[54:55] offset:0
    ds_write_b64 v29, v[56:57] offset:512
    s_mov_b32 m0, s60
    v_lshlrev_b32 v74, 16, v54
    v_and_b32 v75, 0xffff0000, v54
    v_lshlrev_b32 v76, 16, v55
    v_and_b32 v77, 0xffff0000, v55
    v_lshlrev_b32 v78, 16, v58
    v_and_b32 v79, 0xffff0000, v58
    v_pk_fma_f32 v[74:75], v[74:75], v[58:59], v[78:79] op_sel:[0,1,0] op_sel_hi:[1,1,0]
    v_pk_fma_f32 v[76:77], v[76:77], v[60:61], v[78:79] op_sel:[0,0,1] op_sel_hi:[1,0,1]
    v_pk_fma_f32 v[74:75], v[74:75], v[38:39], v[36:37]
    v_pk_fma_f32 v[76:77], v[76:77], v[38:39], v[36:37]
    v_cvt_pk_bf16_f32 v66, v74, v76
    v_cvt_pk_bf16_f32 v67, v75, v77
    ds_write_addtid_b32 v66 offset:4212
    ds_write_addtid_b32 v66 offset:12528
    ds_write_addtid_b32 v67 offset:20852
    ds_write_addtid_b32 v67 offset:29168
    v_mov_b32_dpp v80, v66 wave_shr:1 row_mask:0xf bank_mask:0xf
    v_mov_b32_dpp v81, v67 wave_shr:1 row_mask:0xf bank_mask:0xf
    v_alignbit_b32 v70, v66, v80, 16
    v_alignbit_b32 v71, v67, v81, 16
    v_lshlrev_b32 v74, 16, v56
    v_and_b32 v75, 0xffff0000, v56
    v_lshlrev_b32 v76, 16, v57
    v_and_b32 v77, 0xffff0000, v57
    v_lshlrev_b32 v78, 16, v62
    v_and_b32 v79, 0xffff0000, v62
    v_pk_fma_f32 v[74:75], v[74:75], v[62:63], v[78:79] op_sel:[0,1,0] op_sel_hi:[1,1,0]
    v_pk_fma_f32 v[76:77], v[76:77], v[64:65], v[78:79] op_sel:[0,0,1] op_sel_hi:[1,0,1]
    v_pk_fma_f32 v[74:75], v[74:75], v[38:39], v[36:37]
    v_pk_fma_f32 v[76:77], v[76:77], v[38:39], v[36:37]
    v_mov_b32_dpp v80, v66 wave_ror:1 row_mask:0xf bank_mask:0xf
    v_mov_b32_dpp v81, v67 wave_ror:1 row_mask:0xf bank_mask:0xf
    v_cvt_pk_bf16_f32 v68, v74, v76
    v_cvt_pk_bf16_f32 v69, v75, v77
    s_mov_b64 exec, -2
    ds_write_addtid_b32 v70 offset:52
    ds_write_addtid_b32 v70 offset:8368
    ds_write_addtid_b32 v71 offset:16692
    ds_write_addtid_b32 v71 offset:25008
    s_mov_b64 exec, -1
    ds_write_addtid_b32 v68 offset:4468
    ds_write_addtid_b32 v68 offset:12784
    ds_write_addtid_b32 v69 offset:21108
    ds_write_addtid_b32 v69 offset:29424
    v_mov_b32_dpp v80, v68 wave_shr:1 row_mask:0xf bank_mask:0xf
    v_mov_b32_dpp v81, v69 wave_shr:1 row_mask:0xf bank_mask:0xf
    v_alignbit_b32 v72, v68, v80, 16
    v_alignbit_b32 v73, v69, v81, 16
    v_lshrrev_b32 v80, 16, v68
    v_lshrrev_b32 v81, 16, v69
    s_mov_b64 exec, 1
    v_mov_b32 v80, v66
    v_mov_b32 v81, v67
    s_mov_b64 exec, -1
    ds_write_addtid_b32 v72 offset:308
    ds_write_addtid_b32 v72 offset:8624
    ds_write_addtid_b32 v73 offset:16948
    ds_write_addtid_b32 v73 offset:25264
    s_mov_b32 exec_lo, 1
    s_mov_b32 exec_hi, 0x80000000
    ds_write_b16 v30, v80 offset:52
    ds_write_b16 v30, v80 offset:8368
    ds_write_b16 v30, v81 offset:16692
    ds_write_b16 v30, v81 offset:25008
    s_mov_b64 exec, -1
    buffer_load_dwordx4 v[32:35], v20, s[44:47], 0 offen sc1
    s_add_u32 m0, s12, 133120
    s_add_u32 s13, s13, 29696
    buffer_load_dwordx4 v12, s[48:51], s13 offen  lds
    s_add_u32 s13, s13, 27648
    buffer_load_dwordx4 v12, s[48:51], s13 offen offset:1024  lds
    s_add_u32 m0, s12, 135168
    s_add_u32 s13, s13, 29696
    buffer_load_dwordx4 v12, s[48:51], s13 offen  lds
    s_add_u32 s13, s13, 27648
    buffer_load_dwordx4 v12, s[48:51], s13 offen offset:1024  lds
    s_waitcnt lgkmcnt(0)
    s_barrier
    ds_read_b128 v[144:147], v21 offset:128
    ds_read_b128 v[208:211], v22 offset:3712
    ds_read_b128 v[212:215], v22 offset:3200
    ds_read_b128 v[216:219], v22 offset:2688
    ds_read_b128 v[220:223], v22 offset:2176
    ds_read_b128 v[148:151], v21 offset:640
    ds_read_b128 v[152:155], v21 offset:1152
    ds_read_b128 v[156:159], v21 offset:1664
    ds_read_b128 v[176:179], v21 offset:192
    ds_read_b128 v[240:243], v22 offset:3776
    ds_read_b128 v[244:247], v22 offset:3264
    ds_read_b128 v[248:251], v22 offset:2752
    ds_read_b128 v[252:255], v22 offset:2240
    ds_read_b128 v[180:183], v21 offset:704
    ds_read_b128 v[184:187], v21 offset:1216
    ds_read_b128 v[188:191], v21 offset:1728
    s_waitcnt lgkmcnt(14)
    v_mfma_f32_16x16x32_bf16 v[96:99], v[144:147], v[208:211], 0
    ds_read_b128 v[128:131], v21 offset:0
    s_waitcnt lgkmcnt(14)
    v_mfma_f32_16x16x32_bf16 v[100:103], v[144:147], v[212:215], 0
    ds_read_b128 v[192:195], v22 offset:3584
    s_waitcnt lgkmcnt(14)
    v_mfma_f32_16x16x32_bf16 v[104:107], v[144:147], v[216:219], 0
    ds_read_b128 v[196:199], v22 offset:3072
    s_waitcnt lgkmcnt(14)
    v_mfma_f32_16x16x32_bf16 v[108:111], v[144:147], v[220:223], 0
    ds_read_b128 v[200:203], v22 offset:2560
    s_waitcnt lgkmcnt(12)
    v_mfma_f32_16x16x32_bf16 v[100:103], v[148:151], v[208:211], v[100:103]
    ds_read_b128 v[204:207], v22 offset:2048
    s_add_u32 m0, s12, 137216
    v_mfma_f32_16x16x32_bf16 v[104:107], v[148:151], v[212:215], v[104:107]
    ds_read_b128 v[132:135], v21 offset:512
    v_mfma_f32_16x16x32_bf16 v[108:111], v[148:151], v[216:219], v[108:111]
    ds_read_b128 v[136:139], v21 offset:1024
    v_mfma_f32_16x16x32_bf16 v[104:107], v[152:155], v[208:211], v[104:107]
    ds_read_b128 v[140:143], v21 offset:1536
    v_mfma_f32_16x16x32_bf16 v[108:111], v[152:155], v[212:215], v[108:111]
    v_mfma_f32_16x16x32_bf16 v[108:111], v[156:159], v[208:211], v[108:111]
    s_add_u32 s13, s13, 29696
    s_waitcnt lgkmcnt(8)
    v_mfma_f32_16x16x32_bf16 v[96:99], v[176:179], v[240:243], v[96:99]
    ds_read_b128 v[160:163], v21 offset:64
    v_mfma_f32_16x16x32_bf16 v[100:103], v[176:179], v[244:247], v[100:103]
    ds_read_b128 v[224:227], v22 offset:3648
    v_mfma_f32_16x16x32_bf16 v[104:107], v[176:179], v[248:251], v[104:107]
    ds_read_b128 v[228:231], v22 offset:3136
    v_mfma_f32_16x16x32_bf16 v[108:111], v[176:179], v[252:255], v[108:111]
    ds_read_b128 v[232:235], v22 offset:2624
    v_mfma_f32_16x16x32_bf16 v[100:103], v[180:183], v[240:243], v[100:103]
    ds_read_b128 v[236:239], v22 offset:2112
    v_mfma_f32_16x16x32_bf16 v[104:107], v[180:183], v[244:247], v[104:107]
    ds_read_b128 v[164:167], v21 offset:576
    v_mfma_f32_16x16x32_bf16 v[108:111], v[180:183], v[248:251], v[108:111]
    ds_read_b128 v[168:171], v21 offset:1088
    v_mfma_f32_16x16x32_bf16 v[104:107], v[184:187], v[240:243], v[104:107]
    ds_read_b128 v[172:175], v21 offset:1600
    v_mfma_f32_16x16x32_bf16 v[108:111], v[184:187], v[244:247], v[108:111]
    buffer_load_dwordx4 v12, s[48:51], s13 offen  lds
    v_mfma_f32_16x16x32_bf16 v[108:111], v[188:191], v[240:243], v[108:111]
    s_waitcnt lgkmcnt(8)
    v_mfma_f32_16x16x32_bf16 v[96:99], v[128:131], v[192:195], v[96:99]
    ds_read_b128 v[208:211], v22 offset:1536
    v_mfma_f32_16x16x32_bf16 v[100:103], v[128:131], v[196:199], v[100:103]
    ds_read_b128 v[212:215], v22 offset:1024
    v_mfma_f32_16x16x32_bf16 v[104:107], v[128:131], v[200:203], v[104:107]
    v_mfma_f32_16x16x32_bf16 v[108:111], v[128:131], v[204:207], v[108:111]
    ds_read_b128 v[216:219], v22 offset:512
    s_add_u32 s13, s13, 27648
    v_mfma_f32_16x16x32_bf16 v[100:103], v[132:135], v[192:195], v[100:103]
    v_mfma_f32_16x16x32_bf16 v[104:107], v[132:135], v[196:199], v[104:107]
    ds_read_b128 v[220:223], v22 offset:0
    v_mfma_f32_16x16x32_bf16 v[108:111], v[132:135], v[200:203], v[108:111]
    s_waitcnt vmcnt(5)
    v_cmp_ne_u32 vcc, s65, v35
    v_mfma_f32_16x16x32_bf16 v[104:107], v[136:139], v[192:195], v[104:107]
    s_cbranch_vccnz L_m2_re_B
L_m2_ok_B:
    v_mfma_f32_16x16x32_bf16 v[108:111], v[136:139], v[196:199], v[108:111]
    ds_read_b128 v[52:55], v27 offset:52096
    v_add_f32_dpp v32, v32, v32 quad_perm:[1,0,3,2] row_mask:0xf bank_mask:0xf
    v_mfma_f32_16x16x32_bf16 v[108:111], v[140:143], v[192:195], v[108:111]
    v_add_f32_dpp v33, v33, v33 quad_perm:[1,0,3,2] row_mask:0xf bank_mask:0xf
    s_waitcnt lgkmcnt(5)
    v_mfma_f32_16x16x32_bf16 v[108:111], v[160:163], v[236:239], v[108:111]
    ds_read_b128 v[240:243], v22 offset:1600
    ds_read_b64_tr_b16 a[0:1], v14 offset:32768
    v_mfma_f32_16x16x32_bf16 v[108:111], v[164:167], v[232:235], v[108:111]
    buffer_load_dwordx4 v12, s[48:51], s13 offen offset:1024  lds
    v_mfma_f32_16x16x32_bf16 v[108:111], v[168:171], v[228:231], v[108:111]
    ds_read_b128 v[244:247], v22 offset:1088
    ds_read_b64_tr_b16 a[2:3], v14 offset:33280
    v_mfma_f32_16x16x32_bf16 v[108:111], v[172:175], v[224:227], v[108:111]
    ds_read_b64_tr_b16 a[112:113], v14 offset:49152
    ds_read_b64_tr_b16 a[114:115], v14 offset:49664
    v_mfma_f32_16x16x32_bf16 v[104:107], v[160:163], v[232:235], v[104:107]
    ds_read_b128 v[248:251], v22 offset:576
    ds_read_b64_tr_b16 a[4:5], v14 offset:34816
    v_mfma_f32_16x16x32_bf16 v[104:107], v[164:167], v[228:231], v[104:107]
    ds_read_b64_tr_b16 a[6:7], v14 offset:35328
    v_cvt_pk_bf16_f32 v34, v32, v33
    v_mfma_f32_16x16x32_bf16 v[104:107], v[168:171], v[224:227], v[104:107]
L_padS1_B:
    s_cbranch_execz L_retS_B
    ds_read_b128 v[252:255], v22 offset:64
    ds_read_b64_tr_b16 a[116:117], v14 offset:51200
    v_mfma_f32_16x16x32_bf16 v[100:103], v[160:163], v[228:231], v[100:103]
    ds_read_b64_tr_b16 a[118:119], v14 offset:51712
    v_lshlrev_b32 v32, 16, v34
    v_mfma_f32_16x16x32_bf16 v[100:103], v[164:167], v[224:227], v[100:103]
    buffer_load_dword v42, v31, s[40:43], s79 offen
    v_mfma_f32_16x16x32_bf16 v[96:99], v[160:163], v[224:227], v[96:99]
    ds_read_b64_tr_b16 a[8:9], v14 offset:36864
    s_waitcnt lgkmcnt(14)
    v_mfma_f32_16x16x32_bf16 v[112:115], v[128:131], v[208:211], 0
    ds_write_b128 v23, v[108:111] offset:3072
    v_mfma_f32_16x16x32_bf16 v[116:119], v[128:131], v[212:215], 0
    ds_read_b64_tr_b16 a[10:11], v14 offset:37376
    ds_read_b64_tr_b16 a[120:121], v14 offset:53248
    v_mfma_f32_16x16x32_bf16 v[120:123], v[128:131], v[216:219], 0
    ds_write_b128 v23, v[104:107] offset:2048
    v_mfma_f32_16x16x32_bf16 v[124:127], v[128:131], v[220:223], 0
    ds_read_b64_tr_b16 a[122:123], v14 offset:53760
    ds_read_b64_tr_b16 a[12:13], v14 offset:38912
    v_mfma_f32_16x16x32_bf16 v[112:115], v[132:135], v[204:207], v[112:115]
    ds_write_b128 v23, v[100:103] offset:1024
    v_mfma_f32_16x16x32_bf16 v[116:119], v[132:135], v[208:211], v[116:119]
    ds_read_b64_tr_b16 a[14:15], v14 offset:39424
    ds_read_b64_tr_b16 a[124:125], v14 offset:55296
    v_mfma_f32_16x16x32_bf16 v[120:123], v[132:135], v[212:215], v[120:123]
    ds_write_b128 v23, v[96:99] offset:0
    v_mfma_f32_16x16x32_bf16 v[124:127], v[132:135], v[216:219], v[124:127]
    buffer_load_dword v43, v31, s[40:43], s79 offen offset:896
    v_mfma_f32_16x16x32_bf16 v[112:115], v[136:139], v[200:203], v[112:115]
    ds_read_b64_tr_b16 a[126:127], v14 offset:55808
    v_and_b32 v33, 0xffff0000, v34
    v_mfma_f32_16x16x32_bf16 v[116:119], v[136:139], v[204:207], v[116:119]
    v_add_f32 v32, v32, v28
    v_add_f32 v33, v33, v28
    v_mfma_f32_16x16x32_bf16 v[120:123], v[136:139], v[208:211], v[120:123]
    v_cvt_pk_bf16_f32 v34, v32, v33
    v_lshlrev_b32 v32, 16, v34
    v_mfma_f32_16x16x32_bf16 v[124:127], v[136:139], v[212:215], v[124:127]
    s_waitcnt lgkmcnt(0)
    s_barrier
    v_mfma_f32_16x16x32_bf16 v[112:115], v[140:143], v[196:199], v[112:115]
    ds_read_b128 v[64:67], v24 offset:0
    s_add_u32 s79, s79, 114688
    v_mfma_f32_16x16x32_bf16 v[116:119], v[140:143], v[200:203], v[116:119]
    ds_read_b128 v[68:71], v24 offset:4096
    v_and_b32 v33, 0xffff0000, v34
    v_mfma_f32_16x16x32_bf16 v[120:123], v[140:143], v[204:207], v[120:123]
    ds_read_b128 v[72:75], v24 offset:8192
    v_readlane_b32 s30, v32, 0
    v_mfma_f32_16x16x32_bf16 v[124:127], v[140:143], v[208:211], v[124:127]
    ds_read_b128 v[76:79], v24 offset:12288
    v_readlane_b32 s31, v33, 0
    v_mfma_f32_16x16x32_bf16 v[112:115], v[160:163], v[240:243], v[112:115]
    ds_read_b128 v[192:195], v22 offset:3712
    v_readlane_b32 s32, v32, 2
    v_mfma_f32_16x16x32_bf16 v[116:119], v[160:163], v[244:247], v[116:119]
    ds_read_b128 v[196:199], v22 offset:3200
    v_readlane_b32 s33, v33, 2
    v_mfma_f32_16x16x32_bf16 v[120:123], v[160:163], v[248:251], v[120:123]
    ds_read_b128 v[200:203], v22 offset:2688
    s_lshl_b32 s74, s63, 7
    v_mfma_f32_16x16x32_bf16 v[124:127], v[160:163], v[252:255], v[124:127]
    ds_read_b128 v[204:207], v22 offset:2176
    s_add_u32 s76, s74, 5242880
    v_mfma_f32_16x16x32_bf16 v[112:115], v[164:167], v[236:239], v[112:115]
    buffer_load_dword v92, off, s[44:47], s36 sc1
    v_mfma_f32_16x16x32_bf16 v[116:119], v[164:167], v[240:243], v[116:119]
    ds_read_b128 v[208:211], v22 offset:1664
    s_add_u32 s77, s74, 7340032
    v_mfma_f32_16x16x32_bf16 v[120:123], v[164:167], v[244:247], v[120:123]
    ds_read_b128 v[212:215], v22 offset:1152
    s_mov_b32 vcc_lo, 0x55555555
    v_mfma_f32_16x16x32_bf16 v[124:127], v[164:167], v[248:251], v[124:127]
    ds_read_b128 v[216:219], v22 offset:640
    s_mov_b32 vcc_hi, 0x55555555
    v_mfma_f32_16x16x32_bf16 v[112:115], v[168:171], v[232:235], v[112:115]
    buffer_load_dword v92, off, s[44:47], s36 offset:128 sc1
    ds_read_b128 v[220:223], v22 offset:128
    v_mfma_f32_16x16x32_bf16 v[116:119], v[168:171], v[236:239], v[116:119]
    v_lshlrev_b32 v56, 16, v52
    v_mfma_f32_16x16x32_bf16 v[120:123], v[168:171], v[240:243], v[120:123]
    v_and_b32 v60, 0xffff0000, v52
    v_lshlrev_b32 v57, 16, v53
    v_mfma_f32_16x16x32_bf16 v[124:127], v[168:171], v[244:247], v[124:127]
    v_and_b32 v61, 0xffff0000, v53
    v_lshlrev_b32 v58, 16, v54
    v_mfma_f32_16x16x32_bf16 v[112:115], v[172:175], v[228:231], v[112:115]
    v_and_b32 v62, 0xffff0000, v54
    v_lshlrev_b32 v59, 16, v55
    v_mfma_f32_16x16x32_bf16 v[116:119], v[172:175], v[232:235], v[116:119]
    v_and_b32 v63, 0xffff0000, v55
    s_waitcnt lgkmcnt(8)
    v_mfma_f32_16x16x32_bf16 v[120:123], v[172:175], v[236:239], v[120:123]
    v_add_f32 v64, v64, v68
    v_fmac_f32 v56, s30, v64
    v_mfma_f32_16x16x32_bf16 v[124:127], v[172:175], v[240:243], v[124:127]
    v_mul_f32 v64, s32, v56
    s_waitcnt lgkmcnt(0)
    v_mfma_f32_16x16x32_bf16 v[112:115], v[144:147], v[208:211], v[112:115]
    ds_read_b128 v[224:227], v22 offset:3776
    v_add_f32 v65, v65, v69
    v_mfma_f32_16x16x32_bf16 v[116:119], v[144:147], v[212:215], v[116:119]
    ds_read_b128 v[228:231], v22 offset:3264
    v_fmac_f32 v57, s30, v65
    v_mfma_f32_16x16x32_bf16 v[120:123], v[144:147], v[216:219], v[120:123]
    ds_read_b128 v[232:235], v22 offset:2752
    v_mul_f32 v65, s32, v57
    v_mfma_f32_16x16x32_bf16 v[124:127], v[144:147], v[220:223], v[124:127]
    v_add_f32 v66, v66, v70
    v_fmac_f32 v58, s30, v66
    v_mfma_f32_16x16x32_bf16 v[112:115], v[148:151], v[204:207], v[112:115]
    ds_read_b128 v[236:239], v22 offset:2240
    v_mul_f32 v66, s32, v58
    v_mfma_f32_16x16x32_bf16 v[116:119], v[148:151], v[208:211], v[116:119]
    ds_read_b128 v[240:243], v22 offset:1728
    v_add_f32 v67, v67, v71
    v_mfma_f32_16x16x32_bf16 v[120:123], v[148:151], v[212:215], v[120:123]
    ds_read_b128 v[244:247], v22 offset:1216
    v_fmac_f32 v59, s30, v67
    v_mfma_f32_16x16x32_bf16 v[124:127], v[148:151], v[216:219], v[124:127]
    v_mul_f32 v67, s32, v59
    v_cvt_pk_bf16_f32 v88, v64, v65
    v_mfma_f32_16x16x32_bf16 v[112:115], v[152:155], v[200:203], v[112:115]
    ds_read_b128 v[248:251], v22 offset:704
    v_cvt_pk_bf16_f32 v89, v66, v67
    v_mfma_f32_16x16x32_bf16 v[116:119], v[152:155], v[204:207], v[116:119]
    ds_read_b128 v[252:255], v22 offset:192
    v_add_f32 v72, v72, v76
    v_mfma_f32_16x16x32_bf16 v[120:123], v[152:155], v[208:211], v[120:123]
    v_fmac_f32 v60, s31, v72
    v_mul_f32 v72, s33, v60
    v_mfma_f32_16x16x32_bf16 v[124:127], v[152:155], v[212:215], v[124:127]
    v_add_f32 v73, v73, v77
    v_fmac_f32 v61, s31, v73
    v_mfma_f32_16x16x32_bf16 v[112:115], v[156:159], v[196:199], v[112:115]
    v_mul_f32 v73, s33, v61
    v_add_f32 v74, v74, v78
    v_mfma_f32_16x16x32_bf16 v[116:119], v[156:159], v[200:203], v[116:119]
    v_fmac_f32 v62, s31, v74
    v_mul_f32 v74, s33, v62
    v_mfma_f32_16x16x32_bf16 v[120:123], v[156:159], v[204:207], v[120:123]
    v_add_f32 v75, v75, v79
    v_fmac_f32 v63, s31, v75
    v_mfma_f32_16x16x32_bf16 v[124:127], v[156:159], v[208:211], v[124:127]
    v_mul_f32 v75, s33, v63
    s_waitcnt lgkmcnt(0)
    v_mfma_f32_16x16x32_bf16 v[112:115], v[176:179], v[240:243], v[112:115]
    v_cvt_pk_bf16_f32 v90, v72, v73
    v_cvt_pk_bf16_f32 v91, v74, v75
    v_mfma_f32_16x16x32_bf16 v[116:119], v[176:179], v[244:247], v[116:119]
    v_cvt_pk_bf16_f32 v84, v56, v60
    v_cvt_pk_bf16_f32 v85, v57, v61
    v_mfma_f32_16x16x32_bf16 v[120:123], v[176:179], v[248:251], v[120:123]
    ds_read_b128 v[208:211], v22 offset:3584
    v_cvt_pk_bf16_f32 v86, v58, v62
    v_mfma_f32_16x16x32_bf16 v[124:127], v[176:179], v[252:255], v[124:127]
    v_cvt_pk_bf16_f32 v87, v59, v63
    v_cndmask_b32_dpp v80, v90, v88, vcc quad_perm:[1,0,3,2] row_mask:0xf bank_mask:0xf
    v_mfma_f32_16x16x32_bf16 v[112:115], v[180:183], v[236:239], v[112:115]
    ds_read_b128 v[212:215], v22 offset:3072
    v_cndmask_b32_dpp v81, v91, v89, vcc quad_perm:[1,0,3,2] row_mask:0xf bank_mask:0xf
    v_mfma_f32_16x16x32_bf16 v[116:119], v[180:183], v[240:243], v[116:119]
    s_not_b64 vcc, vcc
    v_cndmask_b32_dpp v82, v88, v90, vcc quad_perm:[1,0,3,2] row_mask:0xf bank_mask:0xf
    v_mfma_f32_16x16x32_bf16 v[120:123], v[180:183], v[244:247], v[120:123]
    ds_read_b128 v[216:219], v22 offset:2560
    v_cndmask_b32_dpp v83, v89, v91, vcc quad_perm:[1,0,3,2] row_mask:0xf bank_mask:0xf
    v_mfma_f32_16x16x32_bf16 v[124:127], v[180:183], v[248:251], v[124:127]
    s_not_b64 vcc, vcc
    v_mfma_f32_16x16x32_bf16 v[112:115], v[184:187], v[232:235], v[112:115]
    buffer_store_dwordx4 v[80:83], v25, s[44:47], s76 offen sc1
    ds_read_b128 v[220:223], v22 offset:2048
    v_mfma_f32_16x16x32_bf16 v[116:119], v[184:187], v[236:239], v[116:119]
    buffer_store_dwordx4 v[84:87], v26, s[44:47], s77 offen sc1
    s_add_u32 s76, s76, 57344
    v_mfma_f32_16x16x32_bf16 v[120:123], v[184:187], v[240:243], v[120:123]
    s_add_u32 s77, s77, 57344
    v_mfma_f32_16x16x32_bf16 v[124:127], v[184:187], v[244:247], v[124:127]
    v_mfma_f32_16x16x32_bf16 v[112:115], v[188:191], v[228:231], v[112:115]
    v_mfma_f32_16x16x32_bf16 v[116:119], v[188:191], v[232:235], v[116:119]
    v_mfma_f32_16x16x32_bf16 v[120:123], v[188:191], v[236:239], v[120:123]
    v_mfma_f32_16x16x32_bf16 v[124:127], v[188:191], v[240:243], v[124:127]
    ds_read_b128 v[240:243], v22 offset:3648
    ds_read_b128 v[244:247], v22 offset:3136
    ds_read_b128 v[248:251], v22 offset:2624
    ds_read_b128 v[252:255], v22 offset:2112
    s_waitcnt vmcnt(4)
    ds_write_b64 v29, v[40:41] offset:4096
    ds_write_b64 v29, v[42:43] offset:4608
    s_mov_b32 m0, s60
    v_lshlrev_b32 v72, 16, v40
    v_and_b32 v73, 0xffff0000, v40
    v_lshlrev_b32 v74, 16, v41
    v_and_b32 v75, 0xffff0000, v41
    v_lshlrev_b32 v76, 16, v44
    v_and_b32 v77, 0xffff0000, v44
    v_pk_fma_f32 v[72:73], v[72:73], v[44:45], v[76:77] op_sel:[0,1,0] op_sel_hi:[1,1,0]
    v_pk_fma_f32 v[74:75], v[74:75], v[46:47], v[76:77] op_sel:[0,0,1] op_sel_hi:[1,0,1]
    v_pk_fma_f32 v[72:73], v[72:73], v[38:39], v[36:37]
    v_pk_fma_f32 v[74:75], v[74:75], v[38:39], v[36:37]
    v_cvt_pk_bf16_f32 v64, v72, v74
    v_cvt_pk_bf16_f32 v65, v73, v75
    ds_write_addtid_b32 v64 offset:6260
    ds_write_addtid_b32 v64 offset:14576
    ds_write_addtid_b32 v65 offset:22900
    ds_write_addtid_b32 v65 offset:31216
    v_mov_b32_dpp v78, v64 wave_shr:1 row_mask:0xf bank_mask:0xf
    v_mov_b32_dpp v79, v65 wave_shr:1 row_mask:0xf bank_mask:0xf
    v_alignbit_b32 v68, v64, v78, 16
    v_alignbit_b32 v69, v65, v79, 16
    v_lshlrev_b32 v72, 16, v42
    v_and_b32 v73, 0xffff0000, v42
    v_lshlrev_b32 v74, 16, v43
    v_and_b32 v75, 0xffff0000, v43
    v_lshlrev_b32 v76, 16, v48
    v_and_b32 v77, 0xffff0000, v48
    v_pk_fma_f32 v[72:73], v[72:73], v[48:49], v[76:77] op_sel:[0,1,0] op_sel_hi:[1,1,0]
    v_pk_fma_f32 v[74:75], v[74:75], v[50:51], v[76:77] op_sel:[0,0,1] op_sel_hi:[1,0,1]
    v_pk_fma_f32 v[72:73], v[72:73], v[38:39], v[36:37]
    v_pk_fma_f32 v[74:75], v[74:75], v[38:39], v[36:37]
    v_mov_b32_dpp v78, v64 wave_ror:1 row_mask:0xf bank_mask:0xf
    v_mov_b32_dpp v79, v65 wave_ror:1 row_mask:0xf bank_mask:0xf
    v_cvt_pk_bf16_f32 v66, v72, v74
    v_cvt_pk_bf16_f32 v67, v73, v75
    s_mov_b64 exec, -2
    ds_write_addtid_b32 v68 offset:2100
    ds_write_addtid_b32 v68 offset:10416
    ds_write_addtid_b32 v69 offset:18740
    ds_write_addtid_b32 v69 offset:27056
    s_mov_b64 exec, -1
    ds_write_addtid_b32 v66 offset:6516
    ds_write_addtid_b32 v66 offset:14832
    ds_write_addtid_b32 v67 offset:23156
    ds_write_addtid_b32 v67 offset:31472
    v_mov_b32_dpp v78, v66 wave_shr:1 row_mask:0xf bank_mask:0xf
    v_mov_b32_dpp v79, v67 wave_shr:1 row_mask:0xf bank_mask:0xf
    v_alignbit_b32 v70, v66, v78, 16
    v_alignbit_b32 v71, v67, v79, 16
    v_lshrrev_b32 v78, 16, v66
    v_lshrrev_b32 v79, 16, v67
    s_mov_b64 exec, 1
    v_mov_b32 v78, v64
    v_mov_b32 v79, v65
    s_mov_b64 exec, -1
    ds_write_addtid_b32 v70 offset:2356
    ds_write_addtid_b32 v70 offset:10672
    ds_write_addtid_b32 v71 offset:18996
    ds_write_addtid_b32 v71 offset:27312
    s_mov_b32 exec_lo, 1
    s_mov_b32 exec_hi, 0x80000000
    ds_write_b16 v30, v78 offset:2100
    ds_write_b16 v30, v78 offset:10416
    ds_write_b16 v30, v79 offset:18740
    ds_write_b16 v30, v79 offset:27056
    s_mov_b64 exec, -1
    s_add_u32 m0, s12, 98304
    s_mul_i32 s13, s4, 14
    buffer_load_dwordx4 v6, s[52:55], s13 offen  lds
    s_add_u32 s13, s13, 6144
    buffer_load_dwordx4 v6, s[52:55], s13 offen offset:1024  lds
    s_add_u32 m0, s12, 100352
    s_add_u32 s13, s13, 8192
    buffer_load_dwordx4 v6, s[52:55], s13 offen  lds
    s_add_u32 s13, s13, 6144
    buffer_load_dwordx4 v6, s[52:55], s13 offen offset:1024  lds
    s_waitcnt lgkmcnt(0)
    s_barrier
    ds_read_b128 v[144:147], v21 offset:2176
    ds_read_b128 v[148:151], v21 offset:2688
    ds_read_b128 v[152:155], v21 offset:3200
    ds_read_b128 v[156:159], v21 offset:3712
    ds_read_b128 v[176:179], v21 offset:2240
    ds_read_b128 v[180:183], v21 offset:2752
    ds_read_b128 v[184:187], v21 offset:3264
    ds_read_b128 v[188:191], v21 offset:3776
    s_waitcnt lgkmcnt(7)
    v_mfma_f32_16x16x32_bf16 v[112:115], v[144:147], v[192:195], v[112:115]
    ds_read_b128 v[128:131], v21 offset:2048
    v_mfma_f32_16x16x32_bf16 v[116:119], v[144:147], v[196:199], v[116:119]
    ds_read_b128 v[132:135], v21 offset:2560
    v_mfma_f32_16x16x32_bf16 v[120:123], v[144:147], v[200:203], v[120:123]
    s_add_u32 m0, s12, 102400
    v_mfma_f32_16x16x32_bf16 v[124:127], v[144:147], v[204:207], v[124:127]
    ds_read_b128 v[136:139], v21 offset:3072
    s_waitcnt lgkmcnt(9)
    v_mfma_f32_16x16x32_bf16 v[116:119], v[148:151], v[192:195], v[116:119]
    ds_read_b128 v[140:143], v21 offset:3584
    v_mfma_f32_16x16x32_bf16 v[120:123], v[148:151], v[196:199], v[120:123]
    s_add_u32 s13, s13, 8192
    v_mfma_f32_16x16x32_bf16 v[124:127], v[148:151], v[200:203], v[124:127]
    ds_read_b128 v[160:163], v21 offset:2112
    s_waitcnt lgkmcnt(9)
    v_mfma_f32_16x16x32_bf16 v[120:123], v[152:155], v[192:195], v[120:123]
    ds_read_b128 v[164:167], v21 offset:2624
    v_mfma_f32_16x16x32_bf16 v[124:127], v[152:155], v[196:199], v[124:127]
    buffer_load_dwordx4 v6, s[52:55], s13 offen  lds
    v_mfma_f32_16x16x32_bf16 v[124:127], v[156:159], v[192:195], v[124:127]
    ds_read_b128 v[168:171], v21 offset:3136
    s_waitcnt lgkmcnt(7)
    v_mfma_f32_16x16x32_bf16 v[112:115], v[176:179], v[224:227], v[112:115]
    ds_read_b128 v[172:175], v21 offset:3648
    v_mfma_f32_16x16x32_bf16 v[116:119], v[176:179], v[228:231], v[116:119]
    s_add_u32 s13, s13, 6144
    v_mfma_f32_16x16x32_bf16 v[120:123], v[176:179], v[232:235], v[120:123]
    ds_read_b64_tr_b16 a[16:17], v15 offset:0
    v_mfma_f32_16x16x32_bf16 v[124:127], v[176:179], v[236:239], v[124:127]
    ds_read_b128 v[52:55], v27 offset:56192
    ds_read_b64_tr_b16 a[18:19], v15 offset:512
    v_mfma_f32_16x16x32_bf16 v[116:119], v[180:183], v[224:227], v[116:119]
    buffer_load_dwordx4 v6, s[52:55], s13 offen offset:1024  lds
    v_mfma_f32_16x16x32_bf16 v[120:123], v[180:183], v[228:231], v[120:123]
    ds_read_b64_tr_b16 a[128:129], v15 offset:16384
    v_mfma_f32_16x16x32_bf16 v[124:127], v[180:183], v[232:235], v[124:127]
    ds_read_b64_tr_b16 a[130:131], v15 offset:16896
    v_mfma_f32_16x16x32_bf16 v[120:123], v[184:187], v[224:227], v[120:123]
    v_mfma_f32_16x16x32_bf16 v[124:127], v[184:187], v[228:231], v[124:127]
    s_add_u32 m0, s12, 104448
    v_mfma_f32_16x16x32_bf16 v[124:127], v[188:191], v[224:227], v[124:127]
    ds_read_b64_tr_b16 a[20:21], v15 offset:2048
    s_waitcnt lgkmcnt(10)
    v_mfma_f32_16x16x32_bf16 v[112:115], v[128:131], v[208:211], v[112:115]
    ds_read_b64_tr_b16 a[22:23], v15 offset:2560
    s_waitcnt vmcnt(6)
    v_mfma_f32_16x16x32_bf16 v[116:119], v[128:131], v[212:215], v[116:119]
    s_mov_b64 exec, 1
    buffer_store_dword v4, off, s[44:47], s14 sc1
    s_mov_b64 exec, -1
    v_mfma_f32_16x16x32_bf16 v[120:123], v[128:131], v[216:219], v[120:123]
    s_add_u32 s14, s14, 114688
    s_add_u32 s13, s13, 8192
    v_mfma_f32_16x16x32_bf16 v[124:127], v[128:131], v[220:223], v[124:127]
    ds_read_b64_tr_b16 a[132:133], v15 offset:18432
    ds_read_b64_tr_b16 a[134:135], v15 offset:18944
    v_mfma_f32_16x16x32_bf16 v[116:119], v[132:135], v[208:211], v[116:119]
    buffer_load_dwordx4 v6, s[52:55], s13 offen  lds
    v_mfma_f32_16x16x32_bf16 v[120:123], v[132:135], v[212:215], v[120:123]
    ds_read_b64_tr_b16 a[24:25], v15 offset:4096
    ds_read_b64_tr_b16 a[26:27], v15 offset:4608
    v_mfma_f32_16x16x32_bf16 v[124:127], v[132:135], v[216:219], v[124:127]
    s_waitcnt lgkmcnt(9)
    v_lshlrev_b32 v56, 16, v52
    v_mfma_f32_16x16x32_bf16 v[120:123], v[136:139], v[208:211], v[120:123]
    s_add_u32 s13, s13, 6144
    v_and_b32 v60, 0xffff0000, v52
    v_mfma_f32_16x16x32_bf16 v[124:127], v[136:139], v[212:215], v[124:127]
    ds_read_b64_tr_b16 a[136:137], v15 offset:20480
    ds_read_b64_tr_b16 a[138:139], v15 offset:20992
    v_mfma_f32_16x16x32_bf16 v[124:127], v[140:143], v[208:211], v[124:127]
    v_lshlrev_b32 v57, 16, v53
    v_mfma_f32_16x16x32_bf16 v[124:127], v[160:163], v[252:255], v[124:127]
    buffer_load_dwordx4 v6, s[52:55], s13 offen offset:1024  lds
    v_mfma_f32_16x16x32_bf16 v[124:127], v[164:167], v[248:251], v[124:127]
    ds_read_b64_tr_b16 a[28:29], v15 offset:6144
    ds_read_b64_tr_b16 a[30:31], v15 offset:6656
    v_mfma_f32_16x16x32_bf16 v[124:127], v[168:171], v[244:247], v[124:127]
    v_and_b32 v61, 0xffff0000, v53
    v_lshlrev_b32 v58, 16, v54
    v_mfma_f32_16x16x32_bf16 v[124:127], v[172:175], v[240:243], v[124:127]
    ds_read_b64_tr_b16 a[140:141], v15 offset:22528
    v_and_b32 v62, 0xffff0000, v54
    v_mfma_f32_16x16x32_bf16 v[120:123], v[160:163], v[248:251], v[120:123]
    ds_read_b64_tr_b16 a[142:143], v15 offset:23040
    v_lshlrev_b32 v59, 16, v55
    v_mfma_f32_16x16x32_bf16 v[120:123], v[164:167], v[244:247], v[120:123]
    v_and_b32 v63, 0xffff0000, v55
    v_mfma_f32_16x16x32_bf16 v[120:123], v[168:171], v[240:243], v[120:123]
    v_mfma_f32_16x16x32_bf16 v[116:119], v[160:163], v[244:247], v[116:119]
    v_mfma_f32_16x16x32_bf16 v[116:119], v[164:167], v[240:243], v[116:119]
    v_mfma_f32_16x16x32_bf16 v[112:115], v[160:163], v[240:243], v[112:115]
    ds_write_b128 v23, v[124:127] offset:19456
    s_nop 3
    ds_write_b128 v23, v[120:123] offset:18432
    s_nop 0
    ds_write_b128 v23, v[116:119] offset:17408
    ds_write_b128 v23, v[112:115] offset:16384
    s_waitcnt lgkmcnt(0)
    s_barrier
    ds_read_b128 v[64:67], v24 offset:16384
    ds_read_b128 v[68:71], v24 offset:20480
    ds_read_b128 v[72:75], v24 offset:24576
    ds_read_b128 v[76:79], v24 offset:28672
    s_add_u32 m0, s12, 32768
    s_mul_i32 s13, s7, 56
    buffer_load_dwordx4 v12, s[48:51], s13 offen offset:0 lds
    s_addk_i32 s13, 27648
    buffer_load_dwordx4 v12, s[48:51], s13 offen offset:1024 lds
    s_addk_i32 s13, 27648
    buffer_load_dwordx4 v12, s[48:51], s13 offen offset:2048 lds
    s_addk_i32 s13, 27648
    buffer_load_dwordx4 v12, s[48:51], s13 offen offset:3072 lds
    s_waitcnt lgkmcnt(2)
    v_pk_add_f32 v[64:65], v[64:65], v[68:69]
    v_pk_fma_f32 v[56:57], v[64:65], s[30:31], v[56:57] op_sel:[0,0,0] op_sel_hi:[1,0,1]
    v_pk_mul_f32 v[64:65], v[56:57], s[32:33] op_sel:[0,0] op_sel_hi:[1,0]
    v_pk_add_f32 v[66:67], v[66:67], v[70:71]
    v_pk_fma_f32 v[58:59], v[66:67], s[30:31], v[58:59] op_sel:[0,0,0] op_sel_hi:[1,0,1]
    v_pk_mul_f32 v[66:67], v[58:59], s[32:33] op_sel:[0,0] op_sel_hi:[1,0]
    v_cvt_pk_bf16_f32 v88, v64, v65
    v_cvt_pk_bf16_f32 v89, v66, v67
    s_waitcnt lgkmcnt(0)
    v_pk_add_f32 v[72:73], v[72:73], v[76:77]
    v_pk_fma_f32 v[60:61], v[72:73], s[30:31], v[60:61] op_sel:[0,1,0] op_sel_hi:[1,1,1]
    v_pk_mul_f32 v[72:73], v[60:61], s[32:33] op_sel:[0,1] op_sel_hi:[1,1]
    v_pk_add_f32 v[74:75], v[74:75], v[78:79]
    v_pk_fma_f32 v[62:63], v[74:75], s[30:31], v[62:63] op_sel:[0,1,0] op_sel_hi:[1,1,1]
    v_pk_mul_f32 v[74:75], v[62:63], s[32:33] op_sel:[0,1] op_sel_hi:[1,1]
    v_cvt_pk_bf16_f32 v90, v72, v73
    v_cvt_pk_bf16_f32 v91, v74, v75
    v_cvt_pk_bf16_f32 v84, v56, v60
    v_cvt_pk_bf16_f32 v85, v57, v61
    v_cvt_pk_bf16_f32 v86, v58, v62
    v_cvt_pk_bf16_f32 v87, v59, v63
    v_cndmask_b32_dpp v80, v90, v88, vcc quad_perm:[1,0,3,2] row_mask:0xf bank_mask:0xf
    v_cndmask_b32_dpp v81, v91, v89, vcc quad_perm:[1,0,3,2] row_mask:0xf bank_mask:0xf
    s_not_b64 vcc, vcc
    v_cndmask_b32_dpp v82, v88, v90, vcc quad_perm:[1,0,3,2] row_mask:0xf bank_mask:0xf
    v_cndmask_b32_dpp v83, v89, v91, vcc quad_perm:[1,0,3,2] row_mask:0xf bank_mask:0xf
    s_not_b64 vcc, vcc
    buffer_store_dwordx4 v[80:83], v25, s[44:47], s76 offen sc1
    buffer_store_dwordx4 v[84:87], v26, s[44:47], s77 offen sc1
    s_branch X_join
L_helper:
    s_mov_b32 s42, 1835008
    s_mov_b32 s43, 0x00020000
    s_mov_b32 s46, 0x10000000
    s_mov_b32 s47, 0x00020000
    s_lshl2_add_u32 s36, s2, s64
    s_mul_i32 s37, s36, 1792
    v_lshrrev_b32 v3, 5, v1
    v_mul_u32_u24 v3, 896, v3
    v_and_b32 v4, 31, v1
    v_cmp_gt_u32 vcc, 28, v4
    v_lshl_add_u32 v3, v4, 4, v3
    v_bfrev_b32 v4, 2
    v_cndmask_b32 v2, v4, v3, vcc
    v_mov_b32 v250, 0
    v_lshrrev_b32 v122, 3, v1
    v_lshlrev_b32 v124, 1, v122
    v_and_b32 v124, 4, v124
    v_and_b32 v123, 7, v1
    v_xor_b32 v124, v124, v123
    v_mul_u32_u24 v129, 3584, v122
    v_lshl_add_u32 v129, v124, 4, v129
    v_lshlrev_b32 v130, 4, v0
    s_lshr_b32 s74, s2, 1
    s_mul_i32 s38, s74, 9363
    s_lshr_b32 s38, s38, 16
    s_mul_i32 s39, s38, 7
    s_sub_u32 s39, s74, s39
    s_and_b32 s74, s2, 1
    s_mul_i32 s74, s74, 7
    s_add_u32 s39, s39, s74
    s_and_b32 s75, s64, 1
    s_lshr_b32 s76, s64, 1
    s_lshl1_add_u32 s74, s39, s75
    s_lshl_b32 s74, s74, 7
    s_mul_i32 s77, s76, 802816
    s_add_u32 s79, s74, s77
    s_lshl1_add_u32 s77, s75, s76
    s_mul_i32 m0, s77, 28672
    s_waitcnt lgkmcnt(0)
    s_lshl_b32 s78, s36, 4
    s_add_u32 s78, s78, 4096
    buffer_load_dword v5, off, s[44:47], s78
    buffer_load_dwordx4 v[6:9], v2, s[40:43], s37 offen
    buffer_load_dwordx4 v[10:13], v2, s[40:43], s37 offen offset:448
    s_load_dword s65, s[44:45], 0
    s_mov_b32 s52, s28
    s_mov_b32 s53, s29
    s_mov_b32 s54, 1605632
    s_mov_b32 s55, 0x00020000
    s_cmp_ge_u32 s2, 28
    s_cbranch_scc1 L_hm_skip
    s_cmp_eq_u32 s38, 0
    s_cselect_b64 s[48:49], s[24:25], s[26:27]
    s_mov_b32 s50, 1605632
    s_mov_b32 s51, 0x00020000
    s_mov_b32 s60, s32
    s_mov_b32 s61, s33
    s_mov_b32 s62, 2408448
    s_mov_b32 s63, 0x00020000
    s_cmp_ge_u32 s2, 14
    s_cselect_b32 s67, 1, 0
    s_mul_i32 s74, s67, 14
    s_sub_u32 s68, s2, s74
    s_lshl2_add_u32 s74, s67, s64
    s_mul_i32 s74, s74, 56
    v_add_u32 v122, s74, v122
    v_lshlrev_b32 v124, 1, v122
    v_mul_u32_u24 v125, 5376, v122
    v_lshl_add_u32 v125, v123, 4, v125
    global_load_ushort v98, v124, s[30:31] offset:0
    global_load_ushort v99, v124, s[30:31] offset:16
    global_load_ushort v100, v124, s[30:31] offset:32
    global_load_ushort v101, v124, s[30:31] offset:48
    global_load_ushort v102, v124, s[30:31] offset:64
    global_load_ushort v103, v124, s[30:31] offset:80
    global_load_ushort v104, v124, s[30:31] offset:96
    s_lshl_b32 s13, s68, 7
    buffer_load_dwordx4 v[14:17], v125, s[60:63], s13 offen offset:0 nt
    s_add_u32 s13, s13, 43008
    buffer_load_dwordx4 v[18:21], v125, s[60:63], s13 offen offset:0 nt
    s_add_u32 s13, s13, 43008
    buffer_load_dwordx4 v[22:25], v125, s[60:63], s13 offen offset:0 nt
    s_add_u32 s13, s13, 43008
    buffer_load_dwordx4 v[26:29], v125, s[60:63], s13 offen offset:0 nt
    s_add_u32 s13, s13, 43008
    buffer_load_dwordx4 v[30:33], v125, s[60:63], s13 offen offset:0 nt
    s_add_u32 s13, s13, 43008
    buffer_load_dwordx4 v[34:37], v125, s[60:63], s13 offen offset:0 nt
    s_add_u32 s13, s13, 43008
    buffer_load_dwordx4 v[38:41], v125, s[60:63], s13 offen offset:0 nt
    v_lshrrev_b32 v122, 4, v1
    v_lshl_add_u32 v122, v123, 2, v122
    s_lshl_b32 s74, s64, 8
    s_add_u32 s74, s74, 131072
    v_lshl_add_u32 v126, v122, 3, s74
    v_and_b32 v122, 31, v1
    v_lshlrev_b32 v127, 3, v122
    v_add_u32 v127, 131072, v127
    s_mul_i32 s76, s68, 9363
    s_lshr_b32 s76, s76, 16
    s_mul_i32 s77, s76, 7
    s_sub_u32 s77, s68, s77
    s_mul_i32 s69, s76, 7168
    s_mul_i32 s70, s76, 7
    s_add_u32 s70, s70, s68
    s_lshl1_add_u32 s76, s76, s67
    s_mul_i32 s76, s76, 7
    s_add_u32 s76, s76, s77
    s_lshl_b32 s76, s76, 9
    s_add_u32 s76, s76, 32768
    v_lshl_add_u32 v128, v122, 4, s76
    s_waitcnt lgkmcnt(0)
    s_add_u32 s65, s65, 1
    s_waitcnt vmcnt(14)
    v_mov_b32 v154, 0x3f803f80
    v_mov_b32 v152, 0
    v_mov_b32 v153, 0
    v_dot2c_f32_bf16 v152, v6, v154
    v_dot2c_f32_bf16 v153, v6, v6
    v_dot2c_f32_bf16 v152, v7, v154
    v_dot2c_f32_bf16 v153, v7, v7
    v_dot2c_f32_bf16 v152, v8, v154
    v_dot2c_f32_bf16 v153, v8, v8
    v_dot2c_f32_bf16 v152, v9, v154
    v_dot2c_f32_bf16 v153, v9, v9
    v_dot2c_f32_bf16 v152, v10, v154
    v_dot2c_f32_bf16 v153, v10, v10
    v_dot2c_f32_bf16 v152, v11, v154
    v_dot2c_f32_bf16 v153, v11, v11
    v_dot2c_f32_bf16 v152, v12, v154
    v_dot2c_f32_bf16 v153, v12, v12
    v_dot2c_f32_bf16 v152, v13, v154
    v_dot2c_f32_bf16 v153, v13, v13
    s_nop 1
    v_add_f32_dpp v152, v152, v152 row_shr:1 row_mask:0xf bank_mask:0xf bound_ctrl:1
    v_add_f32_dpp v153, v153, v153 row_shr:1 row_mask:0xf bank_mask:0xf bound_ctrl:1
    s_nop 0
    v_add_f32_dpp v152, v152, v152 row_shr:2 row_mask:0xf bank_mask:0xf bound_ctrl:1
    v_add_f32_dpp v153, v153, v153 row_shr:2 row_mask:0xf bank_mask:0xf bound_ctrl:1
    s_nop 0
    v_add_f32_dpp v152, v152, v152 row_shr:4 row_mask:0xf bank_mask:0xf bound_ctrl:1
    v_add_f32_dpp v153, v153, v153 row_shr:4 row_mask:0xf bank_mask:0xf bound_ctrl:1
    s_nop 0
    v_add_f32_dpp v152, v152, v152 row_shr:8 row_mask:0xf bank_mask:0xf bound_ctrl:1
    v_add_f32_dpp v153, v153, v153 row_shr:8 row_mask:0xf bank_mask:0xf bound_ctrl:1
    s_nop 0
    v_add_f32_dpp v152, v152, v152 row_bcast:15 row_mask:0xa bank_mask:0xf
    v_add_f32_dpp v153, v153, v153 row_bcast:15 row_mask:0xa bank_mask:0xf
    v_mul_f32 v152, 0x3b124925, v152
    v_mul_f32 v155, v152, v152
    v_mov_b32 v154, 0x3b124925
    v_fma_f32 v153, v153, v154, -v155
    v_max_f32 v153, 0, v153
    v_add_f32 v153, 0x3727c5ac, v153
    v_rsq_f32 v150, v153
    v_mov_b32 v151, s65
    v_mul_f32 v152, v152, v150
    v_readlane_b32 s75, v150, 31
    v_readlane_b32 s76, v152, 31
    s_lshl_b32 s74, s36, 4
    s_add_u32 s74, s74, 4096
    v_mov_b32 v149, s75
    v_cvt_pk_bf16_f32 v148, -s76, -v152
    s_mov_b32 exec_lo, 0
    s_mov_b32 exec_hi, 0x80000000
    buffer_store_dwordx4 v[148:151], off, s[44:47], s74 sc1
    s_mov_b64 exec, -1
    s_waitcnt vmcnt(8)
    v_lshlrev_b32 v98, 16, v98
    v_mul_f32 v106, 0xbfb8aa3b, v98
    v_exp_f32 v106, v106
    v_lshlrev_b32 v99, 16, v99
    v_mul_f32 v107, 0xbfb8aa3b, v99
    v_exp_f32 v107, v107
    v_lshlrev_b32 v100, 16, v100
    v_mul_f32 v108, 0xbfb8aa3b, v100
    v_exp_f32 v108, v108
    v_lshlrev_b32 v101, 16, v101
    v_mul_f32 v109, 0xbfb8aa3b, v101
    v_exp_f32 v109, v109
    v_lshlrev_b32 v102, 16, v102
    v_mul_f32 v110, 0xbfb8aa3b, v102
    v_exp_f32 v110, v110
    v_lshlrev_b32 v103, 16, v103
    v_mul_f32 v111, 0xbfb8aa3b, v103
    v_exp_f32 v111, v111
    v_lshlrev_b32 v104, 16, v104
    v_mul_f32 v112, 0xbfb8aa3b, v104
    v_exp_f32 v112, v112
    v_add_f32 v106, 1.0, v106
    v_rcp_f32 v106, v106
    v_add_f32 v107, 1.0, v107
    v_rcp_f32 v107, v107
    v_add_f32 v108, 1.0, v108
    v_rcp_f32 v108, v108
    v_add_f32 v109, 1.0, v109
    v_rcp_f32 v109, v109
    v_add_f32 v110, 1.0, v110
    v_rcp_f32 v110, v110
    v_add_f32 v111, 1.0, v111
    v_rcp_f32 v111, v111
    v_add_f32 v112, 1.0, v112
    v_rcp_f32 v112, v112
    v_mul_f32 v98, v98, v106
    v_cvt_pk_bf16_f32 v98, v98, 0
    v_lshlrev_b32 v106, 16, v98
    v_mul_f32 v99, v99, v107
    v_cvt_pk_bf16_f32 v99, v99, 0
    v_lshlrev_b32 v107, 16, v99
    v_mul_f32 v100, v100, v108
    v_cvt_pk_bf16_f32 v100, v100, 0
    v_lshlrev_b32 v108, 16, v100
    v_mul_f32 v101, v101, v109
    v_cvt_pk_bf16_f32 v101, v101, 0
    v_lshlrev_b32 v109, 16, v101
    v_mul_f32 v102, v102, v110
    v_cvt_pk_bf16_f32 v102, v102, 0
    v_lshlrev_b32 v110, 16, v102
    v_mul_f32 v103, v103, v111
    v_cvt_pk_bf16_f32 v103, v103, 0
    v_lshlrev_b32 v111, 16, v103
    v_mul_f32 v104, v104, v112
    v_cvt_pk_bf16_f32 v104, v104, 0
    v_lshlrev_b32 v112, 16, v104
    v_mov_b32 v134, 0
    v_mov_b32 v135, s65
    v_lshrrev_b32 v248, 2, v0
    v_mul_u32_u24 v248, 3584, v248
    v_and_b32 v247, 2, v0
    v_lshl_add_u32 v248, v247, 6, v248
    s_lshl_b32 s74, s39, 8
    v_add_u32 v248, s74, v248
    v_mov_b32 v114, 0
    v_mov_b32 v115, 0
    v_mov_b32 v116, 0
    v_mov_b32 v117, 0
    v_mov_b32 v118, 0
    v_mov_b32 v119, 0
    v_mov_b32 v120, 0
    v_mov_b32 v121, 0
    s_waitcnt vmcnt(7)
    s_lshl_b32 s13, s70, 7
    buffer_load_dwordx4 v[42:45], v125, s[60:63], s13 offen offset:1792 nt
    v_dot2c_f32_bf16 v114, v14, v98
    v_dot2c_f32_bf16 v115, v14, v106
    v_dot2c_f32_bf16 v116, v15, v98
    v_dot2c_f32_bf16 v117, v15, v106
    v_dot2c_f32_bf16 v118, v16, v98
    v_dot2c_f32_bf16 v119, v16, v106
    v_dot2c_f32_bf16 v120, v17, v98
    v_dot2c_f32_bf16 v121, v17, v106
    s_waitcnt vmcnt(7)
    s_add_u32 s13, s13, 43008
    buffer_load_dwordx4 v[46:49], v125, s[60:63], s13 offen offset:1792 nt
    v_dot2c_f32_bf16 v114, v18, v99
    v_dot2c_f32_bf16 v115, v18, v107
    v_dot2c_f32_bf16 v116, v19, v99
    v_dot2c_f32_bf16 v117, v19, v107
    v_dot2c_f32_bf16 v118, v20, v99
    v_dot2c_f32_bf16 v119, v20, v107
    v_dot2c_f32_bf16 v120, v21, v99
    v_dot2c_f32_bf16 v121, v21, v107
    s_waitcnt vmcnt(7)
    s_add_u32 s13, s13, 43008
    buffer_load_dwordx4 v[50:53], v125, s[60:63], s13 offen offset:1792 nt
    v_dot2c_f32_bf16 v114, v22, v100
    v_dot2c_f32_bf16 v115, v22, v108
    v_dot2c_f32_bf16 v116, v23, v100
    v_dot2c_f32_bf16 v117, v23, v108
    v_dot2c_f32_bf16 v118, v24, v100
    v_dot2c_f32_bf16 v119, v24, v108
    v_dot2c_f32_bf16 v120, v25, v100
    v_dot2c_f32_bf16 v121, v25, v108
    s_waitcnt vmcnt(7)
    s_add_u32 s13, s13, 43008
    buffer_load_dwordx4 v[54:57], v125, s[60:63], s13 offen offset:1792 nt
    v_dot2c_f32_bf16 v114, v26, v101
    v_dot2c_f32_bf16 v115, v26, v109
    v_dot2c_f32_bf16 v116, v27, v101
    v_dot2c_f32_bf16 v117, v27, v109
    v_dot2c_f32_bf16 v118, v28, v101
    v_dot2c_f32_bf16 v119, v28, v109
    v_dot2c_f32_bf16 v120, v29, v101
    v_dot2c_f32_bf16 v121, v29, v109
    s_waitcnt vmcnt(7)
    s_add_u32 s13, s13, 43008
    buffer_load_dwordx4 v[58:61], v125, s[60:63], s13 offen offset:1792 nt
    v_dot2c_f32_bf16 v114, v30, v102
    v_dot2c_f32_bf16 v115, v30, v110
    v_dot2c_f32_bf16 v116, v31, v102
    v_dot2c_f32_bf16 v117, v31, v110
    v_dot2c_f32_bf16 v118, v32, v102
    v_dot2c_f32_bf16 v119, v32, v110
    v_dot2c_f32_bf16 v120, v33, v102
    v_dot2c_f32_bf16 v121, v33, v110
    s_waitcnt vmcnt(7)
    s_add_u32 s13, s13, 43008
    buffer_load_dwordx4 v[62:65], v125, s[60:63], s13 offen offset:1792 nt
    v_dot2c_f32_bf16 v114, v34, v103
    v_dot2c_f32_bf16 v115, v34, v111
    v_dot2c_f32_bf16 v116, v35, v103
    v_dot2c_f32_bf16 v117, v35, v111
    v_dot2c_f32_bf16 v118, v36, v103
    v_dot2c_f32_bf16 v119, v36, v111
    v_dot2c_f32_bf16 v120, v37, v103
    v_dot2c_f32_bf16 v121, v37, v111
    s_waitcnt vmcnt(7)
    s_add_u32 s13, s13, 43008
    buffer_load_dwordx4 v[66:69], v125, s[60:63], s13 offen offset:1792 nt
    v_dot2c_f32_bf16 v114, v38, v104
    v_dot2c_f32_bf16 v115, v38, v112
    v_dot2c_f32_bf16 v116, v39, v104
    v_dot2c_f32_bf16 v117, v39, v112
    v_dot2c_f32_bf16 v118, v40, v104
    v_dot2c_f32_bf16 v119, v40, v112
    v_dot2c_f32_bf16 v120, v41, v104
    v_dot2c_f32_bf16 v121, v41, v112
    v_permlane32_swap_b32 v114, v118
    v_permlane32_swap_b32 v115, v119
    v_permlane32_swap_b32 v116, v120
    v_permlane32_swap_b32 v117, v121
    v_add_f32 v114, v114, v118
    v_add_f32 v115, v115, v119
    v_add_f32 v116, v116, v120
    v_add_f32 v117, v117, v121
    s_nop 0
    v_permlane16_swap_b32 v114, v116
    v_permlane16_swap_b32 v115, v117
    v_add_f32 v114, v114, v116
    v_add_f32 v115, v115, v117
    s_nop 0
    v_add_f32_dpp v114, v114, v114 row_ror:8 row_mask:0xf bank_mask:0xf
    v_add_f32_dpp v115, v115, v115 row_ror:8 row_mask:0xf bank_mask:0xf
    ds_write_b64 v126, v[114:115] offset:0
    s_waitcnt lgkmcnt(0)
    s_barrier
    s_cmp_lg_u32 s64, 0
    s_cbranch_scc1 L_hm_n0
    ds_read_b64 v[136:137], v127 offset:0
    ds_read_b64 v[138:139], v127 offset:256
    ds_read_b64 v[140:141], v127 offset:512
    ds_read_b64 v[142:143], v127 offset:768
    s_mov_b32 s74, 0
    s_waitcnt lgkmcnt(0)
    v_pk_add_f32 v[136:137], v[136:137], v[138:139]
    v_pk_add_f32 v[140:141], v[140:141], v[142:143]
    v_pk_add_f32 v[132:133], v[136:137], v[140:141]
    s_mov_b32 exec_hi, 0
    buffer_store_dwordx4 v[132:135], v128, s[44:47], s74 offen sc1
    s_mov_b64 exec, -1
L_hm_n0:
    v_mov_b32 v114, 0
    v_mov_b32 v115, 0
    v_mov_b32 v116, 0
    v_mov_b32 v117, 0
    v_mov_b32 v118, 0
    v_mov_b32 v119, 0
    v_mov_b32 v120, 0
    v_mov_b32 v121, 0
    s_waitcnt vmcnt(6)
    s_lshl_b32 s13, s70, 7
    buffer_load_dwordx4 v[70:73], v125, s[60:63], s13 offen offset:2688 nt
    v_dot2c_f32_bf16 v114, v42, v98
    v_dot2c_f32_bf16 v115, v42, v106
    v_dot2c_f32_bf16 v116, v43, v98
    v_dot2c_f32_bf16 v117, v43, v106
    v_dot2c_f32_bf16 v118, v44, v98
    v_dot2c_f32_bf16 v119, v44, v106
    v_dot2c_f32_bf16 v120, v45, v98
    v_dot2c_f32_bf16 v121, v45, v106
    s_waitcnt vmcnt(6)
    s_add_u32 s13, s13, 43008
    buffer_load_dwordx4 v[74:77], v125, s[60:63], s13 offen offset:2688 nt
    v_dot2c_f32_bf16 v114, v46, v99
    v_dot2c_f32_bf16 v115, v46, v107
    v_dot2c_f32_bf16 v116, v47, v99
    v_dot2c_f32_bf16 v117, v47, v107
    v_dot2c_f32_bf16 v118, v48, v99
    v_dot2c_f32_bf16 v119, v48, v107
    v_dot2c_f32_bf16 v120, v49, v99
    v_dot2c_f32_bf16 v121, v49, v107
    s_waitcnt vmcnt(6)
    s_add_u32 s13, s13, 43008
    buffer_load_dwordx4 v[78:81], v125, s[60:63], s13 offen offset:2688 nt
    v_dot2c_f32_bf16 v114, v50, v100
    v_dot2c_f32_bf16 v115, v50, v108
    v_dot2c_f32_bf16 v116, v51, v100
    v_dot2c_f32_bf16 v117, v51, v108
    v_dot2c_f32_bf16 v118, v52, v100
    v_dot2c_f32_bf16 v119, v52, v108
    v_dot2c_f32_bf16 v120, v53, v100
    v_dot2c_f32_bf16 v121, v53, v108
    s_waitcnt vmcnt(6)
    s_add_u32 s13, s13, 43008
    buffer_load_dwordx4 v[82:85], v125, s[60:63], s13 offen offset:2688 nt
    v_dot2c_f32_bf16 v114, v54, v101
    v_dot2c_f32_bf16 v115, v54, v109
    v_dot2c_f32_bf16 v116, v55, v101
    v_dot2c_f32_bf16 v117, v55, v109
    v_dot2c_f32_bf16 v118, v56, v101
    v_dot2c_f32_bf16 v119, v56, v109
    v_dot2c_f32_bf16 v120, v57, v101
    v_dot2c_f32_bf16 v121, v57, v109
    s_waitcnt vmcnt(6)
    s_add_u32 s13, s13, 43008
    buffer_load_dwordx4 v[86:89], v125, s[60:63], s13 offen offset:2688 nt
    v_dot2c_f32_bf16 v114, v58, v102
    v_dot2c_f32_bf16 v115, v58, v110
    v_dot2c_f32_bf16 v116, v59, v102
    v_dot2c_f32_bf16 v117, v59, v110
    v_dot2c_f32_bf16 v118, v60, v102
    v_dot2c_f32_bf16 v119, v60, v110
    v_dot2c_f32_bf16 v120, v61, v102
    v_dot2c_f32_bf16 v121, v61, v110
    s_waitcnt vmcnt(6)
    s_add_u32 s13, s13, 43008
    buffer_load_dwordx4 v[90:93], v125, s[60:63], s13 offen offset:2688 nt
    v_dot2c_f32_bf16 v114, v62, v103
    v_dot2c_f32_bf16 v115, v62, v111
    v_dot2c_f32_bf16 v116, v63, v103
    v_dot2c_f32_bf16 v117, v63, v111
    v_dot2c_f32_bf16 v118, v64, v103
    v_dot2c_f32_bf16 v119, v64, v111
    v_dot2c_f32_bf16 v120, v65, v103
    v_dot2c_f32_bf16 v121, v65, v111
    s_waitcnt vmcnt(6)
    s_add_u32 s13, s13, 43008
    buffer_load_dwordx4 v[94:97], v125, s[60:63], s13 offen offset:2688 nt
    v_dot2c_f32_bf16 v114, v66, v104
    v_dot2c_f32_bf16 v115, v66, v112
    v_dot2c_f32_bf16 v116, v67, v104
    v_dot2c_f32_bf16 v117, v67, v112
    v_dot2c_f32_bf16 v118, v68, v104
    v_dot2c_f32_bf16 v119, v68, v112
    v_dot2c_f32_bf16 v120, v69, v104
    v_dot2c_f32_bf16 v121, v69, v112
    v_permlane32_swap_b32 v114, v118
    v_permlane32_swap_b32 v115, v119
    v_permlane32_swap_b32 v116, v120
    v_permlane32_swap_b32 v117, v121
    v_add_f32 v114, v114, v118
    v_add_f32 v115, v115, v119
    v_add_f32 v116, v116, v120
    v_add_f32 v117, v117, v121
    s_nop 0
    v_permlane16_swap_b32 v114, v116
    v_permlane16_swap_b32 v115, v117
    v_add_f32 v114, v114, v116
    v_add_f32 v115, v115, v117
    s_nop 0
    v_add_f32_dpp v114, v114, v114 row_ror:8 row_mask:0xf bank_mask:0xf
    v_add_f32_dpp v115, v115, v115 row_ror:8 row_mask:0xf bank_mask:0xf
    ds_write_b64 v126, v[114:115] offset:1024
    s_waitcnt lgkmcnt(0)
    s_barrier
    s_cmp_lg_u32 s64, 1
    s_cbranch_scc1 L_hm_n1
    ds_read_b64 v[136:137], v127 offset:1024
    ds_read_b64 v[138:139], v127 offset:1280
    ds_read_b64 v[140:141], v127 offset:1536
    ds_read_b64 v[142:143], v127 offset:1792
    s_add_u32 s74, s69, 14336
    s_waitcnt lgkmcnt(0)
    v_pk_add_f32 v[136:137], v[136:137], v[138:139]
    v_pk_add_f32 v[140:141], v[140:141], v[142:143]
    v_pk_add_f32 v[132:133], v[136:137], v[140:141]
    s_mov_b32 exec_hi, 0
    buffer_store_dwordx4 v[132:135], v128, s[44:47], s74 offen sc1
    s_mov_b64 exec, -1
L_hm_n1:
    v_mov_b32 v114, 0
    v_mov_b32 v115, 0
    v_mov_b32 v116, 0
    v_mov_b32 v117, 0
    v_mov_b32 v118, 0
    v_mov_b32 v119, 0
    v_mov_b32 v120, 0
    v_mov_b32 v121, 0
    s_waitcnt vmcnt(6)
    s_mul_i32 s13, s2, 32768
    buffer_load_dwordx4 v[244:247], v130, s[52:55], s13 offen
    v_dot2c_f32_bf16 v114, v70, v98
    v_dot2c_f32_bf16 v115, v70, v106
    v_dot2c_f32_bf16 v116, v71, v98
    v_dot2c_f32_bf16 v117, v71, v106
    v_dot2c_f32_bf16 v118, v72, v98
    v_dot2c_f32_bf16 v119, v72, v106
    v_dot2c_f32_bf16 v120, v73, v98
    v_dot2c_f32_bf16 v121, v73, v106
    s_waitcnt vmcnt(6)
    s_add_u32 s13, s13, 4096
    buffer_load_dwordx4 v[244:247], v130, s[52:55], s13 offen
    v_dot2c_f32_bf16 v114, v74, v99
    v_dot2c_f32_bf16 v115, v74, v107
    v_dot2c_f32_bf16 v116, v75, v99
    v_dot2c_f32_bf16 v117, v75, v107
    v_dot2c_f32_bf16 v118, v76, v99
    v_dot2c_f32_bf16 v119, v76, v107
    v_dot2c_f32_bf16 v120, v77, v99
    v_dot2c_f32_bf16 v121, v77, v107
    s_waitcnt vmcnt(6)
    s_add_u32 s13, s13, 4096
    buffer_load_dwordx4 v[244:247], v130, s[52:55], s13 offen
    v_dot2c_f32_bf16 v114, v78, v100
    v_dot2c_f32_bf16 v115, v78, v108
    v_dot2c_f32_bf16 v116, v79, v100
    v_dot2c_f32_bf16 v117, v79, v108
    v_dot2c_f32_bf16 v118, v80, v100
    v_dot2c_f32_bf16 v119, v80, v108
    v_dot2c_f32_bf16 v120, v81, v100
    v_dot2c_f32_bf16 v121, v81, v108
    s_waitcnt vmcnt(6)
    s_add_u32 s13, s13, 4096
    buffer_load_dwordx4 v[244:247], v130, s[52:55], s13 offen
    v_dot2c_f32_bf16 v114, v82, v101
    v_dot2c_f32_bf16 v115, v82, v109
    v_dot2c_f32_bf16 v116, v83, v101
    v_dot2c_f32_bf16 v117, v83, v109
    v_dot2c_f32_bf16 v118, v84, v101
    v_dot2c_f32_bf16 v119, v84, v109
    v_dot2c_f32_bf16 v120, v85, v101
    v_dot2c_f32_bf16 v121, v85, v109
    s_waitcnt vmcnt(6)
    s_add_u32 s13, s13, 4096
    buffer_load_dwordx4 v[244:247], v130, s[52:55], s13 offen
    v_dot2c_f32_bf16 v114, v86, v102
    v_dot2c_f32_bf16 v115, v86, v110
    v_dot2c_f32_bf16 v116, v87, v102
    v_dot2c_f32_bf16 v117, v87, v110
    v_dot2c_f32_bf16 v118, v88, v102
    v_dot2c_f32_bf16 v119, v88, v110
    v_dot2c_f32_bf16 v120, v89, v102
    v_dot2c_f32_bf16 v121, v89, v110
    s_waitcnt vmcnt(6)
    s_add_u32 s13, s13, 4096
    buffer_load_dwordx4 v[244:247], v130, s[52:55], s13 offen
    v_dot2c_f32_bf16 v114, v90, v103
    v_dot2c_f32_bf16 v115, v90, v111
    v_dot2c_f32_bf16 v116, v91, v103
    v_dot2c_f32_bf16 v117, v91, v111
    v_dot2c_f32_bf16 v118, v92, v103
    v_dot2c_f32_bf16 v119, v92, v111
    v_dot2c_f32_bf16 v120, v93, v103
    v_dot2c_f32_bf16 v121, v93, v111
    s_waitcnt vmcnt(6)
    s_add_u32 s13, s13, 4096
    buffer_load_dwordx4 v[244:247], v130, s[52:55], s13 offen
    v_dot2c_f32_bf16 v114, v94, v104
    v_dot2c_f32_bf16 v115, v94, v112
    v_dot2c_f32_bf16 v116, v95, v104
    v_dot2c_f32_bf16 v117, v95, v112
    v_dot2c_f32_bf16 v118, v96, v104
    v_dot2c_f32_bf16 v119, v96, v112
    v_dot2c_f32_bf16 v120, v97, v104
    v_dot2c_f32_bf16 v121, v97, v112
    v_permlane32_swap_b32 v114, v118
    v_permlane32_swap_b32 v115, v119
    v_permlane32_swap_b32 v116, v120
    v_permlane32_swap_b32 v117, v121
    v_add_f32 v114, v114, v118
    v_add_f32 v115, v115, v119
    v_add_f32 v116, v116, v120
    v_add_f32 v117, v117, v121
    s_nop 0
    v_permlane16_swap_b32 v114, v116
    v_permlane16_swap_b32 v115, v117
    v_add_f32 v114, v114, v116
    v_add_f32 v115, v115, v117
    s_nop 0
    v_add_f32_dpp v114, v114, v114 row_ror:8 row_mask:0xf bank_mask:0xf
    v_add_f32_dpp v115, v115, v115 row_ror:8 row_mask:0xf bank_mask:0xf
    ds_write_b64 v126, v[114:115] offset:2048
    s_waitcnt lgkmcnt(0)
    s_barrier
    s_cmp_lg_u32 s64, 2
    s_cbranch_scc1 L_hm_n2
    ds_read_b64 v[136:137], v127 offset:2048
    ds_read_b64 v[138:139], v127 offset:2304
    ds_read_b64 v[140:141], v127 offset:2560
    ds_read_b64 v[142:143], v127 offset:2816
    s_add_u32 s74, s69, 21504
    s_waitcnt lgkmcnt(0)
    v_pk_add_f32 v[136:137], v[136:137], v[138:139]
    v_pk_add_f32 v[140:141], v[140:141], v[142:143]
    v_pk_add_f32 v[132:133], v[136:137], v[140:141]
    s_mov_b32 exec_hi, 0
    buffer_store_dwordx4 v[132:135], v128, s[44:47], s74 offen sc1
    s_mov_b64 exec, -1
L_hm_n2:
    s_add_u32 s13, s13, 4096
    buffer_load_dwordx4 v[244:247], v130, s[52:55], s13 offen
    buffer_load_dwordx4 v129, s[48:51], s79 offen lds
    s_add_u32 m0, m0, 1024
    s_add_u32 s79, s79, 28672
    buffer_load_dwordx4 v129, s[48:51], s79 offen lds
    s_add_u32 m0, m0, 1024
    s_add_u32 s79, s79, 28672
    buffer_load_dwordx4 v129, s[48:51], s79 offen lds
    s_add_u32 m0, m0, 1024
    s_add_u32 s79, s79, 28672
    buffer_load_dwordx4 v129, s[48:51], s79 offen lds
    s_add_u32 m0, m0, 1024
    s_add_u32 s79, s79, 28672
    buffer_load_dwordx4 v129, s[48:51], s79 offen lds
    s_add_u32 m0, m0, 1024
    s_add_u32 s79, s79, 28672
    buffer_load_dwordx4 v129, s[48:51], s79 offen lds
    s_add_u32 m0, m0, 1024
    s_add_u32 s79, s79, 28672
    buffer_load_dwordx4 v129, s[48:51], s79 offen lds
    s_add_u32 m0, m0, 1024
    s_add_u32 s79, s79, 28672
    buffer_load_dwordx4 v129, s[48:51], s79 offen lds
    s_add_u32 m0, m0, 1024
    s_add_u32 s79, s79, 28672
    buffer_load_dwordx4 v129, s[48:51], s79 offen lds
    s_add_u32 m0, m0, 1024
    s_add_u32 s79, s79, 28672
    buffer_load_dwordx4 v129, s[48:51], s79 offen lds
    s_add_u32 m0, m0, 1024
    s_add_u32 s79, s79, 28672
    buffer_load_dwordx4 v129, s[48:51], s79 offen lds
    s_add_u32 m0, m0, 1024
    s_add_u32 s79, s79, 28672
    buffer_load_dwordx4 v129, s[48:51], s79 offen lds
    s_add_u32 m0, m0, 1024
    s_add_u32 s79, s79, 28672
    buffer_load_dwordx4 v129, s[48:51], s79 offen lds
    s_add_u32 m0, m0, 1024
    s_add_u32 s79, s79, 28672
    buffer_load_dwordx4 v129, s[48:51], s79 offen lds
    s_add_u32 m0, m0, 1024
    s_add_u32 s79, s79, 28672
    buffer_load_dwordx4 v129, s[48:51], s79 offen lds
    s_add_u32 m0, m0, 1024
    s_add_u32 s79, s79, 28672
    buffer_load_dwordx4 v129, s[48:51], s79 offen lds
    s_add_u32 m0, m0, 1024
    s_add_u32 s79, s79, 28672
    buffer_load_dwordx4 v129, s[48:51], s79 offen lds
    s_add_u32 m0, m0, 1024
    s_add_u32 s79, s79, 28672
    buffer_load_dwordx4 v129, s[48:51], s79 offen lds
    s_add_u32 m0, m0, 1024
    s_add_u32 s79, s79, 28672
    buffer_load_dwordx4 v129, s[48:51], s79 offen lds
    s_add_u32 m0, m0, 1024
    s_add_u32 s79, s79, 28672
    buffer_load_dwordx4 v129, s[48:51], s79 offen lds
    s_add_u32 m0, m0, 1024
    s_add_u32 s79, s79, 28672
    buffer_load_dwordx4 v129, s[48:51], s79 offen lds
    s_add_u32 m0, m0, 1024
    s_add_u32 s79, s79, 28672
    buffer_load_dwordx4 v129, s[48:51], s79 offen lds
    s_add_u32 m0, m0, 1024
    s_add_u32 s79, s79, 28672
    buffer_load_dwordx4 v129, s[48:51], s79 offen lds
    s_add_u32 m0, m0, 1024
    s_add_u32 s79, s79, 28672
    buffer_load_dwordx4 v129, s[48:51], s79 offen lds
    s_add_u32 m0, m0, 1024
    s_add_u32 s79, s79, 28672
    buffer_load_dwordx4 v129, s[48:51], s79 offen lds
    s_add_u32 m0, m0, 1024
    s_add_u32 s79, s79, 28672
    buffer_load_dwordx4 v129, s[48:51], s79 offen lds
    s_add_u32 m0, m0, 1024
    s_add_u32 s79, s79, 28672
    buffer_load_dwordx4 v129, s[48:51], s79 offen lds
    s_add_u32 m0, m0, 1024
    s_add_u32 s79, s79, 28672
    buffer_load_dwordx4 v129, s[48:51], s79 offen lds
    s_add_u32 m0, m0, 1024
    s_add_u32 s79, s79, 28672
    s_branch L_hm_done
L_hm_skip:
    s_waitcnt lgkmcnt(0)
    s_add_u32 s65, s65, 1
    s_waitcnt vmcnt(0)
    v_mov_b32 v154, 0x3f803f80
    v_mov_b32 v152, 0
    v_mov_b32 v153, 0
    v_dot2c_f32_bf16 v152, v6, v154
    v_dot2c_f32_bf16 v153, v6, v6
    v_dot2c_f32_bf16 v152, v7, v154
    v_dot2c_f32_bf16 v153, v7, v7
    v_dot2c_f32_bf16 v152, v8, v154
    v_dot2c_f32_bf16 v153, v8, v8
    v_dot2c_f32_bf16 v152, v9, v154
    v_dot2c_f32_bf16 v153, v9, v9
    v_dot2c_f32_bf16 v152, v10, v154
    v_dot2c_f32_bf16 v153, v10, v10
    v_dot2c_f32_bf16 v152, v11, v154
    v_dot2c_f32_bf16 v153, v11, v11
    v_dot2c_f32_bf16 v152, v12, v154
    v_dot2c_f32_bf16 v153, v12, v12
    v_dot2c_f32_bf16 v152, v13, v154
    v_dot2c_f32_bf16 v153, v13, v13
    s_nop 1
    v_add_f32_dpp v152, v152, v152 row_shr:1 row_mask:0xf bank_mask:0xf bound_ctrl:1
    v_add_f32_dpp v153, v153, v153 row_shr:1 row_mask:0xf bank_mask:0xf bound_ctrl:1
    s_nop 0
    v_add_f32_dpp v152, v152, v152 row_shr:2 row_mask:0xf bank_mask:0xf bound_ctrl:1
    v_add_f32_dpp v153, v153, v153 row_shr:2 row_mask:0xf bank_mask:0xf bound_ctrl:1
    s_nop 0
    v_add_f32_dpp v152, v152, v152 row_shr:4 row_mask:0xf bank_mask:0xf bound_ctrl:1
    v_add_f32_dpp v153, v153, v153 row_shr:4 row_mask:0xf bank_mask:0xf bound_ctrl:1
    s_nop 0
    v_add_f32_dpp v152, v152, v152 row_shr:8 row_mask:0xf bank_mask:0xf bound_ctrl:1
    v_add_f32_dpp v153, v153, v153 row_shr:8 row_mask:0xf bank_mask:0xf bound_ctrl:1
    s_nop 0
    v_add_f32_dpp v152, v152, v152 row_bcast:15 row_mask:0xa bank_mask:0xf
    v_add_f32_dpp v153, v153, v153 row_bcast:15 row_mask:0xa bank_mask:0xf
    v_mul_f32 v152, 0x3b124925, v152
    v_mul_f32 v155, v152, v152
    v_mov_b32 v154, 0x3b124925
    v_fma_f32 v153, v153, v154, -v155
    v_max_f32 v153, 0, v153
    v_add_f32 v153, 0x3727c5ac, v153
    v_rsq_f32 v150, v153
    v_mov_b32 v151, s65
    v_mul_f32 v152, v152, v150
    v_readlane_b32 s75, v150, 31
    v_readlane_b32 s76, v152, 31
    s_lshl_b32 s74, s36, 4
    s_add_u32 s74, s74, 4096
    v_mov_b32 v149, s75
    v_cvt_pk_bf16_f32 v148, -s76, -v152
    s_mov_b32 exec_lo, 0
    s_mov_b32 exec_hi, 0x80000000
    buffer_store_dwordx4 v[148:151], off, s[44:47], s74 sc1
    s_mov_b64 exec, -1
    s_and_b32 s74, s2, 3
    s_lshl2_add_u32 s74, s74, s64
    s_mul_i32 s74, s74, 56
    v_min_u32 v250, 55, v1
    v_add_u32 v250, s74, v250
    v_lshlrev_b32 v250, 7, v250
    v_add_u32 v250, 786432, v250
    buffer_load_dword v251, v250, s[44:47], 0 offen sc1
    s_mov_b32 s74, 114688
    buffer_load_dword v251, v250, s[44:47], s74 offen sc1
    s_sub_u32 s13, 32, s2
    s_mul_i32 s13, s13, 114688
    s_sub_u32 s13, 1605632, s13
    s_mov_b32 s74, 7
L_hm_pf:
    buffer_load_dwordx4 v[144:147], v130, s[52:55], s13 offen
    s_add_u32 s13, s13, 4096
    buffer_load_dwordx4 v[144:147], v130, s[52:55], s13 offen
    s_add_u32 s13, s13, 4096
    buffer_load_dwordx4 v[144:147], v130, s[52:55], s13 offen
    s_add_u32 s13, s13, 4096
    buffer_load_dwordx4 v[144:147], v130, s[52:55], s13 offen
    s_add_u32 s13, s13, 4096
    s_sub_u32 s74, s74, 1
    s_cmp_lg_u32 s74, 0
    s_cbranch_scc1 L_hm_pf
    s_waitcnt vmcnt(0)
L_hm_done:
    s_and_b32 s75, s2, 7
    s_bfe_u32 s76, s2, 0x10003
    s_lshl1_add_u32 s69, s75, s76
    s_lshr_b32 s76, s2, 4
    s_lshl2_add_u32 s15, s69, s76
    s_mul_i32 s75, s15, 28672
    s_add_u32 s75, s75, 7340032
    v_lshl_add_u32 v223, v0, 4, s75
    v_mov_b32 v226, 0x3f803f80
    v_and_b32 v221, 7, v1
    v_lshrrev_b32 v222, 4, v1
    v_lshl_add_u32 v222, v221, 2, v222
    s_lshl_b32 s74, s64, 8
    s_add_u32 s74, s74, 139264
    v_lshl_add_u32 v227, v222, 3, s74
    v_and_b32 v221, 31, v1
    v_lshlrev_b32 v228, 3, v221
    v_add_u32 v228, 139264, v228
    v_lshlrev_b32 v229, 4, v1
    s_lshl_b32 s79, s15, 9
    s_add_u32 s79, s79, 147456
    s_bfe_u32 s74, s2, 0x20001
    s_lshr_b32 s75, s2, 3
    s_lshl2_add_u32 s74, s74, s75
    s_mul_i32 s74, s74, 114688
    s_add_u32 s74, s74, 5242880
    v_min_u32 v249, 223, v0
    v_lshl_add_u32 v249, v249, 7, s74
    s_cmp_lt_u32 s2, 28
    s_cbranch_scc1 L_nogo0
    s_mov_b32 s78, 200000
    s_mov_b32 s77, 0
L_hf0:
    buffer_load_dword v251, v250, s[44:47], s77 offen sc1
    s_sub_u32 s78, s78, 1
    s_cbranch_scc1 L_hf0_ok
    s_waitcnt vmcnt(0)
    v_cmpx_ne_u32 vcc, s65, v251
    s_nop 0
    s_cbranch_execnz L_hf0
L_hf0_ok:
    s_mov_b64 exec, -1
    s_barrier
    s_and_b32 s74, s2, 3
    s_lshl2_add_u32 s74, s74, s64
    s_lshl_b32 s74, s74, 8
    s_add_u32 s74, s74, 196608
    v_mov_b32 v252, s65
    s_mov_b64 exec, 1
    buffer_store_dword v252, off, s[44:47], s74 sc1
    s_mov_b64 exec, -1
L_nogo0:
    s_cmp_lt_u32 s2, 28
    s_cbranch_scc1 L_nogo1
    s_mov_b32 s78, 200000
    s_mov_b32 s77, 114688
L_hf1:
    buffer_load_dword v251, v250, s[44:47], s77 offen sc1
    s_sub_u32 s78, s78, 1
    s_cbranch_scc1 L_hf1_ok
    s_waitcnt vmcnt(0)
    v_cmpx_ne_u32 vcc, s65, v251
    s_nop 0
    s_cbranch_execnz L_hf1
L_hf1_ok:
    s_mov_b64 exec, -1
    s_barrier
    s_and_b32 s74, s2, 3
    s_lshl2_add_u32 s74, s74, s64
    s_lshl_b32 s74, s74, 8
    s_add_u32 s74, s74, 196736
    v_mov_b32 v252, s65
    s_mov_b64 exec, 1
    buffer_store_dword v252, off, s[44:47], s74 sc1
    s_mov_b64 exec, -1
L_nogo1:
    s_cmp_ge_u32 s2, 28
    s_cbranch_scc1 L_hr_skip
    s_mov_b32 s67, s38
    s_mov_b32 s68, s39
    s_and_b32 s75, s64, 1
    s_lshr_b32 s76, s64, 1
    v_lshrrev_b32 v220, 5, v1
    v_bfe_u32 v221, v1, 2, 2
    v_lshl_add_u32 v220, v220, 3, v221
    v_lshlrev_b32 v224, 7, v220
    v_bfe_u32 v221, v1, 4, 1
    v_lshl_add_u32 v224, v221, 5, v224
    v_and_b32 v221, 3, v1
    v_lshl_add_u32 v224, v221, 3, v224
    v_bfe_u32 v221, v1, 3, 1
    v_xor_b32 v221, s75, v221
    v_lshl_add_u32 v224, v221, 6, v224
    s_mul_i32 s77, s76, 57344
    v_add_u32 v224, s77, v224
    v_and_b32 v220, 1, v1
    v_lshlrev_b32 v225, 10, v220
    v_lshrrev_b32 v220, 5, v1
    v_lshl_add_u32 v225, v220, 4, v225
    v_add_u32 v225, 135168, v225
    v_min_u32 v222, 223, v0
    v_lshlrev_b32 v220, 4, v222
    s_mov_b32 s77, 61440
    buffer_load_dwordx4 v[2:5], v220, s[44:47], s77 offen sc1
    buffer_load_dwordx4 v[6:9], v220, s[44:47], s77 offen offset:3584 sc1
    s_mov_b32 s77, 54272
    buffer_load_dwordx4 v[10:13], v220, s[44:47], s77 offen sc1
    buffer_load_dwordx4 v[14:17], v220, s[44:47], s77 offen offset:3584 sc1
    s_waitcnt vmcnt(0)
    v_cmpx_eq_u32 vcc, s65, v5
    v_cmpx_eq_u32 vcc, s65, v9
    v_cmpx_eq_u32 vcc, s65, v13
    v_cmpx_eq_u32 vcc, s65, v17
    s_nop 0
    s_cmp_eq_u64 exec, -1
    s_mov_b64 exec, -1
    s_cbranch_scc0 L_hg_re
L_hg_ok:
    v_add_f32 v230, v2, v6
    v_add_f32 v231, v3, v7
    v_cvt_pk_bf16_f32 v2, v230, v231
    v_lshlrev_b32 v230, 16, v2
    v_and_b32 v231, 0xffff0000, v2
    v_add_f32 v230, 1.0, v230
    v_add_f32 v231, 1.0, v231
    v_cvt_pk_bf16_f32 v2, v230, v231
    v_lshlrev_b32 v230, 16, v2
    v_and_b32 v231, 0xffff0000, v2
    v_add_f32 v232, v10, v14
    v_add_f32 v233, v11, v15
    v_cvt_pk_bf16_f32 v10, v232, v233
    v_lshlrev_b32 v232, 16, v10
    v_and_b32 v233, 0xffff0000, v10
    v_lshlrev_b32 v222, 2, v222
    v_add_u32 v222, 135168, v222
    ds_write_b32 v222, v2
    ds_write_b32 v222, v10 offset:1024
    s_waitcnt lgkmcnt(0)
    s_barrier
    ds_read_b128 v[164:167], v225 offset:0
    ds_read_b64_tr_b16 v[36:37], v224 offset:0
    ds_read_b64_tr_b16 v[38:39], v224 offset:512
    ds_read_b128 v[168:171], v225 offset:32
    ds_read_b64_tr_b16 v[40:41], v224 offset:2048
    ds_read_b64_tr_b16 v[42:43], v224 offset:2560
    ds_read_b128 v[172:175], v225 offset:64
    ds_read_b64_tr_b16 v[44:45], v224 offset:4096
    ds_read_b64_tr_b16 v[46:47], v224 offset:4608
    ds_read_b128 v[176:179], v225 offset:96
    ds_read_b64_tr_b16 v[48:49], v224 offset:6144
    ds_read_b64_tr_b16 v[50:51], v224 offset:6656
    s_waitcnt lgkmcnt(9)
    v_mfma_f32_32x32x16_bf16 v[20:35], v[164:167], v[36:39], 0
    ds_read_b128 v[180:183], v225 offset:128
    ds_read_b64_tr_b16 v[52:53], v224 offset:8192
    ds_read_b64_tr_b16 v[54:55], v224 offset:8704
    s_waitcnt lgkmcnt(9)
    v_mfma_f32_32x32x16_bf16 v[20:35], v[168:171], v[40:43], v[20:35]
    ds_read_b128 v[184:187], v225 offset:160
    ds_read_b64_tr_b16 v[56:57], v224 offset:10240
    ds_read_b64_tr_b16 v[58:59], v224 offset:10752
    s_waitcnt lgkmcnt(9)
    v_mfma_f32_32x32x16_bf16 v[20:35], v[172:175], v[44:47], v[20:35]
    ds_read_b128 v[188:191], v225 offset:192
    ds_read_b64_tr_b16 v[60:61], v224 offset:12288
    ds_read_b64_tr_b16 v[62:63], v224 offset:12800
    s_waitcnt lgkmcnt(9)
    v_mfma_f32_32x32x16_bf16 v[20:35], v[176:179], v[48:51], v[20:35]
    ds_read_b128 v[192:195], v225 offset:224
    ds_read_b64_tr_b16 v[64:65], v224 offset:14336
    ds_read_b64_tr_b16 v[66:67], v224 offset:14848
    s_waitcnt lgkmcnt(9)
    v_mfma_f32_32x32x16_bf16 v[20:35], v[180:183], v[52:55], v[20:35]
    ds_read_b128 v[164:167], v225 offset:256
    ds_read_b64_tr_b16 v[68:69], v224 offset:16384
    ds_read_b64_tr_b16 v[70:71], v224 offset:16896
    s_waitcnt lgkmcnt(9)
    v_mfma_f32_32x32x16_bf16 v[20:35], v[184:187], v[56:59], v[20:35]
    ds_read_b128 v[168:171], v225 offset:288
    ds_read_b64_tr_b16 v[72:73], v224 offset:18432
    ds_read_b64_tr_b16 v[74:75], v224 offset:18944
    s_waitcnt lgkmcnt(9)
    v_mfma_f32_32x32x16_bf16 v[20:35], v[188:191], v[60:63], v[20:35]
    ds_read_b128 v[172:175], v225 offset:320
    ds_read_b64_tr_b16 v[76:77], v224 offset:20480
    ds_read_b64_tr_b16 v[78:79], v224 offset:20992
    s_waitcnt lgkmcnt(9)
    v_mfma_f32_32x32x16_bf16 v[20:35], v[192:195], v[64:67], v[20:35]
    ds_read_b128 v[176:179], v225 offset:352
    ds_read_b64_tr_b16 v[80:81], v224 offset:22528
    ds_read_b64_tr_b16 v[82:83], v224 offset:23040
    s_waitcnt lgkmcnt(9)
    v_mfma_f32_32x32x16_bf16 v[20:35], v[164:167], v[68:71], v[20:35]
    ds_read_b128 v[180:183], v225 offset:384
    ds_read_b64_tr_b16 v[84:85], v224 offset:24576
    ds_read_b64_tr_b16 v[86:87], v224 offset:25088
    s_waitcnt lgkmcnt(9)
    v_mfma_f32_32x32x16_bf16 v[20:35], v[168:171], v[72:75], v[20:35]
    ds_read_b128 v[184:187], v225 offset:416
    ds_read_b64_tr_b16 v[88:89], v224 offset:26624
    ds_read_b64_tr_b16 v[90:91], v224 offset:27136
    s_waitcnt lgkmcnt(9)
    v_mfma_f32_32x32x16_bf16 v[20:35], v[172:175], v[76:79], v[20:35]
    ds_read_b128 v[188:191], v225 offset:448
    ds_read_b64_tr_b16 v[92:93], v224 offset:28672
    ds_read_b64_tr_b16 v[94:95], v224 offset:29184
    s_waitcnt lgkmcnt(9)
    v_mfma_f32_32x32x16_bf16 v[20:35], v[176:179], v[80:83], v[20:35]
    ds_read_b128 v[192:195], v225 offset:480
    ds_read_b64_tr_b16 v[96:97], v224 offset:30720
    ds_read_b64_tr_b16 v[98:99], v224 offset:31232
    s_waitcnt lgkmcnt(9)
    v_mfma_f32_32x32x16_bf16 v[20:35], v[180:183], v[84:87], v[20:35]
    ds_read_b128 v[164:167], v225 offset:512
    ds_read_b64_tr_b16 v[100:101], v224 offset:32768
    ds_read_b64_tr_b16 v[102:103], v224 offset:33280
    s_waitcnt lgkmcnt(9)
    v_mfma_f32_32x32x16_bf16 v[20:35], v[184:187], v[88:91], v[20:35]
    ds_read_b128 v[168:171], v225 offset:544
    ds_read_b64_tr_b16 v[104:105], v224 offset:34816
    ds_read_b64_tr_b16 v[106:107], v224 offset:35328
    s_waitcnt lgkmcnt(9)
    v_mfma_f32_32x32x16_bf16 v[20:35], v[188:191], v[92:95], v[20:35]
    ds_read_b128 v[172:175], v225 offset:576
    ds_read_b64_tr_b16 v[108:109], v224 offset:36864
    ds_read_b64_tr_b16 v[110:111], v224 offset:37376
    s_waitcnt lgkmcnt(9)
    v_mfma_f32_32x32x16_bf16 v[20:35], v[192:195], v[96:99], v[20:35]
    ds_read_b128 v[176:179], v225 offset:608
    ds_read_b64_tr_b16 v[112:113], v224 offset:38912
    ds_read_b64_tr_b16 v[114:115], v224 offset:39424
    s_waitcnt lgkmcnt(9)
    v_mfma_f32_32x32x16_bf16 v[20:35], v[164:167], v[100:103], v[20:35]
    ds_read_b128 v[180:183], v225 offset:640
    ds_read_b64_tr_b16 v[116:117], v224 offset:40960
    ds_read_b64_tr_b16 v[118:119], v224 offset:41472
    s_waitcnt lgkmcnt(9)
    v_mfma_f32_32x32x16_bf16 v[20:35], v[168:171], v[104:107], v[20:35]
    ds_read_b128 v[184:187], v225 offset:672
    ds_read_b64_tr_b16 v[120:121], v224 offset:43008
    ds_read_b64_tr_b16 v[122:123], v224 offset:43520
    s_waitcnt lgkmcnt(9)
    v_mfma_f32_32x32x16_bf16 v[20:35], v[172:175], v[108:111], v[20:35]
    ds_read_b128 v[188:191], v225 offset:704
    ds_read_b64_tr_b16 v[124:125], v224 offset:45056
    ds_read_b64_tr_b16 v[126:127], v224 offset:45568
    s_waitcnt lgkmcnt(9)
    v_mfma_f32_32x32x16_bf16 v[20:35], v[176:179], v[112:115], v[20:35]
    ds_read_b128 v[192:195], v225 offset:736
    ds_read_b64_tr_b16 v[128:129], v224 offset:47104
    ds_read_b64_tr_b16 v[130:131], v224 offset:47616
    s_waitcnt lgkmcnt(9)
    v_mfma_f32_32x32x16_bf16 v[20:35], v[180:183], v[116:119], v[20:35]
    ds_read_b128 v[164:167], v225 offset:768
    ds_read_b64_tr_b16 v[132:133], v224 offset:49152
    ds_read_b64_tr_b16 v[134:135], v224 offset:49664
    s_waitcnt lgkmcnt(9)
    v_mfma_f32_32x32x16_bf16 v[20:35], v[184:187], v[120:123], v[20:35]
    ds_read_b128 v[168:171], v225 offset:800
    ds_read_b64_tr_b16 v[136:137], v224 offset:51200
    ds_read_b64_tr_b16 v[138:139], v224 offset:51712
    s_waitcnt lgkmcnt(9)
    v_mfma_f32_32x32x16_bf16 v[20:35], v[188:191], v[124:127], v[20:35]
    ds_read_b128 v[172:175], v225 offset:832
    ds_read_b64_tr_b16 v[140:141], v224 offset:53248
    ds_read_b64_tr_b16 v[142:143], v224 offset:53760
    s_waitcnt lgkmcnt(9)
    v_mfma_f32_32x32x16_bf16 v[20:35], v[192:195], v[128:131], v[20:35]
    ds_read_b128 v[176:179], v225 offset:864
    ds_read_b64_tr_b16 v[144:145], v224 offset:55296
    ds_read_b64_tr_b16 v[146:147], v224 offset:55808
    s_waitcnt lgkmcnt(9)
    v_mfma_f32_32x32x16_bf16 v[20:35], v[164:167], v[132:135], v[20:35]
    s_waitcnt lgkmcnt(6)
    v_mfma_f32_32x32x16_bf16 v[20:35], v[168:171], v[136:139], v[20:35]
    s_waitcnt lgkmcnt(3)
    v_mfma_f32_32x32x16_bf16 v[20:35], v[172:175], v[140:143], v[20:35]
    s_waitcnt lgkmcnt(0)
    v_mfma_f32_32x32x16_bf16 v[20:35], v[176:179], v[144:147], v[20:35]
    s_mul_i32 s74, s67, 28672
    s_lshl_b32 s75, s68, 2
    s_add_u32 s75, s75, s64
    s_lshl_b32 s75, s75, 9
    s_add_u32 s74, s74, s75
    s_add_u32 s74, s74, 81920
    v_lshlrev_b32 v222, 4, v1
    s_nop 4
    v_cvt_pk_bf16_f32 v3, v20, v21
    v_lshlrev_b32 v220, 16, v3
    v_and_b32 v221, 0xffff0000, v3
    v_sub_f32 v22, v20, v220
    v_sub_f32 v23, v21, v221
    v_cvt_pk_bf16_f32 v2, v220, v22
    v_cvt_pk_bf16_f32 v4, v23, v221
    v_mov_b32 v5, s65
    s_mov_b32 exec_hi, 0
    buffer_store_dwordx4 v[2:5], v222, s[44:47], s74 offen sc1
    s_mov_b64 exec, -1
L_hr_skip:
    s_lshl_b32 s77, s69, 8
    s_add_u32 s77, s77, 196608
    buffer_load_dword v251, off, s[44:47], s77 sc1
    s_waitcnt vmcnt(0)
    v_cmpx_eq_u32 vcc, s65, v251
    s_nop 0
    s_cmp_eq_u64 exec, -1
    s_mov_b64 exec, -1
    s_cbranch_scc0 L_hg0_re
L_hg0_ok:
    buffer_load_dword v251, v249, s[44:47], 0 offen sc1
    s_mov_b32 s74, 0
    buffer_load_dwordx4 v[164:167], v223, s[44:47], s74 offen sc1
    s_mov_b32 s74, 4096
    buffer_load_dwordx4 v[168:171], v223, s[44:47], s74 offen sc1
    s_mov_b32 s74, 8192
    buffer_load_dwordx4 v[172:175], v223, s[44:47], s74 offen sc1
    s_mov_b32 s74, 12288
    buffer_load_dwordx4 v[176:179], v223, s[44:47], s74 offen sc1
    s_mov_b32 s74, 16384
    buffer_load_dwordx4 v[180:183], v223, s[44:47], s74 offen sc1
    s_mov_b32 s74, 20480
    buffer_load_dwordx4 v[184:187], v223, s[44:47], s74 offen sc1
    s_mov_b32 s74, 24576
    buffer_load_dwordx4 v[188:191], v223, s[44:47], s74 offen sc1
    v_mov_b32 v20, 0
    v_mov_b32 v21, 0
    v_mov_b32 v22, 0
    v_mov_b32 v23, 0
    v_mov_b32 v24, 0
    v_mov_b32 v25, 0
    v_mov_b32 v26, 0
    v_mov_b32 v27, 0
    s_waitcnt vmcnt(6)
    v_dot2c_f32_bf16 v20, v164, v226
    v_dot2c_f32_bf16 v21, v164, v164
    v_dot2c_f32_bf16 v22, v165, v226
    v_dot2c_f32_bf16 v23, v165, v165
    v_dot2c_f32_bf16 v24, v166, v226
    v_dot2c_f32_bf16 v25, v166, v166
    v_dot2c_f32_bf16 v26, v167, v226
    v_dot2c_f32_bf16 v27, v167, v167
    s_waitcnt vmcnt(5)
    v_dot2c_f32_bf16 v20, v168, v226
    v_dot2c_f32_bf16 v21, v168, v168
    v_dot2c_f32_bf16 v22, v169, v226
    v_dot2c_f32_bf16 v23, v169, v169
    v_dot2c_f32_bf16 v24, v170, v226
    v_dot2c_f32_bf16 v25, v170, v170
    v_dot2c_f32_bf16 v26, v171, v226
    v_dot2c_f32_bf16 v27, v171, v171
    s_waitcnt vmcnt(4)
    v_dot2c_f32_bf16 v20, v172, v226
    v_dot2c_f32_bf16 v21, v172, v172
    v_dot2c_f32_bf16 v22, v173, v226
    v_dot2c_f32_bf16 v23, v173, v173
    v_dot2c_f32_bf16 v24, v174, v226
    v_dot2c_f32_bf16 v25, v174, v174
    v_dot2c_f32_bf16 v26, v175, v226
    v_dot2c_f32_bf16 v27, v175, v175
    s_waitcnt vmcnt(3)
    v_dot2c_f32_bf16 v20, v176, v226
    v_dot2c_f32_bf16 v21, v176, v176
    v_dot2c_f32_bf16 v22, v177, v226
    v_dot2c_f32_bf16 v23, v177, v177
    v_dot2c_f32_bf16 v24, v178, v226
    v_dot2c_f32_bf16 v25, v178, v178
    v_dot2c_f32_bf16 v26, v179, v226
    v_dot2c_f32_bf16 v27, v179, v179
    s_waitcnt vmcnt(2)
    v_dot2c_f32_bf16 v20, v180, v226
    v_dot2c_f32_bf16 v21, v180, v180
    v_dot2c_f32_bf16 v22, v181, v226
    v_dot2c_f32_bf16 v23, v181, v181
    v_dot2c_f32_bf16 v24, v182, v226
    v_dot2c_f32_bf16 v25, v182, v182
    v_dot2c_f32_bf16 v26, v183, v226
    v_dot2c_f32_bf16 v27, v183, v183
    s_waitcnt vmcnt(1)
    v_dot2c_f32_bf16 v20, v184, v226
    v_dot2c_f32_bf16 v21, v184, v184
    v_dot2c_f32_bf16 v22, v185, v226
    v_dot2c_f32_bf16 v23, v185, v185
    v_dot2c_f32_bf16 v24, v186, v226
    v_dot2c_f32_bf16 v25, v186, v186
    v_dot2c_f32_bf16 v26, v187, v226
    v_dot2c_f32_bf16 v27, v187, v187
    s_waitcnt vmcnt(0)
    v_dot2c_f32_bf16 v20, v188, v226
    v_dot2c_f32_bf16 v21, v188, v188
    v_dot2c_f32_bf16 v22, v189, v226
    v_dot2c_f32_bf16 v23, v189, v189
    v_dot2c_f32_bf16 v24, v190, v226
    v_dot2c_f32_bf16 v25, v190, v190
    v_dot2c_f32_bf16 v26, v191, v226
    v_dot2c_f32_bf16 v27, v191, v191
    v_permlane32_swap_b32 v20, v24
    v_permlane32_swap_b32 v21, v25
    v_permlane32_swap_b32 v22, v26
    v_permlane32_swap_b32 v23, v27
    v_add_f32 v20, v20, v24
    v_add_f32 v21, v21, v25
    v_add_f32 v22, v22, v26
    v_add_f32 v23, v23, v27
    s_nop 0
    v_permlane16_swap_b32 v20, v22
    v_permlane16_swap_b32 v21, v23
    v_add_f32 v20, v20, v22
    v_add_f32 v21, v21, v23
    s_nop 0
    v_add_f32_dpp v20, v20, v20 row_ror:8 row_mask:0xf bank_mask:0xf
    v_add_f32_dpp v21, v21, v21 row_ror:8 row_mask:0xf bank_mask:0xf
    ds_write_b64 v227, v[20:21] offset:0
    s_waitcnt lgkmcnt(0)
    s_barrier
    s_cmp_lg_u32 s64, 0
    s_cbranch_scc1 L_hs_n0
    ds_read_b64 v[230:231], v228 offset:0
    ds_read_b64 v[232:233], v228 offset:256
    ds_read_b64 v[234:235], v228 offset:512
    ds_read_b64 v[236:237], v228 offset:768
    v_mov_b32 v222, 0x3b124925
    s_waitcnt lgkmcnt(0)
    v_pk_add_f32 v[230:231], v[230:231], v[232:233]
    v_pk_add_f32 v[234:235], v[234:235], v[236:237]
    v_pk_add_f32 v[230:231], v[230:231], v[234:235]
    v_mul_f32 v230, 0xbb124925, v230
    v_mul_f32 v220, v230, v230
    v_fma_f32 v231, v231, v222, -v220
    v_max_f32 v231, 0, v231
    v_add_f32 v231, 0x3727c5ac, v231
    v_sqrt_f32 v231, v231
    v_cvt_pk_bf16_f32 v2, v230, v230
    v_cvt_pk_bf16_f32 v221, v231, v231
    v_and_b32 v220, 0xffff0000, v2
    v_and_b32 v221, 0xffff0000, v221
    v_sub_f32 v232, v230, v220
    v_sub_f32 v233, v231, v221
    v_cvt_pk_bf16_f32 v3, v232, v221
    v_cvt_pk_bf16_f32 v4, v221, v233
    v_mov_b32 v5, s65
    s_mov_b32 exec_hi, 0
    buffer_store_dwordx4 v[2:5], v229, s[44:47], s79 offen offset:0 sc1
    s_mov_b64 exec, -1
L_hs_n0:
    s_lshl_b32 s77, s69, 8
    s_add_u32 s77, s77, 196736
    buffer_load_dword v251, off, s[44:47], s77 sc1
    s_waitcnt vmcnt(0)
    v_cmpx_eq_u32 vcc, s65, v251
    s_nop 0
    s_cmp_eq_u64 exec, -1
    s_mov_b64 exec, -1
    s_cbranch_scc0 L_hg1_re
L_hg1_ok:
    s_mov_b32 s74, 57344
    buffer_load_dwordx4 v[192:195], v223, s[44:47], s74 offen sc1
    s_mov_b32 s74, 61440
    buffer_load_dwordx4 v[196:199], v223, s[44:47], s74 offen sc1
    s_mov_b32 s74, 65536
    buffer_load_dwordx4 v[200:203], v223, s[44:47], s74 offen sc1
    s_mov_b32 s74, 69632
    buffer_load_dwordx4 v[204:207], v223, s[44:47], s74 offen sc1
    s_mov_b32 s74, 73728
    buffer_load_dwordx4 v[208:211], v223, s[44:47], s74 offen sc1
    s_mov_b32 s74, 77824
    buffer_load_dwordx4 v[212:215], v223, s[44:47], s74 offen sc1
    s_mov_b32 s74, 81920
    buffer_load_dwordx4 v[216:219], v223, s[44:47], s74 offen sc1
    v_mov_b32 v20, 0
    v_mov_b32 v21, 0
    v_mov_b32 v22, 0
    v_mov_b32 v23, 0
    v_mov_b32 v24, 0
    v_mov_b32 v25, 0
    v_mov_b32 v26, 0
    v_mov_b32 v27, 0
    s_waitcnt vmcnt(6)
    v_dot2c_f32_bf16 v20, v192, v226
    v_dot2c_f32_bf16 v21, v192, v192
    v_dot2c_f32_bf16 v22, v193, v226
    v_dot2c_f32_bf16 v23, v193, v193
    v_dot2c_f32_bf16 v24, v194, v226
    v_dot2c_f32_bf16 v25, v194, v194
    v_dot2c_f32_bf16 v26, v195, v226
    v_dot2c_f32_bf16 v27, v195, v195
    s_waitcnt vmcnt(5)
    v_dot2c_f32_bf16 v20, v196, v226
    v_dot2c_f32_bf16 v21, v196, v196
    v_dot2c_f32_bf16 v22, v197, v226
    v_dot2c_f32_bf16 v23, v197, v197
    v_dot2c_f32_bf16 v24, v198, v226
    v_dot2c_f32_bf16 v25, v198, v198
    v_dot2c_f32_bf16 v26, v199, v226
    v_dot2c_f32_bf16 v27, v199, v199
    s_waitcnt vmcnt(4)
    v_dot2c_f32_bf16 v20, v200, v226
    v_dot2c_f32_bf16 v21, v200, v200
    v_dot2c_f32_bf16 v22, v201, v226
    v_dot2c_f32_bf16 v23, v201, v201
    v_dot2c_f32_bf16 v24, v202, v226
    v_dot2c_f32_bf16 v25, v202, v202
    v_dot2c_f32_bf16 v26, v203, v226
    v_dot2c_f32_bf16 v27, v203, v203
    s_waitcnt vmcnt(3)
    v_dot2c_f32_bf16 v20, v204, v226
    v_dot2c_f32_bf16 v21, v204, v204
    v_dot2c_f32_bf16 v22, v205, v226
    v_dot2c_f32_bf16 v23, v205, v205
    v_dot2c_f32_bf16 v24, v206, v226
    v_dot2c_f32_bf16 v25, v206, v206
    v_dot2c_f32_bf16 v26, v207, v226
    v_dot2c_f32_bf16 v27, v207, v207
    s_waitcnt vmcnt(2)
    v_dot2c_f32_bf16 v20, v208, v226
    v_dot2c_f32_bf16 v21, v208, v208
    v_dot2c_f32_bf16 v22, v209, v226
    v_dot2c_f32_bf16 v23, v209, v209
    v_dot2c_f32_bf16 v24, v210, v226
    v_dot2c_f32_bf16 v25, v210, v210
    v_dot2c_f32_bf16 v26, v211, v226
    v_dot2c_f32_bf16 v27, v211, v211
    s_waitcnt vmcnt(1)
    v_dot2c_f32_bf16 v20, v212, v226
    v_dot2c_f32_bf16 v21, v212, v212
    v_dot2c_f32_bf16 v22, v213, v226
    v_dot2c_f32_bf16 v23, v213, v213
    v_dot2c_f32_bf16 v24, v214, v226
    v_dot2c_f32_bf16 v25, v214, v214
    v_dot2c_f32_bf16 v26, v215, v226
    v_dot2c_f32_bf16 v27, v215, v215
    s_waitcnt vmcnt(0)
    v_dot2c_f32_bf16 v20, v216, v226
    v_dot2c_f32_bf16 v21, v216, v216
    v_dot2c_f32_bf16 v22, v217, v226
    v_dot2c_f32_bf16 v23, v217, v217
    v_dot2c_f32_bf16 v24, v218, v226
    v_dot2c_f32_bf16 v25, v218, v218
    v_dot2c_f32_bf16 v26, v219, v226
    v_dot2c_f32_bf16 v27, v219, v219
    v_permlane32_swap_b32 v20, v24
    v_permlane32_swap_b32 v21, v25
    v_permlane32_swap_b32 v22, v26
    v_permlane32_swap_b32 v23, v27
    v_add_f32 v20, v20, v24
    v_add_f32 v21, v21, v25
    v_add_f32 v22, v22, v26
    v_add_f32 v23, v23, v27
    s_nop 0
    v_permlane16_swap_b32 v20, v22
    v_permlane16_swap_b32 v21, v23
    v_add_f32 v20, v20, v22
    v_add_f32 v21, v21, v23
    s_nop 0
    v_add_f32_dpp v20, v20, v20 row_ror:8 row_mask:0xf bank_mask:0xf
    v_add_f32_dpp v21, v21, v21 row_ror:8 row_mask:0xf bank_mask:0xf
    ds_write_b64 v227, v[20:21] offset:1024
    s_waitcnt lgkmcnt(0)
    s_barrier
    s_cmp_lg_u32 s64, 1
    s_cbranch_scc1 L_hs_n1
    ds_read_b64 v[230:231], v228 offset:1024
    ds_read_b64 v[232:233], v228 offset:1280
    ds_read_b64 v[234:235], v228 offset:1536
    ds_read_b64 v[236:237], v228 offset:1792
    v_mov_b32 v222, 0x3b124925
    s_waitcnt lgkmcnt(0)
    v_pk_add_f32 v[230:231], v[230:231], v[232:233]
    v_pk_add_f32 v[234:235], v[234:235], v[236:237]
    v_pk_add_f32 v[230:231], v[230:231], v[234:235]
    v_mul_f32 v230, 0xbb124925, v230
    v_mul_f32 v220, v230, v230
    v_fma_f32 v231, v231, v222, -v220
    v_max_f32 v231, 0, v231
    v_add_f32 v231, 0x3727c5ac, v231
    v_sqrt_f32 v231, v231
    v_cvt_pk_bf16_f32 v2, v230, v230
    v_cvt_pk_bf16_f32 v221, v231, v231
    v_and_b32 v220, 0xffff0000, v2
    v_and_b32 v221, 0xffff0000, v221
    v_sub_f32 v232, v230, v220
    v_sub_f32 v233, v231, v221
    v_cvt_pk_bf16_f32 v3, v232, v221
    v_cvt_pk_bf16_f32 v4, v221, v233
    v_mov_b32 v5, s65
    s_mov_b32 exec_hi, 0
    buffer_store_dwordx4 v[2:5], v229, s[44:47], s79 offen offset:1024 sc1
    s_mov_b64 exec, -1
L_hs_n1:
L_end:
    s_endpgm
L_m1_re:
    s_mov_b32 s78, 200000
L_m1_lp:
    s_sleep 1
    buffer_load_dwordx4 v[32:35], v20, s[44:47], 0 offen sc1
    s_waitcnt vmcnt(0)
    v_cmpx_eq_u32 vcc, s65, v35
    s_nop 0
    s_cmp_eq_u64 exec, -1
    s_mov_b64 exec, -1
    s_cbranch_scc1 L_m1_ok
    s_sub_u32 s78, s78, 1
    s_cmp_lg_u32 s78, 0
    s_cbranch_scc1 L_m1_lp
    s_branch L_m1_ok
L_h1_re:
    s_mov_b32 s78, 200000
L_h1_lp:
    s_sleep 1
    s_mov_b32 s37, 4096
    buffer_load_dwordx4 v[58:61], v52, s[44:47], s37 offen offset:0 sc1
    buffer_load_dwordx4 v[62:65], v52, s[44:47], s37 offen offset:1024 sc1
    s_mov_b32 s37, 12288
    buffer_load_dwordx4 v[44:47], v52, s[44:47], s37 offen offset:0 sc1
    buffer_load_dwordx4 v[48:51], v52, s[44:47], s37 offen offset:1024 sc1
    s_waitcnt vmcnt(0)
    v_cmpx_eq_u32 vcc, s65, v61
    v_cmpx_eq_u32 vcc, s65, v65
    v_cmpx_eq_u32 vcc, s65, v47
    v_cmpx_eq_u32 vcc, s65, v51
    s_nop 0
    s_cmp_eq_u64 exec, -1
    s_mov_b64 exec, -1
    s_cbranch_scc1 L_h1_ok
    s_sub_u32 s78, s78, 1
    s_cmp_lg_u32 s78, 0
    s_cbranch_scc1 L_h1_lp
    s_branch L_h1_ok
L_m2_re:
    s_mov_b32 s78, 200000
L_m2_lp:
    s_sleep 1
    buffer_load_dwordx4 v[32:35], v20, s[44:47], 0 offen sc1
    s_waitcnt vmcnt(0)
    v_cmp_ne_u32 vcc, s65, v35
    s_nop 0
    s_cbranch_vccz L_m2_ok
    s_sub_u32 s78, s78, 1
    s_cmp_lg_u32 s78, 0
    s_cbranch_scc1 L_m2_lp
    s_branch L_m2_ok
L_f2_re:
    s_mov_b32 s78, 200000
L_f2_lp:
    s_sleep 1
    buffer_load_dword v48, off, s[44:47], s36 sc1
    s_waitcnt vmcnt(0)
    v_cmpx_eq_u32 vcc, s65, v48
    s_nop 0
    s_cmp_eq_u64 exec, -1
    s_mov_b64 exec, -1
    s_cbranch_scc1 L_f2_ok
    s_sub_u32 s78, s78, 1
    s_cmp_lg_u32 s78, 0
    s_cbranch_scc1 L_f2_lp
    s_branch L_f2_ok
L_g_re:
    s_mov_b32 s78, 200000
L_g_lp:
    s_sleep 1
    buffer_load_dwordx4 v[24:27], v5, s[44:47], s20 offen sc1
    buffer_load_dwordx4 v[28:31], v5, s[44:47], s20 offen offset:3584 sc1
    buffer_load_dwordx4 v[32:35], v86, s[44:47], s21 offen sc1
    s_waitcnt vmcnt(0)
    v_cmp_ne_u32 vcc, s65, v27
    v_cmp_ne_u32 s[72:73], s65, v31
    s_nop 0
    s_or_b64 vcc, vcc, s[72:73]
    v_cmp_ne_u32 s[72:73], s65, v35
    s_nop 0
    s_or_b64 vcc, vcc, s[72:73]
    s_cbranch_vccz L_g_ok
    s_sub_u32 s78, s78, 1
    s_cmp_lg_u32 s78, 0
    s_cbranch_scc1 L_g_lp
    s_branch L_g_ok
L_gb_re:
    s_mov_b32 s78, 200000
L_gb_lp:
    s_sleep 1
    buffer_load_dword v13, off, s[44:47], s36 offset:128 sc1
    s_waitcnt vmcnt(0)
    v_cmp_ne_u32 s[34:35], s65, v13
    s_nop 0
    s_cmp_eq_u64 s[34:35], 0
    s_cbranch_scc1 L_gb_ok
    s_sub_u32 s78, s78, 1
    s_cmp_lg_u32 s78, 0
    s_cbranch_scc1 L_gb_lp
    s_branch L_gb_ok
L_s0_re:
    s_mov_b32 s78, 200000
L_s0_lp:
    s_sleep 1
    buffer_load_dwordx4 v[40:43], v5, s[44:47], s16 offen offset:0 sc1
    s_waitcnt vmcnt(0)
    v_cmp_ne_u32 vcc, s65, v43
    s_nop 0
    s_cbranch_vccz L_s0_ok
    s_sub_u32 s78, s78, 1
    s_cmp_lg_u32 s78, 0
    s_cbranch_scc1 L_s0_lp
    s_branch L_s0_ok
L_s1_re:
    s_mov_b32 s78, 200000
L_s1_lp:
    s_sleep 1
    buffer_load_dwordx4 v[44:47], v5, s[44:47], s16 offen offset:512 sc1
    s_waitcnt vmcnt(0)
    v_cmp_ne_u32 vcc, s65, v47
    s_nop 0
    s_cbranch_vccz L_s1_ok
    s_sub_u32 s78, s78, 1
    s_cmp_lg_u32 s78, 0
    s_cbranch_scc1 L_s1_lp
    s_branch L_s1_ok
L_s2_re:
    s_mov_b32 s78, 200000
L_s2_lp:
    s_sleep 1
    buffer_load_dwordx4 v[48:51], v5, s[44:47], s16 offen offset:1024 sc1
    s_waitcnt vmcnt(0)
    v_cmp_ne_u32 vcc, s65, v51
    s_nop 0
    s_cbranch_vccz L_s2_ok
    s_sub_u32 s78, s78, 1
    s_cmp_lg_u32 s78, 0
    s_cbranch_scc1 L_s2_lp
    s_branch L_s2_ok
L_s3_re:
    s_mov_b32 s78, 200000
L_s3_lp:
    s_sleep 1
    buffer_load_dwordx4 v[52:55], v5, s[44:47], s16 offen offset:1536 sc1
    s_waitcnt vmcnt(0)
    v_cmp_ne_u32 vcc, s65, v55
    s_nop 0
    s_cbranch_vccz L_s3_ok
    s_sub_u32 s78, s78, 1
    s_cmp_lg_u32 s78, 0
    s_cbranch_scc1 L_s3_lp
    s_branch L_s3_ok
L_p0_re:
    s_mov_b32 s78, 200000
L_p0_lp:
    s_sleep 1
    s_mov_b32 s77, 0
    buffer_load_dword v13, v19, s[44:47], s77 offen sc1
    s_waitcnt vmcnt(0)
    v_cmp_ne_u32 s[34:35], s65, v13
    s_nop 0
    s_cmp_eq_u64 s[34:35], 0
    s_cbranch_scc1 L_p0_ok
    s_sub_u32 s78, s78, 1
    s_cmp_lg_u32 s78, 0
    s_cbranch_scc1 L_p0_lp
    s_branch L_p0_ok
L_p1_re:
    s_mov_b32 s78, 200000
L_p1_lp:
    s_sleep 1
    s_mov_b32 s77, 1024
    buffer_load_dword v13, v19, s[44:47], s77 offen sc1
    s_waitcnt vmcnt(0)
    v_cmp_ne_u32 vcc, s65, v13
    s_nop 0
    s_cbranch_vccz L_p1_ok
    s_sub_u32 s78, s78, 1
    s_cmp_lg_u32 s78, 0
    s_cbranch_scc1 L_p1_lp
    s_branch L_p1_ok
L_p2_re:
    s_mov_b32 s78, 200000
L_p2_lp:
    s_sleep 1
    s_mov_b32 s77, 2048
    buffer_load_dword v13, v19, s[44:47], s77 offen sc1
    s_waitcnt vmcnt(0)
    v_cmp_ne_u32 vcc, s65, v13
    s_nop 0
    s_cbranch_vccz L_p2_ok
    s_sub_u32 s78, s78, 1
    s_cmp_lg_u32 s78, 0
    s_cbranch_scc1 L_p2_lp
    s_branch L_p2_ok
L_p3_re:
    s_mov_b32 s78, 200000
L_p3_lp:
    s_sleep 1
    s_mov_b32 s77, 3072
    buffer_load_dword v13, v19, s[44:47], s77 offen sc1
    s_waitcnt vmcnt(0)
    v_cmp_ne_u32 vcc, s65, v13
    s_nop 0
    s_cbranch_vccz L_p3_ok
    s_sub_u32 s78, s78, 1
    s_cmp_lg_u32 s78, 0
    s_cbranch_scc1 L_p3_lp
    s_branch L_p3_ok
L_m1_re_B:
    s_mov_b32 s78, 200000
L_m1_lp_B:
    s_sleep 1
    buffer_load_dwordx4 v[32:35], v20, s[44:47], 0 offen sc1
    s_waitcnt vmcnt(0)
    v_cmpx_eq_u32 vcc, s65, v35
    s_nop 0
    s_cmp_eq_u64 exec, -1
    s_mov_b64 exec, -1
    s_cbranch_scc1 L_m1_ok_B
    s_sub_u32 s78, s78, 1
    s_cmp_lg_u32 s78, 0
    s_cbranch_scc1 L_m1_lp_B
    s_branch L_m1_ok_B
L_h1_re_B:
    s_mov_b32 s78, 200000
L_h1_lp_B:
    s_sleep 1
    s_mov_b32 s37, 4096
    buffer_load_dwordx4 v[58:61], v52, s[44:47], s37 offen offset:0 sc1
    buffer_load_dwordx4 v[62:65], v52, s[44:47], s37 offen offset:1024 sc1
    s_mov_b32 s37, 12288
    buffer_load_dwordx4 v[44:47], v52, s[44:47], s37 offen offset:0 sc1
    buffer_load_dwordx4 v[48:51], v52, s[44:47], s37 offen offset:1024 sc1
    s_waitcnt vmcnt(0)
    v_cmpx_eq_u32 vcc, s65, v61
    v_cmpx_eq_u32 vcc, s65, v65
    v_cmpx_eq_u32 vcc, s65, v47
    v_cmpx_eq_u32 vcc, s65, v51
    s_nop 0
    s_cmp_eq_u64 exec, -1
    s_mov_b64 exec, -1
    s_cbranch_scc1 L_h1_ok_B
    s_sub_u32 s78, s78, 1
    s_cmp_lg_u32 s78, 0
    s_cbranch_scc1 L_h1_lp_B
    s_branch L_h1_ok_B
L_m2_re_B:
    s_mov_b32 s78, 200000
L_m2_lp_B:
    s_sleep 1
    buffer_load_dwordx4 v[32:35], v20, s[44:47], 0 offen sc1
    s_waitcnt vmcnt(0)
    v_cmp_ne_u32 vcc, s65, v35
    s_nop 0
    s_cbranch_vccz L_m2_ok_B
    s_sub_u32 s78, s78, 1
    s_cmp_lg_u32 s78, 0
    s_cbranch_scc1 L_m2_lp_B
    s_branch L_m2_ok_B
L_hg_re:
    s_mov_b32 s78, 200000
L_hg_lp:
    s_sleep 1
    s_mov_b32 s77, 61440
    buffer_load_dwordx4 v[2:5], v220, s[44:47], s77 offen sc1
    buffer_load_dwordx4 v[6:9], v220, s[44:47], s77 offen offset:3584 sc1
    s_mov_b32 s77, 54272
    buffer_load_dwordx4 v[10:13], v220, s[44:47], s77 offen sc1
    buffer_load_dwordx4 v[14:17], v220, s[44:47], s77 offen offset:3584 sc1
    s_waitcnt vmcnt(0)
    v_cmpx_eq_u32 vcc, s65, v5
    v_cmpx_eq_u32 vcc, s65, v9
    v_cmpx_eq_u32 vcc, s65, v13
    v_cmpx_eq_u32 vcc, s65, v17
    s_nop 0
    s_cmp_eq_u64 exec, -1
    s_mov_b64 exec, -1
    s_cbranch_scc1 L_hg_ok
    s_sub_u32 s78, s78, 1
    s_cmp_lg_u32 s78, 0
    s_cbranch_scc1 L_hg_lp
    s_branch L_hg_ok
L_hg0_re:
    s_mov_b32 s78, 200000
L_hg0_lp:
    s_sleep 1
    buffer_load_dword v251, off, s[44:47], s77 sc1
    s_waitcnt vmcnt(0)
    v_cmpx_eq_u32 vcc, s65, v251
    s_nop 0
    s_cmp_eq_u64 exec, -1
    s_mov_b64 exec, -1
    s_cbranch_scc1 L_hg0_ok
    s_sub_u32 s78, s78, 1
    s_cmp_lg_u32 s78, 0
    s_cbranch_scc1 L_hg0_lp
    s_branch L_hg0_ok
L_hg1_re:
    s_mov_b32 s78, 200000
L_hg1_lp:
    s_sleep 1
    buffer_load_dword v251, off, s[44:47], s77 sc1
    s_waitcnt vmcnt(0)
    v_cmpx_eq_u32 vcc, s65, v251
    s_nop 0
    s_cmp_eq_u64 exec, -1
    s_mov_b64 exec, -1
    s_cbranch_scc1 L_hg1_ok
    s_sub_u32 s78, s78, 1
    s_cmp_lg_u32 s78, 0
    s_cbranch_scc1 L_hg1_lp
    s_branch L_hg1_ok
L_code_end:
.section .rodata,"a"
.p2align 6
.amdhsa_kernel adaLN_cond__ssm_conv_s4__swiglu_ffn__prompt_kernel
  .amdhsa_next_free_vgpr 512
  .amdhsa_next_free_sgpr 102
  .amdhsa_accum_offset 256
  .amdhsa_group_segment_fixed_size 0
  .amdhsa_kernarg_size 144
  .amdhsa_user_sgpr_count 2
  .amdhsa_user_sgpr_kernarg_segment_ptr 1
  .amdhsa_system_sgpr_workgroup_id_x 1
  .amdhsa_float_denorm_mode_32 3
.end_amdhsa_kernel
```
